```python
import torch

def _softmax(x, axis=-1):
    return torch.softmax(x, dim=axis)
def _gelu(x):
    return torch.nn.functional.gelu(x, approximate="tanh")
def _silu(x):
    return torch.nn.functional.silu(x)
def _sigmoid(x):
    return torch.sigmoid(x)
def _layernorm(x, axis=-1, eps=1e-5):
    m = x.mean(dim=axis, keepdim=True)
    v = x.var(dim=axis, keepdim=True, unbiased=False)
    return (x - m) / torch.sqrt(v + eps)
def _scatter_add(tgt, idx, src, axis=0):
    return tgt.clone().index_add_(axis, idx, src)
def _segment_sum(src, seg, n):
    out = torch.zeros((n,) + src.shape[1:], dtype=src.dtype)
    return out.index_add_(0, seg, src)
def _pad(x, pw):
    flat = tuple(v for pair in reversed(pw) for v in pair)
    return torch.nn.functional.pad(x, flat)

kernel_name = 'sequential_preLN__linear_kernel_hedgehog__geglu_ffn__prompt'

def setup_inputs():

    _w = (lambda a: (lambda t: t.to(torch.bfloat16) if t.is_floating_point() else t)(torch.as_tensor(a)))
    def _A_setup():
        B, S, D, H = 1, 2048, 576, 32
        Dh = D // H
        return {
            "x": _w((lambda *s: torch.randn(*s, dtype=torch.bfloat16) * 0.05)(B, S, D)),
            "wqkv": _w((lambda *s: torch.randn(*s, dtype=torch.bfloat16) * 0.2)(D, 3 * D)),
            "w_phi": _w((lambda *s: torch.randn(*s, dtype=torch.bfloat16) * 0.2)(H, Dh, Dh) * (Dh ** -0.5)),
            "wo": _w((lambda *s: torch.randn(*s, dtype=torch.bfloat16) * 0.05)(D, D)),
        }
    _A_in = _A_setup()

    def _B_setup():
        B, S, D, F = 1, 2048, 576, 4608
        return {
            "x": _w((lambda *s: torch.randn(*s, dtype=torch.bfloat16) * 0.05)(B, S, D)),
            "w_gate": _w((lambda *s: torch.randn(*s, dtype=torch.bfloat16) * 0.05)(D, F)),
            "w_up": _w((lambda *s: torch.randn(*s, dtype=torch.bfloat16) * 0.05)(D, F)),
            "w_down": _w((lambda *s: torch.randn(*s, dtype=torch.bfloat16) * 0.05)(F, D)),
        }
    _B_in = _B_setup()

    return {
        "A_x": _A_in["x"],
        "A_wqkv": _A_in["wqkv"],
        "A_w_phi": _A_in["w_phi"],
        "A_wo": _A_in["wo"],
        "B_x": _B_in["x"],
        "B_w_gate": _B_in["w_gate"],
        "B_w_up": _B_in["w_up"],
        "B_w_down": _B_in["w_down"],
    }

def reference(A_x, A_wqkv, A_w_phi, A_wo, B_x, B_w_gate, B_w_up, B_w_down):
    def _A_ref(x, wqkv, w_phi, wo):
        B, S, D = x.shape
        H = 32; Dh = D // H
        qkv = (lambda x, *d: x.permute(*d))((x @ wqkv).reshape(B, S, 3, H, Dh), 2, 0, 3, 1, 4)
        q, k, v = qkv[0], qkv[1], qkv[2]
        pq = torch.einsum("bhsd,hdf->bhsf", q, w_phi)
        pk = torch.einsum("bhsd,hdf->bhsf", k, w_phi)
        phi_q = torch.concatenate([_softmax(pq, axis=-1), _softmax(-pq, axis=-1)], axis=-1)
        phi_k = torch.concatenate([_softmax(pk, axis=-1), _softmax(-pk, axis=-1)], axis=-1)
        kv = torch.einsum("bhsf,bhsd->bhfd", phi_k, v)
        z  = torch.einsum("bhsf->bhf", phi_k)
        num = torch.einsum("bhqf,bhfd->bhqd", phi_q, kv)
        den = torch.einsum("bhqf,bhf->bhq", phi_q, z)[..., None] + 1e-6
        o = num / den
        return (lambda x, *d: x.permute(*d))(o, 0, 2, 1, 3).reshape(B, S, D) @ wo

    def _B_ref(x, w_gate, w_up, w_down):
        return (_gelu(x @ w_gate) * (x @ w_up)) @ w_down

    x = A_x
    h = x + _A_ref(_layernorm(x, axis=-1), A_wqkv, A_w_phi, A_wo)
    h2 = h + _B_ref(_layernorm(h, axis=-1), B_w_gate, B_w_up, B_w_down)
    return h2
```

```asm
; @launch kernel=k1_kernel grid=(580,1,1) block=(256,1,1) lds=74752
; @launch kernel=k2_kernel grid=(256,1,1) block=(256,1,1) lds=147456
.amdgcn_target "amdgcn-amd-amdhsa--gfx950"
.text
.globl k1_kernel
.p2align 8
.type k1_kernel,@function
k1_kernel:

    s_cmp_ge_u32 s2, 580
    s_cbranch_scc1 L_k1_kernel_end
    s_load_dwordx2 s[4:5], s[0:1], 80
    s_load_dwordx2 s[6:7], s[0:1], 72
    s_load_dwordx2 s[96:97], s[0:1], 0
    s_load_dwordx4 s[36:39], s[0:1], 8
    s_memrealtime s[84:85]
    v_lshrrev_b32 v3, 6, v0
    v_mov_b32 v15, v0
    v_and_b32 v0, 63, v0
    v_readfirstlane_b32 s12, v3
    v_lshlrev_b32 v1, 4, v0
    s_getpc_b64 s[90:91]
L_k1_kernel_pc0:
    s_add_u32 s90, s90, k1_kernel-L_k1_kernel_pc0
    s_addc_u32 s91, s91, -1
    v_lshlrev_b32 v250, 7, v15
    v_min_u32 v251, L_k1_kernel_end-k1_kernel-4, v250
    global_load_dword v252, v251, s[90:91]
    s_waitcnt lgkmcnt(0)
    s_mov_b32 s8, s4
    s_mov_b32 s9, s5
    s_mov_b32 s10, 0x10000000
    s_mov_b32 s11, 0x00020000
    s_mov_b32 s92, s6
    s_mov_b32 s93, s7
    s_mov_b32 s94, 256
    s_mov_b32 s95, 0x00020000
    s_or_b32 s26, s2, s12
    s_cmp_lg_u32 s26, 0
    s_cbranch_scc1 L_k1_kernel_nn
    s_or_b32 s84, s84, 1
    v_mov_b32 v4, 0
    v_mov_b32 v5, s84
    s_mov_b64 exec, 1
    buffer_store_dword v5, v4, s[92:95], 0 offen sc1
    s_mov_b64 exec, -1
L_k1_kernel_nn:
    s_cmp_lt_u32 s2, 72
    s_cbranch_scc1 L_k1_kernel_bg
    s_cmp_ge_u32 s2, 328
    s_cbranch_scc1 L_k1_kernel_bg
    s_sub_u32 s2, s2, 72
    s_and_b32 s14, s2, 3
    s_lshl_b32 s14, s14, 2
    s_bfe_u32 s15, s2, 0x20003
    s_add_u32 s14, s14, s15
    s_bfe_u32 s13, s2, 0x10002
    s_lshl_b32 s13, s13, 3
    s_lshr_b32 s15, s2, 5
    s_add_u32 s13, s13, s15
    s_mov_b32 s24, s96
    s_mov_b32 s25, s97
    s_mov_b32 s26, 2359296
    s_mov_b32 s27, 0x00020000
    s_setprio 2
    s_lshl_b32 s18, s13, 3
    s_lshl_b32 s19, s12, 1
    s_add_u32 s18, s18, s19
    s_mul_i32 s20, s18, 18432
    s_mul_i32 s21, s12, 18688
    v_lshrrev_b32 v4, 3, v0
    v_mul_u32_u24 v4, 1152, v4
    v_and_b32 v5, 7, v0
    v_lshlrev_b32 v5, 4, v5
    v_add_u32 v4, v4, v5
    v_add_u32 v4, 1024, v4
    s_add_u32 m0, s21, 0
    s_add_u32 s22, s20, 0
    buffer_load_dwordx4 v1, s[24:27], s22 offen lds
    s_add_u32 m0, s21, 1040
    s_add_u32 s22, s20, 1152
    buffer_load_dwordx4 v1, s[24:27], s22 offen lds
    s_add_u32 m0, s21, 2080
    s_add_u32 s22, s20, 2304
    buffer_load_dwordx4 v1, s[24:27], s22 offen lds
    s_add_u32 m0, s21, 3120
    s_add_u32 s22, s20, 3456
    buffer_load_dwordx4 v1, s[24:27], s22 offen lds
    s_add_u32 m0, s21, 4160
    s_add_u32 s22, s20, 4608
    buffer_load_dwordx4 v1, s[24:27], s22 offen lds
    s_add_u32 m0, s21, 5200
    s_add_u32 s22, s20, 5760
    buffer_load_dwordx4 v1, s[24:27], s22 offen lds
    s_add_u32 m0, s21, 6240
    s_add_u32 s22, s20, 6912
    buffer_load_dwordx4 v1, s[24:27], s22 offen lds
    s_add_u32 m0, s21, 7280
    s_add_u32 s22, s20, 8064
    buffer_load_dwordx4 v1, s[24:27], s22 offen lds
    s_add_u32 m0, s21, 8320
    s_add_u32 s22, s20, 9216
    buffer_load_dwordx4 v1, s[24:27], s22 offen lds
    s_add_u32 m0, s21, 9360
    s_add_u32 s22, s20, 10368
    buffer_load_dwordx4 v1, s[24:27], s22 offen lds
    s_add_u32 m0, s21, 10400
    s_add_u32 s22, s20, 11520
    buffer_load_dwordx4 v1, s[24:27], s22 offen lds
    s_add_u32 m0, s21, 11440
    s_add_u32 s22, s20, 12672
    buffer_load_dwordx4 v1, s[24:27], s22 offen lds
    s_add_u32 m0, s21, 12480
    s_add_u32 s22, s20, 13824
    buffer_load_dwordx4 v1, s[24:27], s22 offen lds
    s_add_u32 m0, s21, 13520
    s_add_u32 s22, s20, 14976
    buffer_load_dwordx4 v1, s[24:27], s22 offen lds
    s_add_u32 m0, s21, 14560
    s_add_u32 s22, s20, 16128
    buffer_load_dwordx4 v1, s[24:27], s22 offen lds
    s_add_u32 m0, s21, 15600
    s_add_u32 s22, s20, 17280
    buffer_load_dwordx4 v1, s[24:27], s22 offen lds
    s_add_u32 m0, s21, 16640
    s_add_u32 s22, s20, 0
    buffer_load_dwordx4 v4, s[24:27], s22 offen lds
    s_add_u32 m0, s21, 17664
    s_add_u32 s22, s20, 9216
    buffer_load_dwordx4 v4, s[24:27], s22 offen lds
    s_cmp_lg_u32 s12, 0
    s_cbranch_scc1 L_ni1
    v_mov_b32 v13, 0
    buffer_load_dword v14, v13, s[92:95], 0 offen sc1
L_ni1:
    v_and_b32 v6, 15, v0
    v_lshrrev_b32 v7, 4, v0
    v_mul_u32_u24 v8, 1040, v6
    v_lshlrev_b32 v9, 4, v7
    v_add_u32 v8, v8, v9
    v_add_u32 v8, s21, v8
    v_lshlrev_b32 v10, 7, v6
    v_add_u32 v10, v10, v9
    s_add_u32 s23, s21, 16640
    v_add_u32 v10, s23, v10
    s_mov_b32 s28, 0x3f803f80
    s_mov_b32 s29, 0xffff0000
    s_waitcnt vmcnt(0)
    ds_read_b128 v[112:115], v8 offset:0
    ds_read_b128 v[116:119], v8 offset:64
    ds_read_b128 v[120:123], v8 offset:128
    ds_read_b128 v[124:127], v8 offset:192
    ds_read_b128 v[128:131], v8 offset:256
    ds_read_b128 v[132:135], v8 offset:320
    ds_read_b128 v[136:139], v8 offset:384
    ds_read_b128 v[140:143], v8 offset:448
    ds_read_b128 v[144:147], v8 offset:512
    ds_read_b128 v[148:151], v8 offset:576
    ds_read_b128 v[152:155], v8 offset:640
    ds_read_b128 v[156:159], v8 offset:704
    s_waitcnt lgkmcnt(4)
    ds_read_b128 v[160:163], v8 offset:768
    ds_read_b128 v[164:167], v8 offset:832
    ds_read_b128 v[168:171], v8 offset:896
    ds_read_b128 v[172:175], v8 offset:960
    ds_read_b128 v[176:179], v10 offset:0
    ds_read_b128 v[180:183], v10 offset:64
    s_waitcnt lgkmcnt(0)
    s_add_u32 m0, s21, 0
    s_add_u32 s22, s20, 18432
    buffer_load_dwordx4 v1, s[24:27], s22 offen lds
    s_add_u32 m0, s21, 1040
    s_add_u32 s22, s20, 19584
    buffer_load_dwordx4 v1, s[24:27], s22 offen lds
    s_add_u32 m0, s21, 2080
    s_add_u32 s22, s20, 20736
    buffer_load_dwordx4 v1, s[24:27], s22 offen lds
    s_add_u32 m0, s21, 3120
    s_add_u32 s22, s20, 21888
    buffer_load_dwordx4 v1, s[24:27], s22 offen lds
    s_add_u32 m0, s21, 4160
    s_add_u32 s22, s20, 23040
    buffer_load_dwordx4 v1, s[24:27], s22 offen lds
    s_add_u32 m0, s21, 5200
    s_add_u32 s22, s20, 24192
    buffer_load_dwordx4 v1, s[24:27], s22 offen lds
    s_add_u32 m0, s21, 6240
    s_add_u32 s22, s20, 25344
    buffer_load_dwordx4 v1, s[24:27], s22 offen lds
    s_add_u32 m0, s21, 7280
    s_add_u32 s22, s20, 26496
    buffer_load_dwordx4 v1, s[24:27], s22 offen lds
    s_add_u32 m0, s21, 8320
    s_add_u32 s22, s20, 27648
    buffer_load_dwordx4 v1, s[24:27], s22 offen lds
    s_add_u32 m0, s21, 9360
    s_add_u32 s22, s20, 28800
    buffer_load_dwordx4 v1, s[24:27], s22 offen lds
    s_add_u32 m0, s21, 10400
    s_add_u32 s22, s20, 29952
    buffer_load_dwordx4 v1, s[24:27], s22 offen lds
    s_add_u32 m0, s21, 11440
    s_add_u32 s22, s20, 31104
    buffer_load_dwordx4 v1, s[24:27], s22 offen lds
    s_add_u32 m0, s21, 12480
    s_add_u32 s22, s20, 32256
    buffer_load_dwordx4 v1, s[24:27], s22 offen lds
    s_add_u32 m0, s21, 13520
    s_add_u32 s22, s20, 33408
    buffer_load_dwordx4 v1, s[24:27], s22 offen lds
    s_add_u32 m0, s21, 14560
    s_add_u32 s22, s20, 34560
    buffer_load_dwordx4 v1, s[24:27], s22 offen lds
    s_add_u32 m0, s21, 15600
    s_add_u32 s22, s20, 35712
    buffer_load_dwordx4 v1, s[24:27], s22 offen lds
    s_add_u32 m0, s21, 16640
    s_add_u32 s22, s20, 18432
    buffer_load_dwordx4 v4, s[24:27], s22 offen lds
    s_add_u32 m0, s21, 17664
    s_add_u32 s22, s20, 27648
    buffer_load_dwordx4 v4, s[24:27], s22 offen lds
    v_mov_b32 v36, s28
    v_mov_b32 v37, s28
    v_mov_b32 v38, s28
    v_mov_b32 v39, s28
    s_nop 1
    v_mfma_f32_16x16x32_bf16 v[16:19], v[36:39], v[112:115], 0
    v_mfma_f32_16x16x32_bf16 v[20:23], v[112:115], v[112:115], 0
    v_mfma_f32_16x16x32_bf16 v[16:19], v[36:39], v[116:119], v[16:19]
    v_mfma_f32_16x16x32_bf16 v[20:23], v[116:119], v[116:119], v[20:23]
    v_mfma_f32_16x16x32_bf16 v[16:19], v[36:39], v[120:123], v[16:19]
    v_mfma_f32_16x16x32_bf16 v[20:23], v[120:123], v[120:123], v[20:23]
    v_mfma_f32_16x16x32_bf16 v[16:19], v[36:39], v[124:127], v[16:19]
    v_mfma_f32_16x16x32_bf16 v[20:23], v[124:127], v[124:127], v[20:23]
    v_mfma_f32_16x16x32_bf16 v[16:19], v[36:39], v[128:131], v[16:19]
    v_mfma_f32_16x16x32_bf16 v[20:23], v[128:131], v[128:131], v[20:23]
    v_mfma_f32_16x16x32_bf16 v[16:19], v[36:39], v[132:135], v[16:19]
    v_mfma_f32_16x16x32_bf16 v[20:23], v[132:135], v[132:135], v[20:23]
    v_mfma_f32_16x16x32_bf16 v[16:19], v[36:39], v[136:139], v[16:19]
    v_mfma_f32_16x16x32_bf16 v[20:23], v[136:139], v[136:139], v[20:23]
    v_mfma_f32_16x16x32_bf16 v[16:19], v[36:39], v[140:143], v[16:19]
    v_mfma_f32_16x16x32_bf16 v[20:23], v[140:143], v[140:143], v[20:23]
    v_mfma_f32_16x16x32_bf16 v[16:19], v[36:39], v[144:147], v[16:19]
    v_mfma_f32_16x16x32_bf16 v[20:23], v[144:147], v[144:147], v[20:23]
    v_mfma_f32_16x16x32_bf16 v[16:19], v[36:39], v[148:151], v[16:19]
    v_mfma_f32_16x16x32_bf16 v[20:23], v[148:151], v[148:151], v[20:23]
    v_mfma_f32_16x16x32_bf16 v[16:19], v[36:39], v[152:155], v[16:19]
    v_mfma_f32_16x16x32_bf16 v[20:23], v[152:155], v[152:155], v[20:23]
    v_mfma_f32_16x16x32_bf16 v[16:19], v[36:39], v[156:159], v[16:19]
    v_mfma_f32_16x16x32_bf16 v[20:23], v[156:159], v[156:159], v[20:23]
    v_mfma_f32_16x16x32_bf16 v[16:19], v[36:39], v[160:163], v[16:19]
    v_mfma_f32_16x16x32_bf16 v[20:23], v[160:163], v[160:163], v[20:23]
    v_mfma_f32_16x16x32_bf16 v[16:19], v[36:39], v[164:167], v[16:19]
    v_mfma_f32_16x16x32_bf16 v[20:23], v[164:167], v[164:167], v[20:23]
    v_mfma_f32_16x16x32_bf16 v[16:19], v[36:39], v[168:171], v[16:19]
    v_mfma_f32_16x16x32_bf16 v[20:23], v[168:171], v[168:171], v[20:23]
    v_mfma_f32_16x16x32_bf16 v[16:19], v[36:39], v[172:175], v[16:19]
    v_mfma_f32_16x16x32_bf16 v[20:23], v[172:175], v[172:175], v[20:23]
    v_mfma_f32_16x16x32_bf16 v[16:19], v[36:39], v[176:179], v[16:19]
    v_mfma_f32_16x16x32_bf16 v[20:23], v[176:179], v[176:179], v[20:23]
    v_mfma_f32_16x16x32_bf16 v[16:19], v[36:39], v[180:183], v[16:19]
    v_mfma_f32_16x16x32_bf16 v[20:23], v[180:183], v[180:183], v[20:23]
    v_and_b32 v28, 3, v6
    v_lshrrev_b32 v29, 2, v6
    s_nop 4
    v_cmp_eq_u32 vcc, 1, v28
    s_nop 1
    v_cndmask_b32 v20, v20, v21, vcc
    v_cmp_eq_u32 vcc, 2, v28
    s_nop 1
    v_cndmask_b32 v20, v20, v22, vcc
    v_cmp_eq_u32 vcc, 3, v28
    s_nop 1
    v_cndmask_b32 v20, v20, v23, vcc
    v_cmp_eq_u32 vcc, v29, v7
    s_nop 1
    v_cndmask_b32 v20, 0, v20, vcc
    v_mov_b32 v21, v20
    s_nop 1
    v_permlane32_swap_b32 v20, v21
    s_nop 1
    v_add_f32 v20, v20, v21
    v_mov_b32 v21, v20
    s_nop 1
    v_permlane16_swap_b32 v20, v21
    s_nop 1
    v_add_f32 v20, v20, v21
    v_mul_f32 v24, 0x3ae38e39, v16
    v_mul_f32 v20, 0x3ae38e39, v20
    v_fma_f32 v20, -v24, v24, v20
    v_max_f32 v20, 0, v20
    v_add_f32 v20, 0x3727c5ac, v20
    v_rsq_f32 v26, v20
    s_nop 0
    v_mul_f32 v27, v24, v26
    v_sub_f32 v27, 0, v27
    v_lshlrev_b32 v28, 16, v112
    v_and_b32 v29, s29, v112
    v_fma_f32 v28, v28, v26, v27
    v_fma_f32 v29, v29, v26, v27
    v_cvt_pk_bf16_f32 v112, v28, v29
    v_lshlrev_b32 v30, 16, v113
    v_and_b32 v31, s29, v113
    v_fma_f32 v30, v30, v26, v27
    v_fma_f32 v31, v31, v26, v27
    v_cvt_pk_bf16_f32 v113, v30, v31
    v_lshlrev_b32 v32, 16, v114
    v_and_b32 v33, s29, v114
    v_fma_f32 v32, v32, v26, v27
    v_fma_f32 v33, v33, v26, v27
    v_cvt_pk_bf16_f32 v114, v32, v33
    v_lshlrev_b32 v34, 16, v115
    v_and_b32 v35, s29, v115
    v_fma_f32 v34, v34, v26, v27
    v_fma_f32 v35, v35, v26, v27
    v_cvt_pk_bf16_f32 v115, v34, v35
    v_lshlrev_b32 v28, 16, v116
    v_and_b32 v29, s29, v116
    v_fma_f32 v28, v28, v26, v27
    v_fma_f32 v29, v29, v26, v27
    v_cvt_pk_bf16_f32 v116, v28, v29
    v_lshlrev_b32 v30, 16, v117
    v_and_b32 v31, s29, v117
    v_fma_f32 v30, v30, v26, v27
    v_fma_f32 v31, v31, v26, v27
    v_cvt_pk_bf16_f32 v117, v30, v31
    v_lshlrev_b32 v32, 16, v118
    v_and_b32 v33, s29, v118
    v_fma_f32 v32, v32, v26, v27
    v_fma_f32 v33, v33, v26, v27
    v_cvt_pk_bf16_f32 v118, v32, v33
    v_lshlrev_b32 v34, 16, v119
    v_and_b32 v35, s29, v119
    v_fma_f32 v34, v34, v26, v27
    v_fma_f32 v35, v35, v26, v27
    v_cvt_pk_bf16_f32 v119, v34, v35
    v_lshlrev_b32 v28, 16, v120
    v_and_b32 v29, s29, v120
    v_fma_f32 v28, v28, v26, v27
    v_fma_f32 v29, v29, v26, v27
    v_cvt_pk_bf16_f32 v120, v28, v29
    v_lshlrev_b32 v30, 16, v121
    v_and_b32 v31, s29, v121
    v_fma_f32 v30, v30, v26, v27
    v_fma_f32 v31, v31, v26, v27
    v_cvt_pk_bf16_f32 v121, v30, v31
    v_lshlrev_b32 v32, 16, v122
    v_and_b32 v33, s29, v122
    v_fma_f32 v32, v32, v26, v27
    v_fma_f32 v33, v33, v26, v27
    v_cvt_pk_bf16_f32 v122, v32, v33
    v_lshlrev_b32 v34, 16, v123
    v_and_b32 v35, s29, v123
    v_fma_f32 v34, v34, v26, v27
    v_fma_f32 v35, v35, v26, v27
    v_cvt_pk_bf16_f32 v123, v34, v35
    v_lshlrev_b32 v28, 16, v124
    v_and_b32 v29, s29, v124
    v_fma_f32 v28, v28, v26, v27
    v_fma_f32 v29, v29, v26, v27
    v_cvt_pk_bf16_f32 v124, v28, v29
    v_lshlrev_b32 v30, 16, v125
    v_and_b32 v31, s29, v125
    v_fma_f32 v30, v30, v26, v27
    v_fma_f32 v31, v31, v26, v27
    v_cvt_pk_bf16_f32 v125, v30, v31
    v_lshlrev_b32 v32, 16, v126
    v_and_b32 v33, s29, v126
    v_fma_f32 v32, v32, v26, v27
    v_fma_f32 v33, v33, v26, v27
    v_cvt_pk_bf16_f32 v126, v32, v33
    v_lshlrev_b32 v34, 16, v127
    v_and_b32 v35, s29, v127
    v_fma_f32 v34, v34, v26, v27
    v_fma_f32 v35, v35, v26, v27
    v_cvt_pk_bf16_f32 v127, v34, v35
    v_lshlrev_b32 v28, 16, v128
    v_and_b32 v29, s29, v128
    v_fma_f32 v28, v28, v26, v27
    v_fma_f32 v29, v29, v26, v27
    v_cvt_pk_bf16_f32 v128, v28, v29
    v_lshlrev_b32 v30, 16, v129
    v_and_b32 v31, s29, v129
    v_fma_f32 v30, v30, v26, v27
    v_fma_f32 v31, v31, v26, v27
    v_cvt_pk_bf16_f32 v129, v30, v31
    v_lshlrev_b32 v32, 16, v130
    v_and_b32 v33, s29, v130
    v_fma_f32 v32, v32, v26, v27
    v_fma_f32 v33, v33, v26, v27
    v_cvt_pk_bf16_f32 v130, v32, v33
    v_lshlrev_b32 v34, 16, v131
    v_and_b32 v35, s29, v131
    v_fma_f32 v34, v34, v26, v27
    v_fma_f32 v35, v35, v26, v27
    v_cvt_pk_bf16_f32 v131, v34, v35
    v_lshlrev_b32 v28, 16, v132
    v_and_b32 v29, s29, v132
    v_fma_f32 v28, v28, v26, v27
    v_fma_f32 v29, v29, v26, v27
    v_cvt_pk_bf16_f32 v132, v28, v29
    v_lshlrev_b32 v30, 16, v133
    v_and_b32 v31, s29, v133
    v_fma_f32 v30, v30, v26, v27
    v_fma_f32 v31, v31, v26, v27
    v_cvt_pk_bf16_f32 v133, v30, v31
    v_lshlrev_b32 v32, 16, v134
    v_and_b32 v33, s29, v134
    v_fma_f32 v32, v32, v26, v27
    v_fma_f32 v33, v33, v26, v27
    v_cvt_pk_bf16_f32 v134, v32, v33
    v_lshlrev_b32 v34, 16, v135
    v_and_b32 v35, s29, v135
    v_fma_f32 v34, v34, v26, v27
    v_fma_f32 v35, v35, v26, v27
    v_cvt_pk_bf16_f32 v135, v34, v35
    v_lshlrev_b32 v28, 16, v136
    v_and_b32 v29, s29, v136
    v_fma_f32 v28, v28, v26, v27
    v_fma_f32 v29, v29, v26, v27
    v_cvt_pk_bf16_f32 v136, v28, v29
    v_lshlrev_b32 v30, 16, v137
    v_and_b32 v31, s29, v137
    v_fma_f32 v30, v30, v26, v27
    v_fma_f32 v31, v31, v26, v27
    v_cvt_pk_bf16_f32 v137, v30, v31
    v_lshlrev_b32 v32, 16, v138
    v_and_b32 v33, s29, v138
    v_fma_f32 v32, v32, v26, v27
    v_fma_f32 v33, v33, v26, v27
    v_cvt_pk_bf16_f32 v138, v32, v33
    v_lshlrev_b32 v34, 16, v139
    v_and_b32 v35, s29, v139
    v_fma_f32 v34, v34, v26, v27
    v_fma_f32 v35, v35, v26, v27
    v_cvt_pk_bf16_f32 v139, v34, v35
    v_lshlrev_b32 v28, 16, v140
    v_and_b32 v29, s29, v140
    v_fma_f32 v28, v28, v26, v27
    v_fma_f32 v29, v29, v26, v27
    v_cvt_pk_bf16_f32 v140, v28, v29
    v_lshlrev_b32 v30, 16, v141
    v_and_b32 v31, s29, v141
    v_fma_f32 v30, v30, v26, v27
    v_fma_f32 v31, v31, v26, v27
    v_cvt_pk_bf16_f32 v141, v30, v31
    v_lshlrev_b32 v32, 16, v142
    v_and_b32 v33, s29, v142
    v_fma_f32 v32, v32, v26, v27
    v_fma_f32 v33, v33, v26, v27
    v_cvt_pk_bf16_f32 v142, v32, v33
    v_lshlrev_b32 v34, 16, v143
    v_and_b32 v35, s29, v143
    v_fma_f32 v34, v34, v26, v27
    v_fma_f32 v35, v35, v26, v27
    v_cvt_pk_bf16_f32 v143, v34, v35
    v_lshlrev_b32 v28, 16, v144
    v_and_b32 v29, s29, v144
    v_fma_f32 v28, v28, v26, v27
    v_fma_f32 v29, v29, v26, v27
    v_cvt_pk_bf16_f32 v144, v28, v29
    v_lshlrev_b32 v30, 16, v145
    v_and_b32 v31, s29, v145
    v_fma_f32 v30, v30, v26, v27
    v_fma_f32 v31, v31, v26, v27
    v_cvt_pk_bf16_f32 v145, v30, v31
    v_lshlrev_b32 v32, 16, v146
    v_and_b32 v33, s29, v146
    v_fma_f32 v32, v32, v26, v27
    v_fma_f32 v33, v33, v26, v27
    v_cvt_pk_bf16_f32 v146, v32, v33
    v_lshlrev_b32 v34, 16, v147
    v_and_b32 v35, s29, v147
    v_fma_f32 v34, v34, v26, v27
    v_fma_f32 v35, v35, v26, v27
    v_cvt_pk_bf16_f32 v147, v34, v35
    v_lshlrev_b32 v28, 16, v148
    v_and_b32 v29, s29, v148
    v_fma_f32 v28, v28, v26, v27
    v_fma_f32 v29, v29, v26, v27
    v_cvt_pk_bf16_f32 v148, v28, v29
    v_lshlrev_b32 v30, 16, v149
    v_and_b32 v31, s29, v149
    v_fma_f32 v30, v30, v26, v27
    v_fma_f32 v31, v31, v26, v27
    v_cvt_pk_bf16_f32 v149, v30, v31
    v_lshlrev_b32 v32, 16, v150
    v_and_b32 v33, s29, v150
    v_fma_f32 v32, v32, v26, v27
    v_fma_f32 v33, v33, v26, v27
    v_cvt_pk_bf16_f32 v150, v32, v33
    v_lshlrev_b32 v34, 16, v151
    v_and_b32 v35, s29, v151
    v_fma_f32 v34, v34, v26, v27
    v_fma_f32 v35, v35, v26, v27
    v_cvt_pk_bf16_f32 v151, v34, v35
    v_lshlrev_b32 v28, 16, v152
    v_and_b32 v29, s29, v152
    v_fma_f32 v28, v28, v26, v27
    v_fma_f32 v29, v29, v26, v27
    v_cvt_pk_bf16_f32 v152, v28, v29
    v_lshlrev_b32 v30, 16, v153
    v_and_b32 v31, s29, v153
    v_fma_f32 v30, v30, v26, v27
    v_fma_f32 v31, v31, v26, v27
    v_cvt_pk_bf16_f32 v153, v30, v31
    v_lshlrev_b32 v32, 16, v154
    v_and_b32 v33, s29, v154
    v_fma_f32 v32, v32, v26, v27
    v_fma_f32 v33, v33, v26, v27
    v_cvt_pk_bf16_f32 v154, v32, v33
    v_lshlrev_b32 v34, 16, v155
    v_and_b32 v35, s29, v155
    v_fma_f32 v34, v34, v26, v27
    v_fma_f32 v35, v35, v26, v27
    v_cvt_pk_bf16_f32 v155, v34, v35
    v_lshlrev_b32 v28, 16, v156
    v_and_b32 v29, s29, v156
    v_fma_f32 v28, v28, v26, v27
    v_fma_f32 v29, v29, v26, v27
    v_cvt_pk_bf16_f32 v156, v28, v29
    v_lshlrev_b32 v30, 16, v157
    v_and_b32 v31, s29, v157
    v_fma_f32 v30, v30, v26, v27
    v_fma_f32 v31, v31, v26, v27
    v_cvt_pk_bf16_f32 v157, v30, v31
    v_lshlrev_b32 v32, 16, v158
    v_and_b32 v33, s29, v158
    v_fma_f32 v32, v32, v26, v27
    v_fma_f32 v33, v33, v26, v27
    v_cvt_pk_bf16_f32 v158, v32, v33
    v_lshlrev_b32 v34, 16, v159
    v_and_b32 v35, s29, v159
    v_fma_f32 v34, v34, v26, v27
    v_fma_f32 v35, v35, v26, v27
    v_cvt_pk_bf16_f32 v159, v34, v35
    v_lshlrev_b32 v28, 16, v160
    v_and_b32 v29, s29, v160
    v_fma_f32 v28, v28, v26, v27
    v_fma_f32 v29, v29, v26, v27
    v_cvt_pk_bf16_f32 v160, v28, v29
    v_lshlrev_b32 v30, 16, v161
    v_and_b32 v31, s29, v161
    v_fma_f32 v30, v30, v26, v27
    v_fma_f32 v31, v31, v26, v27
    v_cvt_pk_bf16_f32 v161, v30, v31
    v_lshlrev_b32 v32, 16, v162
    v_and_b32 v33, s29, v162
    v_fma_f32 v32, v32, v26, v27
    v_fma_f32 v33, v33, v26, v27
    v_cvt_pk_bf16_f32 v162, v32, v33
    v_lshlrev_b32 v34, 16, v163
    v_and_b32 v35, s29, v163
    v_fma_f32 v34, v34, v26, v27
    v_fma_f32 v35, v35, v26, v27
    v_cvt_pk_bf16_f32 v163, v34, v35
    v_lshlrev_b32 v28, 16, v164
    v_and_b32 v29, s29, v164
    v_fma_f32 v28, v28, v26, v27
    v_fma_f32 v29, v29, v26, v27
    v_cvt_pk_bf16_f32 v164, v28, v29
    v_lshlrev_b32 v30, 16, v165
    v_and_b32 v31, s29, v165
    v_fma_f32 v30, v30, v26, v27
    v_fma_f32 v31, v31, v26, v27
    v_cvt_pk_bf16_f32 v165, v30, v31
    v_lshlrev_b32 v32, 16, v166
    v_and_b32 v33, s29, v166
    v_fma_f32 v32, v32, v26, v27
    v_fma_f32 v33, v33, v26, v27
    v_cvt_pk_bf16_f32 v166, v32, v33
    v_lshlrev_b32 v34, 16, v167
    v_and_b32 v35, s29, v167
    v_fma_f32 v34, v34, v26, v27
    v_fma_f32 v35, v35, v26, v27
    v_cvt_pk_bf16_f32 v167, v34, v35
    v_lshlrev_b32 v28, 16, v168
    v_and_b32 v29, s29, v168
    v_fma_f32 v28, v28, v26, v27
    v_fma_f32 v29, v29, v26, v27
    v_cvt_pk_bf16_f32 v168, v28, v29
    v_lshlrev_b32 v30, 16, v169
    v_and_b32 v31, s29, v169
    v_fma_f32 v30, v30, v26, v27
    v_fma_f32 v31, v31, v26, v27
    v_cvt_pk_bf16_f32 v169, v30, v31
    v_lshlrev_b32 v32, 16, v170
    v_and_b32 v33, s29, v170
    v_fma_f32 v32, v32, v26, v27
    v_fma_f32 v33, v33, v26, v27
    v_cvt_pk_bf16_f32 v170, v32, v33
    v_lshlrev_b32 v34, 16, v171
    v_and_b32 v35, s29, v171
    v_fma_f32 v34, v34, v26, v27
    v_fma_f32 v35, v35, v26, v27
    v_cvt_pk_bf16_f32 v171, v34, v35
    v_lshlrev_b32 v28, 16, v172
    v_and_b32 v29, s29, v172
    v_fma_f32 v28, v28, v26, v27
    v_fma_f32 v29, v29, v26, v27
    v_cvt_pk_bf16_f32 v172, v28, v29
    v_lshlrev_b32 v30, 16, v173
    v_and_b32 v31, s29, v173
    v_fma_f32 v30, v30, v26, v27
    v_fma_f32 v31, v31, v26, v27
    v_cvt_pk_bf16_f32 v173, v30, v31
    v_lshlrev_b32 v32, 16, v174
    v_and_b32 v33, s29, v174
    v_fma_f32 v32, v32, v26, v27
    v_fma_f32 v33, v33, v26, v27
    v_cvt_pk_bf16_f32 v174, v32, v33
    v_lshlrev_b32 v34, 16, v175
    v_and_b32 v35, s29, v175
    v_fma_f32 v34, v34, v26, v27
    v_fma_f32 v35, v35, v26, v27
    v_cvt_pk_bf16_f32 v175, v34, v35
    v_lshlrev_b32 v28, 16, v176
    v_and_b32 v29, s29, v176
    v_fma_f32 v28, v28, v26, v27
    v_fma_f32 v29, v29, v26, v27
    v_cvt_pk_bf16_f32 v176, v28, v29
    v_lshlrev_b32 v30, 16, v177
    v_and_b32 v31, s29, v177
    v_fma_f32 v30, v30, v26, v27
    v_fma_f32 v31, v31, v26, v27
    v_cvt_pk_bf16_f32 v177, v30, v31
    v_lshlrev_b32 v32, 16, v178
    v_and_b32 v33, s29, v178
    v_fma_f32 v32, v32, v26, v27
    v_fma_f32 v33, v33, v26, v27
    v_cvt_pk_bf16_f32 v178, v32, v33
    v_lshlrev_b32 v34, 16, v179
    v_and_b32 v35, s29, v179
    v_fma_f32 v34, v34, v26, v27
    v_fma_f32 v35, v35, v26, v27
    v_cvt_pk_bf16_f32 v179, v34, v35
    v_lshlrev_b32 v28, 16, v180
    v_and_b32 v29, s29, v180
    v_fma_f32 v28, v28, v26, v27
    v_fma_f32 v29, v29, v26, v27
    v_cvt_pk_bf16_f32 v180, v28, v29
    v_lshlrev_b32 v30, 16, v181
    v_and_b32 v31, s29, v181
    v_fma_f32 v30, v30, v26, v27
    v_fma_f32 v31, v31, v26, v27
    v_cvt_pk_bf16_f32 v181, v30, v31
    v_lshlrev_b32 v32, 16, v182
    v_and_b32 v33, s29, v182
    v_fma_f32 v32, v32, v26, v27
    v_fma_f32 v33, v33, v26, v27
    v_cvt_pk_bf16_f32 v182, v32, v33
    v_lshlrev_b32 v34, 16, v183
    v_and_b32 v35, s29, v183
    v_fma_f32 v34, v34, v26, v27
    v_fma_f32 v35, v35, v26, v27
    v_cvt_pk_bf16_f32 v183, v34, v35
    s_waitcnt vmcnt(0)
    ds_read_b128 v[184:187], v8 offset:0
    ds_read_b128 v[188:191], v8 offset:64
    ds_read_b128 v[192:195], v8 offset:128
    ds_read_b128 v[196:199], v8 offset:192
    ds_read_b128 v[200:203], v8 offset:256
    ds_read_b128 v[204:207], v8 offset:320
    ds_read_b128 v[208:211], v8 offset:384
    ds_read_b128 v[212:215], v8 offset:448
    ds_read_b128 v[216:219], v8 offset:512
    ds_read_b128 v[220:223], v8 offset:576
    ds_read_b128 v[224:227], v8 offset:640
    ds_read_b128 v[228:231], v8 offset:704
    s_waitcnt lgkmcnt(4)
    ds_read_b128 v[232:235], v8 offset:768
    ds_read_b128 v[236:239], v8 offset:832
    ds_read_b128 v[240:243], v8 offset:896
    ds_read_b128 v[244:247], v8 offset:960
    ds_read_b128 v[248:251], v10 offset:0
    ds_read_b128 v[252:255], v10 offset:64
    s_waitcnt lgkmcnt(0)
    v_mov_b32 v36, s28
    v_mov_b32 v37, s28
    v_mov_b32 v38, s28
    v_mov_b32 v39, s28
    s_nop 1
    v_mfma_f32_16x16x32_bf16 v[16:19], v[36:39], v[184:187], 0
    v_mfma_f32_16x16x32_bf16 v[20:23], v[184:187], v[184:187], 0
    v_mfma_f32_16x16x32_bf16 v[16:19], v[36:39], v[188:191], v[16:19]
    v_mfma_f32_16x16x32_bf16 v[20:23], v[188:191], v[188:191], v[20:23]
    v_mfma_f32_16x16x32_bf16 v[16:19], v[36:39], v[192:195], v[16:19]
    v_mfma_f32_16x16x32_bf16 v[20:23], v[192:195], v[192:195], v[20:23]
    v_mfma_f32_16x16x32_bf16 v[16:19], v[36:39], v[196:199], v[16:19]
    v_mfma_f32_16x16x32_bf16 v[20:23], v[196:199], v[196:199], v[20:23]
    v_mfma_f32_16x16x32_bf16 v[16:19], v[36:39], v[200:203], v[16:19]
    v_mfma_f32_16x16x32_bf16 v[20:23], v[200:203], v[200:203], v[20:23]
    v_mfma_f32_16x16x32_bf16 v[16:19], v[36:39], v[204:207], v[16:19]
    v_mfma_f32_16x16x32_bf16 v[20:23], v[204:207], v[204:207], v[20:23]
    v_mfma_f32_16x16x32_bf16 v[16:19], v[36:39], v[208:211], v[16:19]
    v_mfma_f32_16x16x32_bf16 v[20:23], v[208:211], v[208:211], v[20:23]
    v_mfma_f32_16x16x32_bf16 v[16:19], v[36:39], v[212:215], v[16:19]
    v_mfma_f32_16x16x32_bf16 v[20:23], v[212:215], v[212:215], v[20:23]
    v_mfma_f32_16x16x32_bf16 v[16:19], v[36:39], v[216:219], v[16:19]
    v_mfma_f32_16x16x32_bf16 v[20:23], v[216:219], v[216:219], v[20:23]
    v_mfma_f32_16x16x32_bf16 v[16:19], v[36:39], v[220:223], v[16:19]
    v_mfma_f32_16x16x32_bf16 v[20:23], v[220:223], v[220:223], v[20:23]
    v_mfma_f32_16x16x32_bf16 v[16:19], v[36:39], v[224:227], v[16:19]
    v_mfma_f32_16x16x32_bf16 v[20:23], v[224:227], v[224:227], v[20:23]
    v_mfma_f32_16x16x32_bf16 v[16:19], v[36:39], v[228:231], v[16:19]
    v_mfma_f32_16x16x32_bf16 v[20:23], v[228:231], v[228:231], v[20:23]
    v_mfma_f32_16x16x32_bf16 v[16:19], v[36:39], v[232:235], v[16:19]
    v_mfma_f32_16x16x32_bf16 v[20:23], v[232:235], v[232:235], v[20:23]
    v_mfma_f32_16x16x32_bf16 v[16:19], v[36:39], v[236:239], v[16:19]
    v_mfma_f32_16x16x32_bf16 v[20:23], v[236:239], v[236:239], v[20:23]
    v_mfma_f32_16x16x32_bf16 v[16:19], v[36:39], v[240:243], v[16:19]
    v_mfma_f32_16x16x32_bf16 v[20:23], v[240:243], v[240:243], v[20:23]
    v_mfma_f32_16x16x32_bf16 v[16:19], v[36:39], v[244:247], v[16:19]
    v_mfma_f32_16x16x32_bf16 v[20:23], v[244:247], v[244:247], v[20:23]
    v_mfma_f32_16x16x32_bf16 v[16:19], v[36:39], v[248:251], v[16:19]
    v_mfma_f32_16x16x32_bf16 v[20:23], v[248:251], v[248:251], v[20:23]
    v_mfma_f32_16x16x32_bf16 v[16:19], v[36:39], v[252:255], v[16:19]
    v_mfma_f32_16x16x32_bf16 v[20:23], v[252:255], v[252:255], v[20:23]
    v_and_b32 v28, 3, v6
    v_lshrrev_b32 v29, 2, v6
    s_nop 4
    v_cmp_eq_u32 vcc, 1, v28
    s_nop 1
    v_cndmask_b32 v20, v20, v21, vcc
    v_cmp_eq_u32 vcc, 2, v28
    s_nop 1
    v_cndmask_b32 v20, v20, v22, vcc
    v_cmp_eq_u32 vcc, 3, v28
    s_nop 1
    v_cndmask_b32 v20, v20, v23, vcc
    v_cmp_eq_u32 vcc, v29, v7
    s_nop 1
    v_cndmask_b32 v20, 0, v20, vcc
    v_mov_b32 v21, v20
    s_nop 1
    v_permlane32_swap_b32 v20, v21
    s_nop 1
    v_add_f32 v20, v20, v21
    v_mov_b32 v21, v20
    s_nop 1
    v_permlane16_swap_b32 v20, v21
    s_nop 1
    v_add_f32 v20, v20, v21
    v_mul_f32 v25, 0x3ae38e39, v16
    v_mul_f32 v20, 0x3ae38e39, v20
    v_fma_f32 v20, -v25, v25, v20
    v_max_f32 v20, 0, v20
    v_add_f32 v20, 0x3727c5ac, v20
    v_rsq_f32 v26, v20
    s_nop 0
    v_mul_f32 v27, v25, v26
    v_sub_f32 v27, 0, v27
    v_lshlrev_b32 v28, 16, v184
    v_and_b32 v29, s29, v184
    v_fma_f32 v28, v28, v26, v27
    v_fma_f32 v29, v29, v26, v27
    v_cvt_pk_bf16_f32 v184, v28, v29
    v_lshlrev_b32 v30, 16, v185
    v_and_b32 v31, s29, v185
    v_fma_f32 v30, v30, v26, v27
    v_fma_f32 v31, v31, v26, v27
    v_cvt_pk_bf16_f32 v185, v30, v31
    v_lshlrev_b32 v32, 16, v186
    v_and_b32 v33, s29, v186
    v_fma_f32 v32, v32, v26, v27
    v_fma_f32 v33, v33, v26, v27
    v_cvt_pk_bf16_f32 v186, v32, v33
    v_lshlrev_b32 v34, 16, v187
    v_and_b32 v35, s29, v187
    v_fma_f32 v34, v34, v26, v27
    v_fma_f32 v35, v35, v26, v27
    v_cvt_pk_bf16_f32 v187, v34, v35
    v_lshlrev_b32 v28, 16, v188
    v_and_b32 v29, s29, v188
    v_fma_f32 v28, v28, v26, v27
    v_fma_f32 v29, v29, v26, v27
    v_cvt_pk_bf16_f32 v188, v28, v29
    v_lshlrev_b32 v30, 16, v189
    v_and_b32 v31, s29, v189
    v_fma_f32 v30, v30, v26, v27
    v_fma_f32 v31, v31, v26, v27
    v_cvt_pk_bf16_f32 v189, v30, v31
    v_lshlrev_b32 v32, 16, v190
    v_and_b32 v33, s29, v190
    v_fma_f32 v32, v32, v26, v27
    v_fma_f32 v33, v33, v26, v27
    v_cvt_pk_bf16_f32 v190, v32, v33
    v_lshlrev_b32 v34, 16, v191
    v_and_b32 v35, s29, v191
    v_fma_f32 v34, v34, v26, v27
    v_fma_f32 v35, v35, v26, v27
    v_cvt_pk_bf16_f32 v191, v34, v35
    v_lshlrev_b32 v28, 16, v192
    v_and_b32 v29, s29, v192
    v_fma_f32 v28, v28, v26, v27
    v_fma_f32 v29, v29, v26, v27
    v_cvt_pk_bf16_f32 v192, v28, v29
    v_lshlrev_b32 v30, 16, v193
    v_and_b32 v31, s29, v193
    v_fma_f32 v30, v30, v26, v27
    v_fma_f32 v31, v31, v26, v27
    v_cvt_pk_bf16_f32 v193, v30, v31
    v_lshlrev_b32 v32, 16, v194
    v_and_b32 v33, s29, v194
    v_fma_f32 v32, v32, v26, v27
    v_fma_f32 v33, v33, v26, v27
    v_cvt_pk_bf16_f32 v194, v32, v33
    v_lshlrev_b32 v34, 16, v195
    v_and_b32 v35, s29, v195
    v_fma_f32 v34, v34, v26, v27
    v_fma_f32 v35, v35, v26, v27
    v_cvt_pk_bf16_f32 v195, v34, v35
    v_lshlrev_b32 v28, 16, v196
    v_and_b32 v29, s29, v196
    v_fma_f32 v28, v28, v26, v27
    v_fma_f32 v29, v29, v26, v27
    v_cvt_pk_bf16_f32 v196, v28, v29
    v_lshlrev_b32 v30, 16, v197
    v_and_b32 v31, s29, v197
    v_fma_f32 v30, v30, v26, v27
    v_fma_f32 v31, v31, v26, v27
    v_cvt_pk_bf16_f32 v197, v30, v31
    v_lshlrev_b32 v32, 16, v198
    v_and_b32 v33, s29, v198
    v_fma_f32 v32, v32, v26, v27
    v_fma_f32 v33, v33, v26, v27
    v_cvt_pk_bf16_f32 v198, v32, v33
    v_lshlrev_b32 v34, 16, v199
    v_and_b32 v35, s29, v199
    v_fma_f32 v34, v34, v26, v27
    v_fma_f32 v35, v35, v26, v27
    v_cvt_pk_bf16_f32 v199, v34, v35
    v_lshlrev_b32 v28, 16, v200
    v_and_b32 v29, s29, v200
    v_fma_f32 v28, v28, v26, v27
    v_fma_f32 v29, v29, v26, v27
    v_cvt_pk_bf16_f32 v200, v28, v29
    v_lshlrev_b32 v30, 16, v201
    v_and_b32 v31, s29, v201
    v_fma_f32 v30, v30, v26, v27
    v_fma_f32 v31, v31, v26, v27
    v_cvt_pk_bf16_f32 v201, v30, v31
    v_lshlrev_b32 v32, 16, v202
    v_and_b32 v33, s29, v202
    v_fma_f32 v32, v32, v26, v27
    v_fma_f32 v33, v33, v26, v27
    v_cvt_pk_bf16_f32 v202, v32, v33
    v_lshlrev_b32 v34, 16, v203
    v_and_b32 v35, s29, v203
    v_fma_f32 v34, v34, v26, v27
    v_fma_f32 v35, v35, v26, v27
    v_cvt_pk_bf16_f32 v203, v34, v35
    v_lshlrev_b32 v28, 16, v204
    v_and_b32 v29, s29, v204
    v_fma_f32 v28, v28, v26, v27
    v_fma_f32 v29, v29, v26, v27
    v_cvt_pk_bf16_f32 v204, v28, v29
    v_lshlrev_b32 v30, 16, v205
    v_and_b32 v31, s29, v205
    v_fma_f32 v30, v30, v26, v27
    v_fma_f32 v31, v31, v26, v27
    v_cvt_pk_bf16_f32 v205, v30, v31
    v_lshlrev_b32 v32, 16, v206
    v_and_b32 v33, s29, v206
    v_fma_f32 v32, v32, v26, v27
    v_fma_f32 v33, v33, v26, v27
    v_cvt_pk_bf16_f32 v206, v32, v33
    v_lshlrev_b32 v34, 16, v207
    v_and_b32 v35, s29, v207
    v_fma_f32 v34, v34, v26, v27
    v_fma_f32 v35, v35, v26, v27
    v_cvt_pk_bf16_f32 v207, v34, v35
    v_lshlrev_b32 v28, 16, v208
    v_and_b32 v29, s29, v208
    v_fma_f32 v28, v28, v26, v27
    v_fma_f32 v29, v29, v26, v27
    v_cvt_pk_bf16_f32 v208, v28, v29
    v_lshlrev_b32 v30, 16, v209
    v_and_b32 v31, s29, v209
    v_fma_f32 v30, v30, v26, v27
    v_fma_f32 v31, v31, v26, v27
    v_cvt_pk_bf16_f32 v209, v30, v31
    v_lshlrev_b32 v32, 16, v210
    v_and_b32 v33, s29, v210
    v_fma_f32 v32, v32, v26, v27
    v_fma_f32 v33, v33, v26, v27
    v_cvt_pk_bf16_f32 v210, v32, v33
    v_lshlrev_b32 v34, 16, v211
    v_and_b32 v35, s29, v211
    v_fma_f32 v34, v34, v26, v27
    v_fma_f32 v35, v35, v26, v27
    v_cvt_pk_bf16_f32 v211, v34, v35
    v_lshlrev_b32 v28, 16, v212
    v_and_b32 v29, s29, v212
    v_fma_f32 v28, v28, v26, v27
    v_fma_f32 v29, v29, v26, v27
    v_cvt_pk_bf16_f32 v212, v28, v29
    v_lshlrev_b32 v30, 16, v213
    v_and_b32 v31, s29, v213
    v_fma_f32 v30, v30, v26, v27
    v_fma_f32 v31, v31, v26, v27
    v_cvt_pk_bf16_f32 v213, v30, v31
    v_lshlrev_b32 v32, 16, v214
    v_and_b32 v33, s29, v214
    v_fma_f32 v32, v32, v26, v27
    v_fma_f32 v33, v33, v26, v27
    v_cvt_pk_bf16_f32 v214, v32, v33
    v_lshlrev_b32 v34, 16, v215
    v_and_b32 v35, s29, v215
    v_fma_f32 v34, v34, v26, v27
    v_fma_f32 v35, v35, v26, v27
    v_cvt_pk_bf16_f32 v215, v34, v35
    v_lshlrev_b32 v28, 16, v216
    v_and_b32 v29, s29, v216
    v_fma_f32 v28, v28, v26, v27
    v_fma_f32 v29, v29, v26, v27
    v_cvt_pk_bf16_f32 v216, v28, v29
    v_lshlrev_b32 v30, 16, v217
    v_and_b32 v31, s29, v217
    v_fma_f32 v30, v30, v26, v27
    v_fma_f32 v31, v31, v26, v27
    v_cvt_pk_bf16_f32 v217, v30, v31
    v_lshlrev_b32 v32, 16, v218
    v_and_b32 v33, s29, v218
    v_fma_f32 v32, v32, v26, v27
    v_fma_f32 v33, v33, v26, v27
    v_cvt_pk_bf16_f32 v218, v32, v33
    v_lshlrev_b32 v34, 16, v219
    v_and_b32 v35, s29, v219
    v_fma_f32 v34, v34, v26, v27
    v_fma_f32 v35, v35, v26, v27
    v_cvt_pk_bf16_f32 v219, v34, v35
    v_lshlrev_b32 v28, 16, v220
    v_and_b32 v29, s29, v220
    v_fma_f32 v28, v28, v26, v27
    v_fma_f32 v29, v29, v26, v27
    v_cvt_pk_bf16_f32 v220, v28, v29
    v_lshlrev_b32 v30, 16, v221
    v_and_b32 v31, s29, v221
    v_fma_f32 v30, v30, v26, v27
    v_fma_f32 v31, v31, v26, v27
    v_cvt_pk_bf16_f32 v221, v30, v31
    v_lshlrev_b32 v32, 16, v222
    v_and_b32 v33, s29, v222
    v_fma_f32 v32, v32, v26, v27
    v_fma_f32 v33, v33, v26, v27
    v_cvt_pk_bf16_f32 v222, v32, v33
    v_lshlrev_b32 v34, 16, v223
    v_and_b32 v35, s29, v223
    v_fma_f32 v34, v34, v26, v27
    v_fma_f32 v35, v35, v26, v27
    v_cvt_pk_bf16_f32 v223, v34, v35
    v_lshlrev_b32 v28, 16, v224
    v_and_b32 v29, s29, v224
    v_fma_f32 v28, v28, v26, v27
    v_fma_f32 v29, v29, v26, v27
    v_cvt_pk_bf16_f32 v224, v28, v29
    v_lshlrev_b32 v30, 16, v225
    v_and_b32 v31, s29, v225
    v_fma_f32 v30, v30, v26, v27
    v_fma_f32 v31, v31, v26, v27
    v_cvt_pk_bf16_f32 v225, v30, v31
    v_lshlrev_b32 v32, 16, v226
    v_and_b32 v33, s29, v226
    v_fma_f32 v32, v32, v26, v27
    v_fma_f32 v33, v33, v26, v27
    v_cvt_pk_bf16_f32 v226, v32, v33
    v_lshlrev_b32 v34, 16, v227
    v_and_b32 v35, s29, v227
    v_fma_f32 v34, v34, v26, v27
    v_fma_f32 v35, v35, v26, v27
    v_cvt_pk_bf16_f32 v227, v34, v35
    v_lshlrev_b32 v28, 16, v228
    v_and_b32 v29, s29, v228
    v_fma_f32 v28, v28, v26, v27
    v_fma_f32 v29, v29, v26, v27
    v_cvt_pk_bf16_f32 v228, v28, v29
    v_lshlrev_b32 v30, 16, v229
    v_and_b32 v31, s29, v229
    v_fma_f32 v30, v30, v26, v27
    v_fma_f32 v31, v31, v26, v27
    v_cvt_pk_bf16_f32 v229, v30, v31
    v_lshlrev_b32 v32, 16, v230
    v_and_b32 v33, s29, v230
    v_fma_f32 v32, v32, v26, v27
    v_fma_f32 v33, v33, v26, v27
    v_cvt_pk_bf16_f32 v230, v32, v33
    v_lshlrev_b32 v34, 16, v231
    v_and_b32 v35, s29, v231
    v_fma_f32 v34, v34, v26, v27
    v_fma_f32 v35, v35, v26, v27
    v_cvt_pk_bf16_f32 v231, v34, v35
    v_lshlrev_b32 v28, 16, v232
    v_and_b32 v29, s29, v232
    v_fma_f32 v28, v28, v26, v27
    v_fma_f32 v29, v29, v26, v27
    v_cvt_pk_bf16_f32 v232, v28, v29
    v_lshlrev_b32 v30, 16, v233
    v_and_b32 v31, s29, v233
    v_fma_f32 v30, v30, v26, v27
    v_fma_f32 v31, v31, v26, v27
    v_cvt_pk_bf16_f32 v233, v30, v31
    v_lshlrev_b32 v32, 16, v234
    v_and_b32 v33, s29, v234
    v_fma_f32 v32, v32, v26, v27
    v_fma_f32 v33, v33, v26, v27
    v_cvt_pk_bf16_f32 v234, v32, v33
    v_lshlrev_b32 v34, 16, v235
    v_and_b32 v35, s29, v235
    v_fma_f32 v34, v34, v26, v27
    v_fma_f32 v35, v35, v26, v27
    v_cvt_pk_bf16_f32 v235, v34, v35
    v_lshlrev_b32 v28, 16, v236
    v_and_b32 v29, s29, v236
    v_fma_f32 v28, v28, v26, v27
    v_fma_f32 v29, v29, v26, v27
    v_cvt_pk_bf16_f32 v236, v28, v29
    v_lshlrev_b32 v30, 16, v237
    v_and_b32 v31, s29, v237
    v_fma_f32 v30, v30, v26, v27
    v_fma_f32 v31, v31, v26, v27
    v_cvt_pk_bf16_f32 v237, v30, v31
    v_lshlrev_b32 v32, 16, v238
    v_and_b32 v33, s29, v238
    v_fma_f32 v32, v32, v26, v27
    v_fma_f32 v33, v33, v26, v27
    v_cvt_pk_bf16_f32 v238, v32, v33
    v_lshlrev_b32 v34, 16, v239
    v_and_b32 v35, s29, v239
    v_fma_f32 v34, v34, v26, v27
    v_fma_f32 v35, v35, v26, v27
    v_cvt_pk_bf16_f32 v239, v34, v35
    v_lshlrev_b32 v28, 16, v240
    v_and_b32 v29, s29, v240
    v_fma_f32 v28, v28, v26, v27
    v_fma_f32 v29, v29, v26, v27
    v_cvt_pk_bf16_f32 v240, v28, v29
    v_lshlrev_b32 v30, 16, v241
    v_and_b32 v31, s29, v241
    v_fma_f32 v30, v30, v26, v27
    v_fma_f32 v31, v31, v26, v27
    v_cvt_pk_bf16_f32 v241, v30, v31
    v_lshlrev_b32 v32, 16, v242
    v_and_b32 v33, s29, v242
    v_fma_f32 v32, v32, v26, v27
    v_fma_f32 v33, v33, v26, v27
    v_cvt_pk_bf16_f32 v242, v32, v33
    v_lshlrev_b32 v34, 16, v243
    v_and_b32 v35, s29, v243
    v_fma_f32 v34, v34, v26, v27
    v_fma_f32 v35, v35, v26, v27
    v_cvt_pk_bf16_f32 v243, v34, v35
    v_lshlrev_b32 v28, 16, v244
    v_and_b32 v29, s29, v244
    v_fma_f32 v28, v28, v26, v27
    v_fma_f32 v29, v29, v26, v27
    v_cvt_pk_bf16_f32 v244, v28, v29
    v_lshlrev_b32 v30, 16, v245
    v_and_b32 v31, s29, v245
    v_fma_f32 v30, v30, v26, v27
    v_fma_f32 v31, v31, v26, v27
    v_cvt_pk_bf16_f32 v245, v30, v31
    v_lshlrev_b32 v32, 16, v246
    v_and_b32 v33, s29, v246
    v_fma_f32 v32, v32, v26, v27
    v_fma_f32 v33, v33, v26, v27
    v_cvt_pk_bf16_f32 v246, v32, v33
    v_lshlrev_b32 v34, 16, v247
    v_and_b32 v35, s29, v247
    v_fma_f32 v34, v34, v26, v27
    v_fma_f32 v35, v35, v26, v27
    v_cvt_pk_bf16_f32 v247, v34, v35
    v_lshlrev_b32 v28, 16, v248
    v_and_b32 v29, s29, v248
    v_fma_f32 v28, v28, v26, v27
    v_fma_f32 v29, v29, v26, v27
    v_cvt_pk_bf16_f32 v248, v28, v29
    v_lshlrev_b32 v30, 16, v249
    v_and_b32 v31, s29, v249
    v_fma_f32 v30, v30, v26, v27
    v_fma_f32 v31, v31, v26, v27
    v_cvt_pk_bf16_f32 v249, v30, v31
    v_lshlrev_b32 v32, 16, v250
    v_and_b32 v33, s29, v250
    v_fma_f32 v32, v32, v26, v27
    v_fma_f32 v33, v33, v26, v27
    v_cvt_pk_bf16_f32 v250, v32, v33
    v_lshlrev_b32 v34, 16, v251
    v_and_b32 v35, s29, v251
    v_fma_f32 v34, v34, v26, v27
    v_fma_f32 v35, v35, v26, v27
    v_cvt_pk_bf16_f32 v251, v34, v35
    v_lshlrev_b32 v28, 16, v252
    v_and_b32 v29, s29, v252
    v_fma_f32 v28, v28, v26, v27
    v_fma_f32 v29, v29, v26, v27
    v_cvt_pk_bf16_f32 v252, v28, v29
    v_lshlrev_b32 v30, 16, v253
    v_and_b32 v31, s29, v253
    v_fma_f32 v30, v30, v26, v27
    v_fma_f32 v31, v31, v26, v27
    v_cvt_pk_bf16_f32 v253, v30, v31
    v_lshlrev_b32 v32, 16, v254
    v_and_b32 v33, s29, v254
    v_fma_f32 v32, v32, v26, v27
    v_fma_f32 v33, v33, v26, v27
    v_cvt_pk_bf16_f32 v254, v32, v33
    v_lshlrev_b32 v34, 16, v255
    v_and_b32 v35, s29, v255
    v_fma_f32 v34, v34, v26, v27
    v_fma_f32 v35, v35, v26, v27
    v_cvt_pk_bf16_f32 v255, v34, v35
    s_cmp_lg_u32 s12, 0
    s_cbranch_scc1 L_gn2
    s_waitcnt vmcnt(0)
    s_mov_b32 s88, 0
    v_mov_b32 v13, 0
L_gl2:
    v_readfirstlane_b32 s86, v14
    s_nop 3
    s_cmp_lg_u32 s86, 0
    s_cbranch_scc1 L_gn2
    buffer_load_dword v14, v13, s[92:95], 0 offen sc1
    s_add_u32 s88, s88, 1
    s_waitcnt vmcnt(0)
    s_cmp_lt_u32 s88, 1048576
    s_cbranch_scc1 L_gl2
L_gn2:
    s_lshr_b32 s17, s14, 2
    s_lshl_b32 s17, s17, 7
    s_add_u32 s17, s17, 75513856
    v_min_u32 v5, 17, v0
    v_lshlrev_b32 v5, 9, v5
    v_add_u32 v11, s17, v5
    s_cmp_lg_u32 s12, 0
    s_cbranch_scc1 L_pd3
    s_mov_b32 s88, 0
L_pl3:
    buffer_load_dword v12, v11, s[8:11], 0 offen sc1
    s_add_u32 s88, s88, 1
    s_waitcnt vmcnt(0)
    v_cmp_ne_u32 vcc, s86, v12
    s_nop 1
    s_cbranch_vccz L_pd3
    s_sleep 1
    s_cmp_lt_u32 s88, 1048576
    s_cbranch_scc1 L_pl3
L_pd3:
    s_barrier
    s_mul_i32 s22, s14, 147456
    s_add_u32 s22, s22, 0x0
    s_mul_i32 s23, s12, 6144
    s_add_u32 s22, s22, s23
    s_add_u32 m0, s23, 0
    s_add_u32 s21, s22, 0
    buffer_load_dwordx4 v1, s[8:11], s21 offen offset:0 sc1 lds
    buffer_load_dwordx4 v1, s[8:11], s21 offen offset:1024 sc1 lds
    buffer_load_dwordx4 v1, s[8:11], s21 offen offset:2048 sc1 lds
    buffer_load_dwordx4 v1, s[8:11], s21 offen offset:3072 sc1 lds
    s_add_u32 m0, s23, 4096
    s_add_u32 s21, s22, 4096
    buffer_load_dwordx4 v1, s[8:11], s21 offen offset:0 sc1 lds
    buffer_load_dwordx4 v1, s[8:11], s21 offen offset:1024 sc1 lds
    s_add_u32 m0, s23, 24576
    s_add_u32 s21, s22, 24576
    buffer_load_dwordx4 v1, s[8:11], s21 offen offset:0 sc1 lds
    buffer_load_dwordx4 v1, s[8:11], s21 offen offset:1024 sc1 lds
    buffer_load_dwordx4 v1, s[8:11], s21 offen offset:2048 sc1 lds
    buffer_load_dwordx4 v1, s[8:11], s21 offen offset:3072 sc1 lds
    s_add_u32 m0, s23, 28672
    s_add_u32 s21, s22, 28672
    buffer_load_dwordx4 v1, s[8:11], s21 offen offset:0 sc1 lds
    buffer_load_dwordx4 v1, s[8:11], s21 offen offset:1024 sc1 lds
    s_add_u32 m0, s23, 49152
    s_add_u32 s21, s22, 49152
    buffer_load_dwordx4 v1, s[8:11], s21 offen offset:0 sc1 lds
    buffer_load_dwordx4 v1, s[8:11], s21 offen offset:1024 sc1 lds
    buffer_load_dwordx4 v1, s[8:11], s21 offen offset:2048 sc1 lds
    buffer_load_dwordx4 v1, s[8:11], s21 offen offset:3072 sc1 lds
    s_add_u32 m0, s23, 53248
    s_add_u32 s21, s22, 53248
    buffer_load_dwordx4 v1, s[8:11], s21 offen offset:0 sc1 lds
    buffer_load_dwordx4 v1, s[8:11], s21 offen offset:1024 sc1 lds
    s_cmp_lg_u32 s14, 0
    s_cbranch_scc1 L_nomux4
    v_lshlrev_b32 v28, 2, v6
    s_lshl_b32 s21, s18, 6
    s_add_u32 s21, s21, 0x4a0000
    s_mov_b64 exec, 0xffff
    buffer_store_dword v24, v28, s[8:11], s21 offen sc1
    buffer_store_dword v25, v28, s[8:11], s21 offen offset:64 sc1
    s_mov_b64 exec, -1
    s_waitcnt vmcnt(0)
L_nomux4:
    v_mov_b32 v2, v1
    v_add_u32 v3, 49152, v1
    s_waitcnt vmcnt(12)
    s_barrier
    ds_read_b128 v[16:19], v2 offset:0
    ds_read_b128 v[20:23], v2 offset:1024
    ds_read_b128 v[24:27], v2 offset:2048
    ds_read_b128 v[28:31], v2 offset:3072
    ds_read_b128 v[32:35], v2 offset:4096
    ds_read_b128 v[36:39], v2 offset:5120
    ds_read_b128 v[40:43], v2 offset:6144
    s_waitcnt lgkmcnt(6)
    v_mfma_f32_16x16x32_bf16 v[48:51], v[16:19], v[112:115], 0
    ds_read_b128 v[44:47], v2 offset:7168
    v_mfma_f32_16x16x32_bf16 v[52:55], v[16:19], v[184:187], 0
    s_waitcnt lgkmcnt(6)
    v_mfma_f32_16x16x32_bf16 v[56:59], v[20:23], v[112:115], 0
    ds_read_b128 v[16:19], v2 offset:8192
    v_mfma_f32_16x16x32_bf16 v[60:63], v[20:23], v[184:187], 0
    s_waitcnt lgkmcnt(6)
    v_mfma_f32_16x16x32_bf16 v[64:67], v[24:27], v[112:115], 0
    ds_read_b128 v[20:23], v2 offset:9216
    v_mfma_f32_16x16x32_bf16 v[68:71], v[24:27], v[184:187], 0
    s_waitcnt lgkmcnt(6)
    v_mfma_f32_16x16x32_bf16 v[72:75], v[28:31], v[112:115], 0
    ds_read_b128 v[24:27], v2 offset:10240
    v_mfma_f32_16x16x32_bf16 v[76:79], v[28:31], v[184:187], 0
    s_waitcnt lgkmcnt(6)
    v_mfma_f32_16x16x32_bf16 v[80:83], v[32:35], v[112:115], 0
    ds_read_b128 v[28:31], v2 offset:11264
    v_mfma_f32_16x16x32_bf16 v[84:87], v[32:35], v[184:187], 0
    s_waitcnt lgkmcnt(6)
    v_mfma_f32_16x16x32_bf16 v[88:91], v[112:115], v[36:39], 0
    ds_read_b128 v[32:35], v2 offset:12288
    v_mfma_f32_16x16x32_bf16 v[92:95], v[184:187], v[36:39], 0
    s_waitcnt lgkmcnt(6)
    v_mfma_f32_16x16x32_bf16 v[96:99], v[112:115], v[40:43], 0
    ds_read_b128 v[36:39], v2 offset:13312
    v_mfma_f32_16x16x32_bf16 v[100:103], v[184:187], v[40:43], 0
    s_waitcnt lgkmcnt(6)
    v_mfma_f32_16x16x32_bf16 v[104:107], v[112:115], v[44:47], 0
    ds_read_b128 v[40:43], v2 offset:14336
    v_mfma_f32_16x16x32_bf16 v[108:111], v[184:187], v[44:47], 0
    s_waitcnt lgkmcnt(6)
    v_mfma_f32_16x16x32_bf16 v[48:51], v[16:19], v[116:119], v[48:51]
    ds_read_b128 v[44:47], v2 offset:15360
    v_mfma_f32_16x16x32_bf16 v[52:55], v[16:19], v[188:191], v[52:55]
    s_waitcnt lgkmcnt(6)
    v_mfma_f32_16x16x32_bf16 v[56:59], v[20:23], v[116:119], v[56:59]
    ds_read_b128 v[16:19], v2 offset:16384
    v_mfma_f32_16x16x32_bf16 v[60:63], v[20:23], v[188:191], v[60:63]
    s_waitcnt lgkmcnt(6)
    v_mfma_f32_16x16x32_bf16 v[64:67], v[24:27], v[116:119], v[64:67]
    ds_read_b128 v[20:23], v2 offset:17408
    v_mfma_f32_16x16x32_bf16 v[68:71], v[24:27], v[188:191], v[68:71]
    s_waitcnt lgkmcnt(6)
    v_mfma_f32_16x16x32_bf16 v[72:75], v[28:31], v[116:119], v[72:75]
    ds_read_b128 v[24:27], v2 offset:18432
    v_mfma_f32_16x16x32_bf16 v[76:79], v[28:31], v[188:191], v[76:79]
    s_waitcnt lgkmcnt(6)
    v_mfma_f32_16x16x32_bf16 v[80:83], v[32:35], v[116:119], v[80:83]
    ds_read_b128 v[28:31], v2 offset:19456
    v_mfma_f32_16x16x32_bf16 v[84:87], v[32:35], v[188:191], v[84:87]
    s_waitcnt lgkmcnt(6)
    v_mfma_f32_16x16x32_bf16 v[88:91], v[116:119], v[36:39], v[88:91]
    ds_read_b128 v[32:35], v2 offset:20480
    v_mfma_f32_16x16x32_bf16 v[92:95], v[188:191], v[36:39], v[92:95]
    s_waitcnt lgkmcnt(6)
    v_mfma_f32_16x16x32_bf16 v[96:99], v[116:119], v[40:43], v[96:99]
    ds_read_b128 v[36:39], v2 offset:21504
    v_mfma_f32_16x16x32_bf16 v[100:103], v[188:191], v[40:43], v[100:103]
    s_waitcnt lgkmcnt(6)
    v_mfma_f32_16x16x32_bf16 v[104:107], v[116:119], v[44:47], v[104:107]
    ds_read_b128 v[40:43], v2 offset:22528
    v_mfma_f32_16x16x32_bf16 v[108:111], v[188:191], v[44:47], v[108:111]
    s_waitcnt lgkmcnt(6)
    v_mfma_f32_16x16x32_bf16 v[48:51], v[16:19], v[120:123], v[48:51]
    ds_read_b128 v[44:47], v2 offset:23552
    v_mfma_f32_16x16x32_bf16 v[52:55], v[16:19], v[192:195], v[52:55]
    s_waitcnt lgkmcnt(6)
    v_mfma_f32_16x16x32_bf16 v[56:59], v[20:23], v[120:123], v[56:59]
    v_mfma_f32_16x16x32_bf16 v[60:63], v[20:23], v[192:195], v[60:63]
    s_waitcnt lgkmcnt(5)
    v_mfma_f32_16x16x32_bf16 v[64:67], v[24:27], v[120:123], v[64:67]
    v_mfma_f32_16x16x32_bf16 v[68:71], v[24:27], v[192:195], v[68:71]
    s_waitcnt lgkmcnt(0)
    s_waitcnt vmcnt(6)
    s_barrier
    ds_read_b128 v[16:19], v2 offset:24576
    s_add_u32 m0, s23, 0
    s_add_u32 s21, s22, 73728
    buffer_load_dwordx4 v1, s[8:11], s21 offen offset:0 sc1 lds
    v_mfma_f32_16x16x32_bf16 v[72:75], v[28:31], v[120:123], v[72:75]
    ds_read_b128 v[20:23], v2 offset:25600
    v_mfma_f32_16x16x32_bf16 v[76:79], v[28:31], v[192:195], v[76:79]
    ds_read_b128 v[24:27], v2 offset:26624
    buffer_load_dwordx4 v1, s[8:11], s21 offen offset:1024 sc1 lds
    v_mfma_f32_16x16x32_bf16 v[80:83], v[32:35], v[120:123], v[80:83]
    ds_read_b128 v[28:31], v2 offset:27648
    v_mfma_f32_16x16x32_bf16 v[84:87], v[32:35], v[192:195], v[84:87]
    buffer_load_dwordx4 v1, s[8:11], s21 offen offset:2048 sc1 lds
    v_mfma_f32_16x16x32_bf16 v[88:91], v[120:123], v[36:39], v[88:91]
    ds_read_b128 v[32:35], v2 offset:28672
    v_mfma_f32_16x16x32_bf16 v[92:95], v[192:195], v[36:39], v[92:95]
    buffer_load_dwordx4 v1, s[8:11], s21 offen offset:3072 sc1 lds
    v_mfma_f32_16x16x32_bf16 v[96:99], v[120:123], v[40:43], v[96:99]
    ds_read_b128 v[36:39], v2 offset:29696
    v_mfma_f32_16x16x32_bf16 v[100:103], v[192:195], v[40:43], v[100:103]
    s_add_u32 m0, s23, 4096
    s_add_u32 s21, s22, 77824
    buffer_load_dwordx4 v1, s[8:11], s21 offen offset:0 sc1 lds
    v_mfma_f32_16x16x32_bf16 v[104:107], v[120:123], v[44:47], v[104:107]
    ds_read_b128 v[40:43], v2 offset:30720
    v_mfma_f32_16x16x32_bf16 v[108:111], v[192:195], v[44:47], v[108:111]
    buffer_load_dwordx4 v1, s[8:11], s21 offen offset:1024 sc1 lds
    s_waitcnt lgkmcnt(6)
    v_mfma_f32_16x16x32_bf16 v[48:51], v[16:19], v[124:127], v[48:51]
    ds_read_b128 v[44:47], v2 offset:31744
    v_mfma_f32_16x16x32_bf16 v[52:55], v[16:19], v[196:199], v[52:55]
    s_waitcnt lgkmcnt(6)
    v_mfma_f32_16x16x32_bf16 v[56:59], v[20:23], v[124:127], v[56:59]
    ds_read_b128 v[16:19], v2 offset:32768
    v_mfma_f32_16x16x32_bf16 v[60:63], v[20:23], v[196:199], v[60:63]
    s_waitcnt lgkmcnt(6)
    v_mfma_f32_16x16x32_bf16 v[64:67], v[24:27], v[124:127], v[64:67]
    ds_read_b128 v[20:23], v2 offset:33792
    v_mfma_f32_16x16x32_bf16 v[68:71], v[24:27], v[196:199], v[68:71]
    s_waitcnt lgkmcnt(6)
    v_mfma_f32_16x16x32_bf16 v[72:75], v[28:31], v[124:127], v[72:75]
    ds_read_b128 v[24:27], v2 offset:34816
    v_mfma_f32_16x16x32_bf16 v[76:79], v[28:31], v[196:199], v[76:79]
    s_waitcnt lgkmcnt(6)
    v_mfma_f32_16x16x32_bf16 v[80:83], v[32:35], v[124:127], v[80:83]
    ds_read_b128 v[28:31], v2 offset:35840
    v_mfma_f32_16x16x32_bf16 v[84:87], v[32:35], v[196:199], v[84:87]
    s_waitcnt lgkmcnt(6)
    v_mfma_f32_16x16x32_bf16 v[88:91], v[124:127], v[36:39], v[88:91]
    ds_read_b128 v[32:35], v2 offset:36864
    v_mfma_f32_16x16x32_bf16 v[92:95], v[196:199], v[36:39], v[92:95]
    s_waitcnt lgkmcnt(6)
    v_mfma_f32_16x16x32_bf16 v[96:99], v[124:127], v[40:43], v[96:99]
    ds_read_b128 v[36:39], v2 offset:37888
    v_mfma_f32_16x16x32_bf16 v[100:103], v[196:199], v[40:43], v[100:103]
    s_waitcnt lgkmcnt(6)
    v_mfma_f32_16x16x32_bf16 v[104:107], v[124:127], v[44:47], v[104:107]
    ds_read_b128 v[40:43], v2 offset:38912
    v_mfma_f32_16x16x32_bf16 v[108:111], v[196:199], v[44:47], v[108:111]
    s_waitcnt lgkmcnt(6)
    v_mfma_f32_16x16x32_bf16 v[48:51], v[16:19], v[128:131], v[48:51]
    ds_read_b128 v[44:47], v2 offset:39936
    v_mfma_f32_16x16x32_bf16 v[52:55], v[16:19], v[200:203], v[52:55]
    s_waitcnt lgkmcnt(6)
    v_mfma_f32_16x16x32_bf16 v[56:59], v[20:23], v[128:131], v[56:59]
    ds_read_b128 v[16:19], v2 offset:40960
    v_mfma_f32_16x16x32_bf16 v[60:63], v[20:23], v[200:203], v[60:63]
    s_waitcnt lgkmcnt(6)
    v_mfma_f32_16x16x32_bf16 v[64:67], v[24:27], v[128:131], v[64:67]
    ds_read_b128 v[20:23], v2 offset:41984
    v_mfma_f32_16x16x32_bf16 v[68:71], v[24:27], v[200:203], v[68:71]
    s_waitcnt lgkmcnt(6)
    v_mfma_f32_16x16x32_bf16 v[72:75], v[28:31], v[128:131], v[72:75]
    ds_read_b128 v[24:27], v2 offset:43008
    v_mfma_f32_16x16x32_bf16 v[76:79], v[28:31], v[200:203], v[76:79]
    s_waitcnt lgkmcnt(6)
    v_mfma_f32_16x16x32_bf16 v[80:83], v[32:35], v[128:131], v[80:83]
    ds_read_b128 v[28:31], v2 offset:44032
    v_mfma_f32_16x16x32_bf16 v[84:87], v[32:35], v[200:203], v[84:87]
    s_waitcnt lgkmcnt(6)
    v_mfma_f32_16x16x32_bf16 v[88:91], v[128:131], v[36:39], v[88:91]
    ds_read_b128 v[32:35], v2 offset:45056
    v_mfma_f32_16x16x32_bf16 v[92:95], v[200:203], v[36:39], v[92:95]
    s_waitcnt lgkmcnt(6)
    v_mfma_f32_16x16x32_bf16 v[96:99], v[128:131], v[40:43], v[96:99]
    ds_read_b128 v[36:39], v2 offset:46080
    v_mfma_f32_16x16x32_bf16 v[100:103], v[200:203], v[40:43], v[100:103]
    s_waitcnt lgkmcnt(6)
    v_mfma_f32_16x16x32_bf16 v[104:107], v[128:131], v[44:47], v[104:107]
    ds_read_b128 v[40:43], v2 offset:47104
    v_mfma_f32_16x16x32_bf16 v[108:111], v[200:203], v[44:47], v[108:111]
    s_waitcnt lgkmcnt(6)
    v_mfma_f32_16x16x32_bf16 v[48:51], v[16:19], v[132:135], v[48:51]
    ds_read_b128 v[44:47], v2 offset:48128
    v_mfma_f32_16x16x32_bf16 v[52:55], v[16:19], v[204:207], v[52:55]
    s_waitcnt lgkmcnt(6)
    v_mfma_f32_16x16x32_bf16 v[56:59], v[20:23], v[132:135], v[56:59]
    v_mfma_f32_16x16x32_bf16 v[60:63], v[20:23], v[204:207], v[60:63]
    s_waitcnt lgkmcnt(5)
    v_mfma_f32_16x16x32_bf16 v[64:67], v[24:27], v[132:135], v[64:67]
    v_mfma_f32_16x16x32_bf16 v[68:71], v[24:27], v[204:207], v[68:71]
    s_waitcnt lgkmcnt(0)
    s_waitcnt vmcnt(6)
    s_barrier
    ds_read_b128 v[16:19], v3 offset:0
    s_add_u32 m0, s23, 24576
    s_add_u32 s21, s22, 98304
    buffer_load_dwordx4 v1, s[8:11], s21 offen offset:0 sc1 lds
    v_mfma_f32_16x16x32_bf16 v[72:75], v[28:31], v[132:135], v[72:75]
    ds_read_b128 v[20:23], v3 offset:1024
    v_mfma_f32_16x16x32_bf16 v[76:79], v[28:31], v[204:207], v[76:79]
    ds_read_b128 v[24:27], v3 offset:2048
    buffer_load_dwordx4 v1, s[8:11], s21 offen offset:1024 sc1 lds
    v_mfma_f32_16x16x32_bf16 v[80:83], v[32:35], v[132:135], v[80:83]
    ds_read_b128 v[28:31], v3 offset:3072
    v_mfma_f32_16x16x32_bf16 v[84:87], v[32:35], v[204:207], v[84:87]
    buffer_load_dwordx4 v1, s[8:11], s21 offen offset:2048 sc1 lds
    v_mfma_f32_16x16x32_bf16 v[88:91], v[132:135], v[36:39], v[88:91]
    ds_read_b128 v[32:35], v3 offset:4096
    v_mfma_f32_16x16x32_bf16 v[92:95], v[204:207], v[36:39], v[92:95]
    buffer_load_dwordx4 v1, s[8:11], s21 offen offset:3072 sc1 lds
    v_mfma_f32_16x16x32_bf16 v[96:99], v[132:135], v[40:43], v[96:99]
    ds_read_b128 v[36:39], v3 offset:5120
    v_mfma_f32_16x16x32_bf16 v[100:103], v[204:207], v[40:43], v[100:103]
    s_add_u32 m0, s23, 28672
    s_add_u32 s21, s22, 102400
    buffer_load_dwordx4 v1, s[8:11], s21 offen offset:0 sc1 lds
    v_mfma_f32_16x16x32_bf16 v[104:107], v[132:135], v[44:47], v[104:107]
    ds_read_b128 v[40:43], v3 offset:6144
    v_mfma_f32_16x16x32_bf16 v[108:111], v[204:207], v[44:47], v[108:111]
    buffer_load_dwordx4 v1, s[8:11], s21 offen offset:1024 sc1 lds
    s_waitcnt lgkmcnt(6)
    v_mfma_f32_16x16x32_bf16 v[48:51], v[16:19], v[136:139], v[48:51]
    ds_read_b128 v[44:47], v3 offset:7168
    v_mfma_f32_16x16x32_bf16 v[52:55], v[16:19], v[208:211], v[52:55]
    s_waitcnt lgkmcnt(6)
    v_mfma_f32_16x16x32_bf16 v[56:59], v[20:23], v[136:139], v[56:59]
    ds_read_b128 v[16:19], v3 offset:8192
    v_mfma_f32_16x16x32_bf16 v[60:63], v[20:23], v[208:211], v[60:63]
    s_waitcnt lgkmcnt(6)
    v_mfma_f32_16x16x32_bf16 v[64:67], v[24:27], v[136:139], v[64:67]
    ds_read_b128 v[20:23], v3 offset:9216
    v_mfma_f32_16x16x32_bf16 v[68:71], v[24:27], v[208:211], v[68:71]
    s_waitcnt lgkmcnt(6)
    v_mfma_f32_16x16x32_bf16 v[72:75], v[28:31], v[136:139], v[72:75]
    ds_read_b128 v[24:27], v3 offset:10240
    v_mfma_f32_16x16x32_bf16 v[76:79], v[28:31], v[208:211], v[76:79]
    s_waitcnt lgkmcnt(6)
    v_mfma_f32_16x16x32_bf16 v[80:83], v[32:35], v[136:139], v[80:83]
    ds_read_b128 v[28:31], v3 offset:11264
    v_mfma_f32_16x16x32_bf16 v[84:87], v[32:35], v[208:211], v[84:87]
    s_waitcnt lgkmcnt(6)
    v_mfma_f32_16x16x32_bf16 v[88:91], v[136:139], v[36:39], v[88:91]
    ds_read_b128 v[32:35], v3 offset:12288
    v_mfma_f32_16x16x32_bf16 v[92:95], v[208:211], v[36:39], v[92:95]
    s_waitcnt lgkmcnt(6)
    v_mfma_f32_16x16x32_bf16 v[96:99], v[136:139], v[40:43], v[96:99]
    ds_read_b128 v[36:39], v3 offset:13312
    v_mfma_f32_16x16x32_bf16 v[100:103], v[208:211], v[40:43], v[100:103]
    s_waitcnt lgkmcnt(6)
    v_mfma_f32_16x16x32_bf16 v[104:107], v[136:139], v[44:47], v[104:107]
    ds_read_b128 v[40:43], v3 offset:14336
    v_mfma_f32_16x16x32_bf16 v[108:111], v[208:211], v[44:47], v[108:111]
    s_waitcnt lgkmcnt(6)
    v_mfma_f32_16x16x32_bf16 v[48:51], v[16:19], v[140:143], v[48:51]
    ds_read_b128 v[44:47], v3 offset:15360
    v_mfma_f32_16x16x32_bf16 v[52:55], v[16:19], v[212:215], v[52:55]
    s_waitcnt lgkmcnt(6)
    v_mfma_f32_16x16x32_bf16 v[56:59], v[20:23], v[140:143], v[56:59]
    ds_read_b128 v[16:19], v3 offset:16384
    v_mfma_f32_16x16x32_bf16 v[60:63], v[20:23], v[212:215], v[60:63]
    s_waitcnt lgkmcnt(6)
    v_mfma_f32_16x16x32_bf16 v[64:67], v[24:27], v[140:143], v[64:67]
    ds_read_b128 v[20:23], v3 offset:17408
    v_mfma_f32_16x16x32_bf16 v[68:71], v[24:27], v[212:215], v[68:71]
    s_waitcnt lgkmcnt(6)
    v_mfma_f32_16x16x32_bf16 v[72:75], v[28:31], v[140:143], v[72:75]
    ds_read_b128 v[24:27], v3 offset:18432
    v_mfma_f32_16x16x32_bf16 v[76:79], v[28:31], v[212:215], v[76:79]
    s_waitcnt lgkmcnt(6)
    v_mfma_f32_16x16x32_bf16 v[80:83], v[32:35], v[140:143], v[80:83]
    ds_read_b128 v[28:31], v3 offset:19456
    v_mfma_f32_16x16x32_bf16 v[84:87], v[32:35], v[212:215], v[84:87]
    s_waitcnt lgkmcnt(6)
    v_mfma_f32_16x16x32_bf16 v[88:91], v[140:143], v[36:39], v[88:91]
    ds_read_b128 v[32:35], v3 offset:20480
    v_mfma_f32_16x16x32_bf16 v[92:95], v[212:215], v[36:39], v[92:95]
    s_waitcnt lgkmcnt(6)
    v_mfma_f32_16x16x32_bf16 v[96:99], v[140:143], v[40:43], v[96:99]
    ds_read_b128 v[36:39], v3 offset:21504
    v_mfma_f32_16x16x32_bf16 v[100:103], v[212:215], v[40:43], v[100:103]
    s_waitcnt lgkmcnt(6)
    v_mfma_f32_16x16x32_bf16 v[104:107], v[140:143], v[44:47], v[104:107]
    ds_read_b128 v[40:43], v3 offset:22528
    v_mfma_f32_16x16x32_bf16 v[108:111], v[212:215], v[44:47], v[108:111]
    s_waitcnt lgkmcnt(6)
    v_mfma_f32_16x16x32_bf16 v[48:51], v[16:19], v[144:147], v[48:51]
    ds_read_b128 v[44:47], v3 offset:23552
    v_mfma_f32_16x16x32_bf16 v[52:55], v[16:19], v[216:219], v[52:55]
    s_waitcnt lgkmcnt(6)
    v_mfma_f32_16x16x32_bf16 v[56:59], v[20:23], v[144:147], v[56:59]
    v_mfma_f32_16x16x32_bf16 v[60:63], v[20:23], v[216:219], v[60:63]
    s_waitcnt lgkmcnt(5)
    v_mfma_f32_16x16x32_bf16 v[64:67], v[24:27], v[144:147], v[64:67]
    v_mfma_f32_16x16x32_bf16 v[68:71], v[24:27], v[216:219], v[68:71]
    s_waitcnt lgkmcnt(0)
    s_waitcnt vmcnt(6)
    s_barrier
    ds_read_b128 v[16:19], v2 offset:0
    s_add_u32 m0, s23, 49152
    s_add_u32 s21, s22, 122880
    buffer_load_dwordx4 v1, s[8:11], s21 offen offset:0 sc1 lds
    v_mfma_f32_16x16x32_bf16 v[72:75], v[28:31], v[144:147], v[72:75]
    ds_read_b128 v[20:23], v2 offset:1024
    v_mfma_f32_16x16x32_bf16 v[76:79], v[28:31], v[216:219], v[76:79]
    ds_read_b128 v[24:27], v2 offset:2048
    buffer_load_dwordx4 v1, s[8:11], s21 offen offset:1024 sc1 lds
    v_mfma_f32_16x16x32_bf16 v[80:83], v[32:35], v[144:147], v[80:83]
    ds_read_b128 v[28:31], v2 offset:3072
    v_mfma_f32_16x16x32_bf16 v[84:87], v[32:35], v[216:219], v[84:87]
    buffer_load_dwordx4 v1, s[8:11], s21 offen offset:2048 sc1 lds
    v_mfma_f32_16x16x32_bf16 v[88:91], v[144:147], v[36:39], v[88:91]
    ds_read_b128 v[32:35], v2 offset:4096
    v_mfma_f32_16x16x32_bf16 v[92:95], v[216:219], v[36:39], v[92:95]
    buffer_load_dwordx4 v1, s[8:11], s21 offen offset:3072 sc1 lds
    v_mfma_f32_16x16x32_bf16 v[96:99], v[144:147], v[40:43], v[96:99]
    ds_read_b128 v[36:39], v2 offset:5120
    v_mfma_f32_16x16x32_bf16 v[100:103], v[216:219], v[40:43], v[100:103]
    s_add_u32 m0, s23, 53248
    s_add_u32 s21, s22, 126976
    buffer_load_dwordx4 v1, s[8:11], s21 offen offset:0 sc1 lds
    v_mfma_f32_16x16x32_bf16 v[104:107], v[144:147], v[44:47], v[104:107]
    ds_read_b128 v[40:43], v2 offset:6144
    v_mfma_f32_16x16x32_bf16 v[108:111], v[216:219], v[44:47], v[108:111]
    buffer_load_dwordx4 v1, s[8:11], s21 offen offset:1024 sc1 lds
    s_waitcnt lgkmcnt(6)
    v_mfma_f32_16x16x32_bf16 v[48:51], v[16:19], v[148:151], v[48:51]
    ds_read_b128 v[44:47], v2 offset:7168
    v_mfma_f32_16x16x32_bf16 v[52:55], v[16:19], v[220:223], v[52:55]
    s_waitcnt lgkmcnt(6)
    v_mfma_f32_16x16x32_bf16 v[56:59], v[20:23], v[148:151], v[56:59]
    ds_read_b128 v[16:19], v2 offset:8192
    v_mfma_f32_16x16x32_bf16 v[60:63], v[20:23], v[220:223], v[60:63]
    s_waitcnt lgkmcnt(6)
    v_mfma_f32_16x16x32_bf16 v[64:67], v[24:27], v[148:151], v[64:67]
    ds_read_b128 v[20:23], v2 offset:9216
    v_mfma_f32_16x16x32_bf16 v[68:71], v[24:27], v[220:223], v[68:71]
    s_waitcnt lgkmcnt(6)
    v_mfma_f32_16x16x32_bf16 v[72:75], v[28:31], v[148:151], v[72:75]
    ds_read_b128 v[24:27], v2 offset:10240
    v_mfma_f32_16x16x32_bf16 v[76:79], v[28:31], v[220:223], v[76:79]
    s_waitcnt lgkmcnt(6)
    v_mfma_f32_16x16x32_bf16 v[80:83], v[32:35], v[148:151], v[80:83]
    ds_read_b128 v[28:31], v2 offset:11264
    v_mfma_f32_16x16x32_bf16 v[84:87], v[32:35], v[220:223], v[84:87]
    s_waitcnt lgkmcnt(6)
    v_mfma_f32_16x16x32_bf16 v[88:91], v[148:151], v[36:39], v[88:91]
    ds_read_b128 v[32:35], v2 offset:12288
    v_mfma_f32_16x16x32_bf16 v[92:95], v[220:223], v[36:39], v[92:95]
    s_waitcnt lgkmcnt(6)
    v_mfma_f32_16x16x32_bf16 v[96:99], v[148:151], v[40:43], v[96:99]
    ds_read_b128 v[36:39], v2 offset:13312
    v_mfma_f32_16x16x32_bf16 v[100:103], v[220:223], v[40:43], v[100:103]
    s_waitcnt lgkmcnt(6)
    v_mfma_f32_16x16x32_bf16 v[104:107], v[148:151], v[44:47], v[104:107]
    ds_read_b128 v[40:43], v2 offset:14336
    v_mfma_f32_16x16x32_bf16 v[108:111], v[220:223], v[44:47], v[108:111]
    s_waitcnt lgkmcnt(6)
    v_mfma_f32_16x16x32_bf16 v[48:51], v[16:19], v[152:155], v[48:51]
    ds_read_b128 v[44:47], v2 offset:15360
    v_mfma_f32_16x16x32_bf16 v[52:55], v[16:19], v[224:227], v[52:55]
    s_waitcnt lgkmcnt(6)
    v_mfma_f32_16x16x32_bf16 v[56:59], v[20:23], v[152:155], v[56:59]
    ds_read_b128 v[16:19], v2 offset:16384
    v_mfma_f32_16x16x32_bf16 v[60:63], v[20:23], v[224:227], v[60:63]
    s_waitcnt lgkmcnt(6)
    v_mfma_f32_16x16x32_bf16 v[64:67], v[24:27], v[152:155], v[64:67]
    ds_read_b128 v[20:23], v2 offset:17408
    v_mfma_f32_16x16x32_bf16 v[68:71], v[24:27], v[224:227], v[68:71]
    s_waitcnt lgkmcnt(6)
    v_mfma_f32_16x16x32_bf16 v[72:75], v[28:31], v[152:155], v[72:75]
    ds_read_b128 v[24:27], v2 offset:18432
    v_mfma_f32_16x16x32_bf16 v[76:79], v[28:31], v[224:227], v[76:79]
    s_waitcnt lgkmcnt(6)
    v_mfma_f32_16x16x32_bf16 v[80:83], v[32:35], v[152:155], v[80:83]
    ds_read_b128 v[28:31], v2 offset:19456
    v_mfma_f32_16x16x32_bf16 v[84:87], v[32:35], v[224:227], v[84:87]
    s_waitcnt lgkmcnt(6)
    v_mfma_f32_16x16x32_bf16 v[88:91], v[152:155], v[36:39], v[88:91]
    ds_read_b128 v[32:35], v2 offset:20480
    v_mfma_f32_16x16x32_bf16 v[92:95], v[224:227], v[36:39], v[92:95]
    s_waitcnt lgkmcnt(6)
    v_mfma_f32_16x16x32_bf16 v[96:99], v[152:155], v[40:43], v[96:99]
    ds_read_b128 v[36:39], v2 offset:21504
    v_mfma_f32_16x16x32_bf16 v[100:103], v[224:227], v[40:43], v[100:103]
    s_waitcnt lgkmcnt(6)
    v_mfma_f32_16x16x32_bf16 v[104:107], v[152:155], v[44:47], v[104:107]
    ds_read_b128 v[40:43], v2 offset:22528
    v_mfma_f32_16x16x32_bf16 v[108:111], v[224:227], v[44:47], v[108:111]
    s_waitcnt lgkmcnt(6)
    v_mfma_f32_16x16x32_bf16 v[48:51], v[16:19], v[156:159], v[48:51]
    ds_read_b128 v[44:47], v2 offset:23552
    v_mfma_f32_16x16x32_bf16 v[52:55], v[16:19], v[228:231], v[52:55]
    s_waitcnt lgkmcnt(6)
    v_mfma_f32_16x16x32_bf16 v[56:59], v[20:23], v[156:159], v[56:59]
    v_mfma_f32_16x16x32_bf16 v[60:63], v[20:23], v[228:231], v[60:63]
    s_waitcnt lgkmcnt(5)
    v_mfma_f32_16x16x32_bf16 v[64:67], v[24:27], v[156:159], v[64:67]
    v_mfma_f32_16x16x32_bf16 v[68:71], v[24:27], v[228:231], v[68:71]
    s_waitcnt lgkmcnt(0)
    s_waitcnt vmcnt(6)
    s_barrier
    ds_read_b128 v[16:19], v2 offset:24576
    v_mfma_f32_16x16x32_bf16 v[72:75], v[28:31], v[156:159], v[72:75]
    ds_read_b128 v[20:23], v2 offset:25600
    v_mfma_f32_16x16x32_bf16 v[76:79], v[28:31], v[228:231], v[76:79]
    ds_read_b128 v[24:27], v2 offset:26624
    v_mfma_f32_16x16x32_bf16 v[80:83], v[32:35], v[156:159], v[80:83]
    ds_read_b128 v[28:31], v2 offset:27648
    v_mfma_f32_16x16x32_bf16 v[84:87], v[32:35], v[228:231], v[84:87]
    v_mfma_f32_16x16x32_bf16 v[88:91], v[156:159], v[36:39], v[88:91]
    ds_read_b128 v[32:35], v2 offset:28672
    v_mfma_f32_16x16x32_bf16 v[92:95], v[228:231], v[36:39], v[92:95]
    v_mfma_f32_16x16x32_bf16 v[96:99], v[156:159], v[40:43], v[96:99]
    ds_read_b128 v[36:39], v2 offset:29696
    v_mfma_f32_16x16x32_bf16 v[100:103], v[228:231], v[40:43], v[100:103]
    v_mfma_f32_16x16x32_bf16 v[104:107], v[156:159], v[44:47], v[104:107]
    ds_read_b128 v[40:43], v2 offset:30720
    v_mfma_f32_16x16x32_bf16 v[108:111], v[228:231], v[44:47], v[108:111]
    s_waitcnt lgkmcnt(6)
    v_mfma_f32_16x16x32_bf16 v[48:51], v[16:19], v[160:163], v[48:51]
    ds_read_b128 v[44:47], v2 offset:31744
    v_mfma_f32_16x16x32_bf16 v[52:55], v[16:19], v[232:235], v[52:55]
    s_waitcnt lgkmcnt(6)
    v_mfma_f32_16x16x32_bf16 v[56:59], v[20:23], v[160:163], v[56:59]
    ds_read_b128 v[16:19], v2 offset:32768
    v_mfma_f32_16x16x32_bf16 v[60:63], v[20:23], v[232:235], v[60:63]
    s_waitcnt lgkmcnt(6)
    v_mfma_f32_16x16x32_bf16 v[64:67], v[24:27], v[160:163], v[64:67]
    ds_read_b128 v[20:23], v2 offset:33792
    v_mfma_f32_16x16x32_bf16 v[68:71], v[24:27], v[232:235], v[68:71]
    s_waitcnt lgkmcnt(6)
    v_mfma_f32_16x16x32_bf16 v[72:75], v[28:31], v[160:163], v[72:75]
    ds_read_b128 v[24:27], v2 offset:34816
    v_mfma_f32_16x16x32_bf16 v[76:79], v[28:31], v[232:235], v[76:79]
    s_waitcnt lgkmcnt(6)
    v_mfma_f32_16x16x32_bf16 v[80:83], v[32:35], v[160:163], v[80:83]
    ds_read_b128 v[28:31], v2 offset:35840
    v_mfma_f32_16x16x32_bf16 v[84:87], v[32:35], v[232:235], v[84:87]
    s_waitcnt lgkmcnt(6)
    v_mfma_f32_16x16x32_bf16 v[88:91], v[160:163], v[36:39], v[88:91]
    ds_read_b128 v[32:35], v2 offset:36864
    v_mfma_f32_16x16x32_bf16 v[92:95], v[232:235], v[36:39], v[92:95]
    s_waitcnt lgkmcnt(6)
    v_mfma_f32_16x16x32_bf16 v[96:99], v[160:163], v[40:43], v[96:99]
    ds_read_b128 v[36:39], v2 offset:37888
    v_mfma_f32_16x16x32_bf16 v[100:103], v[232:235], v[40:43], v[100:103]
    s_waitcnt lgkmcnt(6)
    v_mfma_f32_16x16x32_bf16 v[104:107], v[160:163], v[44:47], v[104:107]
    ds_read_b128 v[40:43], v2 offset:38912
    v_mfma_f32_16x16x32_bf16 v[108:111], v[232:235], v[44:47], v[108:111]
    s_waitcnt lgkmcnt(6)
    v_mfma_f32_16x16x32_bf16 v[48:51], v[16:19], v[164:167], v[48:51]
    ds_read_b128 v[44:47], v2 offset:39936
    v_mfma_f32_16x16x32_bf16 v[52:55], v[16:19], v[236:239], v[52:55]
    s_waitcnt lgkmcnt(6)
    v_mfma_f32_16x16x32_bf16 v[56:59], v[20:23], v[164:167], v[56:59]
    ds_read_b128 v[16:19], v2 offset:40960
    v_mfma_f32_16x16x32_bf16 v[60:63], v[20:23], v[236:239], v[60:63]
    s_waitcnt lgkmcnt(6)
    v_mfma_f32_16x16x32_bf16 v[64:67], v[24:27], v[164:167], v[64:67]
    ds_read_b128 v[20:23], v2 offset:41984
    v_mfma_f32_16x16x32_bf16 v[68:71], v[24:27], v[236:239], v[68:71]
    s_waitcnt lgkmcnt(6)
    v_mfma_f32_16x16x32_bf16 v[72:75], v[28:31], v[164:167], v[72:75]
    ds_read_b128 v[24:27], v2 offset:43008
    v_mfma_f32_16x16x32_bf16 v[76:79], v[28:31], v[236:239], v[76:79]
    s_waitcnt lgkmcnt(6)
    v_mfma_f32_16x16x32_bf16 v[80:83], v[32:35], v[164:167], v[80:83]
    ds_read_b128 v[28:31], v2 offset:44032
    v_mfma_f32_16x16x32_bf16 v[84:87], v[32:35], v[236:239], v[84:87]
    s_waitcnt lgkmcnt(6)
    v_mfma_f32_16x16x32_bf16 v[88:91], v[164:167], v[36:39], v[88:91]
    ds_read_b128 v[32:35], v2 offset:45056
    v_mfma_f32_16x16x32_bf16 v[92:95], v[236:239], v[36:39], v[92:95]
    s_waitcnt lgkmcnt(6)
    v_mfma_f32_16x16x32_bf16 v[96:99], v[164:167], v[40:43], v[96:99]
    ds_read_b128 v[36:39], v2 offset:46080
    v_mfma_f32_16x16x32_bf16 v[100:103], v[236:239], v[40:43], v[100:103]
    s_waitcnt lgkmcnt(6)
    v_mfma_f32_16x16x32_bf16 v[104:107], v[164:167], v[44:47], v[104:107]
    ds_read_b128 v[40:43], v2 offset:47104
    v_mfma_f32_16x16x32_bf16 v[108:111], v[236:239], v[44:47], v[108:111]
    s_waitcnt lgkmcnt(6)
    v_mfma_f32_16x16x32_bf16 v[48:51], v[16:19], v[168:171], v[48:51]
    ds_read_b128 v[44:47], v2 offset:48128
    v_mfma_f32_16x16x32_bf16 v[52:55], v[16:19], v[240:243], v[52:55]
    s_waitcnt lgkmcnt(6)
    v_mfma_f32_16x16x32_bf16 v[56:59], v[20:23], v[168:171], v[56:59]
    v_mfma_f32_16x16x32_bf16 v[60:63], v[20:23], v[240:243], v[60:63]
    s_waitcnt lgkmcnt(5)
    v_mfma_f32_16x16x32_bf16 v[64:67], v[24:27], v[168:171], v[64:67]
    v_mfma_f32_16x16x32_bf16 v[68:71], v[24:27], v[240:243], v[68:71]
    s_waitcnt lgkmcnt(0)
    s_waitcnt vmcnt(0)
    s_barrier
    ds_read_b128 v[16:19], v3 offset:0
    v_mfma_f32_16x16x32_bf16 v[72:75], v[28:31], v[168:171], v[72:75]
    ds_read_b128 v[20:23], v3 offset:1024
    v_mfma_f32_16x16x32_bf16 v[76:79], v[28:31], v[240:243], v[76:79]
    ds_read_b128 v[24:27], v3 offset:2048
    v_mfma_f32_16x16x32_bf16 v[80:83], v[32:35], v[168:171], v[80:83]
    ds_read_b128 v[28:31], v3 offset:3072
    v_mfma_f32_16x16x32_bf16 v[84:87], v[32:35], v[240:243], v[84:87]
    v_mfma_f32_16x16x32_bf16 v[88:91], v[168:171], v[36:39], v[88:91]
    ds_read_b128 v[32:35], v3 offset:4096
    v_mfma_f32_16x16x32_bf16 v[92:95], v[240:243], v[36:39], v[92:95]
    v_mfma_f32_16x16x32_bf16 v[96:99], v[168:171], v[40:43], v[96:99]
    ds_read_b128 v[36:39], v3 offset:5120
    v_mfma_f32_16x16x32_bf16 v[100:103], v[240:243], v[40:43], v[100:103]
    v_mfma_f32_16x16x32_bf16 v[104:107], v[168:171], v[44:47], v[104:107]
    ds_read_b128 v[40:43], v3 offset:6144
    v_mfma_f32_16x16x32_bf16 v[108:111], v[240:243], v[44:47], v[108:111]
    s_waitcnt lgkmcnt(6)
    v_mfma_f32_16x16x32_bf16 v[48:51], v[16:19], v[172:175], v[48:51]
    ds_read_b128 v[44:47], v3 offset:7168
    v_mfma_f32_16x16x32_bf16 v[52:55], v[16:19], v[244:247], v[52:55]
    s_waitcnt lgkmcnt(6)
    v_mfma_f32_16x16x32_bf16 v[56:59], v[20:23], v[172:175], v[56:59]
    ds_read_b128 v[16:19], v3 offset:8192
    v_mfma_f32_16x16x32_bf16 v[60:63], v[20:23], v[244:247], v[60:63]
    s_waitcnt lgkmcnt(6)
    v_mfma_f32_16x16x32_bf16 v[64:67], v[24:27], v[172:175], v[64:67]
    ds_read_b128 v[20:23], v3 offset:9216
    v_mfma_f32_16x16x32_bf16 v[68:71], v[24:27], v[244:247], v[68:71]
    s_waitcnt lgkmcnt(6)
    v_mfma_f32_16x16x32_bf16 v[72:75], v[28:31], v[172:175], v[72:75]
    ds_read_b128 v[24:27], v3 offset:10240
    v_mfma_f32_16x16x32_bf16 v[76:79], v[28:31], v[244:247], v[76:79]
    s_waitcnt lgkmcnt(6)
    v_mfma_f32_16x16x32_bf16 v[80:83], v[32:35], v[172:175], v[80:83]
    ds_read_b128 v[28:31], v3 offset:11264
    v_mfma_f32_16x16x32_bf16 v[84:87], v[32:35], v[244:247], v[84:87]
    s_waitcnt lgkmcnt(6)
    v_mfma_f32_16x16x32_bf16 v[88:91], v[172:175], v[36:39], v[88:91]
    ds_read_b128 v[32:35], v3 offset:12288
    v_mfma_f32_16x16x32_bf16 v[92:95], v[244:247], v[36:39], v[92:95]
    s_waitcnt lgkmcnt(6)
    v_mfma_f32_16x16x32_bf16 v[96:99], v[172:175], v[40:43], v[96:99]
    ds_read_b128 v[36:39], v3 offset:13312
    v_mfma_f32_16x16x32_bf16 v[100:103], v[244:247], v[40:43], v[100:103]
    s_waitcnt lgkmcnt(6)
    v_mfma_f32_16x16x32_bf16 v[104:107], v[172:175], v[44:47], v[104:107]
    ds_read_b128 v[40:43], v3 offset:14336
    v_mfma_f32_16x16x32_bf16 v[108:111], v[244:247], v[44:47], v[108:111]
    s_waitcnt lgkmcnt(6)
    v_mfma_f32_16x16x32_bf16 v[48:51], v[16:19], v[176:179], v[48:51]
    ds_read_b128 v[44:47], v3 offset:15360
    v_mfma_f32_16x16x32_bf16 v[52:55], v[16:19], v[248:251], v[52:55]
    s_waitcnt lgkmcnt(6)
    v_mfma_f32_16x16x32_bf16 v[56:59], v[20:23], v[176:179], v[56:59]
    ds_read_b128 v[16:19], v3 offset:16384
    v_mfma_f32_16x16x32_bf16 v[60:63], v[20:23], v[248:251], v[60:63]
    s_waitcnt lgkmcnt(6)
    v_mfma_f32_16x16x32_bf16 v[64:67], v[24:27], v[176:179], v[64:67]
    ds_read_b128 v[20:23], v3 offset:17408
    v_mfma_f32_16x16x32_bf16 v[68:71], v[24:27], v[248:251], v[68:71]
    s_waitcnt lgkmcnt(6)
    v_mfma_f32_16x16x32_bf16 v[72:75], v[28:31], v[176:179], v[72:75]
    ds_read_b128 v[24:27], v3 offset:18432
    v_mfma_f32_16x16x32_bf16 v[76:79], v[28:31], v[248:251], v[76:79]
    s_waitcnt lgkmcnt(6)
    v_mfma_f32_16x16x32_bf16 v[80:83], v[32:35], v[176:179], v[80:83]
    ds_read_b128 v[28:31], v3 offset:19456
    v_mfma_f32_16x16x32_bf16 v[84:87], v[32:35], v[248:251], v[84:87]
    s_waitcnt lgkmcnt(6)
    v_mfma_f32_16x16x32_bf16 v[88:91], v[176:179], v[36:39], v[88:91]
    ds_read_b128 v[32:35], v3 offset:20480
    v_mfma_f32_16x16x32_bf16 v[92:95], v[248:251], v[36:39], v[92:95]
    s_waitcnt lgkmcnt(6)
    v_mfma_f32_16x16x32_bf16 v[96:99], v[176:179], v[40:43], v[96:99]
    ds_read_b128 v[36:39], v3 offset:21504
    v_mfma_f32_16x16x32_bf16 v[100:103], v[248:251], v[40:43], v[100:103]
    s_waitcnt lgkmcnt(6)
    v_mfma_f32_16x16x32_bf16 v[104:107], v[176:179], v[44:47], v[104:107]
    ds_read_b128 v[40:43], v3 offset:22528
    v_mfma_f32_16x16x32_bf16 v[108:111], v[248:251], v[44:47], v[108:111]
    s_waitcnt lgkmcnt(6)
    v_mfma_f32_16x16x32_bf16 v[48:51], v[16:19], v[180:183], v[48:51]
    ds_read_b128 v[44:47], v3 offset:23552
    v_mfma_f32_16x16x32_bf16 v[52:55], v[16:19], v[252:255], v[52:55]
    s_waitcnt lgkmcnt(6)
    v_mfma_f32_16x16x32_bf16 v[56:59], v[20:23], v[180:183], v[56:59]
    v_mfma_f32_16x16x32_bf16 v[60:63], v[20:23], v[252:255], v[60:63]
    s_waitcnt lgkmcnt(5)
    v_mfma_f32_16x16x32_bf16 v[64:67], v[24:27], v[180:183], v[64:67]
    v_mfma_f32_16x16x32_bf16 v[68:71], v[24:27], v[252:255], v[68:71]
    s_waitcnt lgkmcnt(4)
    v_mfma_f32_16x16x32_bf16 v[72:75], v[28:31], v[180:183], v[72:75]
    v_mfma_f32_16x16x32_bf16 v[76:79], v[28:31], v[252:255], v[76:79]
    s_waitcnt lgkmcnt(3)
    v_mfma_f32_16x16x32_bf16 v[80:83], v[32:35], v[180:183], v[80:83]
    v_mfma_f32_16x16x32_bf16 v[84:87], v[32:35], v[252:255], v[84:87]
    s_waitcnt lgkmcnt(2)
    v_mfma_f32_16x16x32_bf16 v[88:91], v[180:183], v[36:39], v[88:91]
    v_mfma_f32_16x16x32_bf16 v[92:95], v[252:255], v[36:39], v[92:95]
    s_waitcnt lgkmcnt(1)
    v_mfma_f32_16x16x32_bf16 v[96:99], v[180:183], v[40:43], v[96:99]
    v_mfma_f32_16x16x32_bf16 v[100:103], v[252:255], v[40:43], v[100:103]
    s_waitcnt lgkmcnt(0)
    v_mfma_f32_16x16x32_bf16 v[104:107], v[180:183], v[44:47], v[104:107]
    v_mfma_f32_16x16x32_bf16 v[108:111], v[252:255], v[44:47], v[108:111]
    s_nop 7
    s_barrier
    v_and_b32 v6, 15, v0
    v_lshrrev_b32 v7, 4, v0
    s_mov_b32 s29, 0x3fb8aa3b
    v_max3_f32 v16, v48, v49, v50
    v_min3_f32 v17, v48, v49, v50
    v_max3_f32 v16, v16, v51, v56
    v_min3_f32 v17, v17, v51, v56
    v_max3_f32 v16, v16, v57, v58
    v_min3_f32 v17, v17, v57, v58
    v_max3_f32 v16, v16, v59, v64
    v_min3_f32 v17, v17, v59, v64
    v_max3_f32 v16, v16, v65, v66
    v_min3_f32 v17, v17, v65, v66
    v_max3_f32 v16, v16, v67, v72
    v_min3_f32 v17, v17, v67, v72
    v_max3_f32 v16, v16, v73, v74
    v_min3_f32 v17, v17, v73, v74
    v_max3_f32 v16, v16, v75, v80
    v_min3_f32 v17, v17, v75, v80
    v_max_f32 v16, v16, v81
    v_min_f32 v17, v17, v81
    v_mul_f32 v16, s29, v16
    v_mul_f32 v17, s29, v17
    v_sub_f32 v16, 0, v16
    v_fma_f32 v112, v48, s29, v16
    v_fma_f32 v130, -v48, s29, v17
    v_fma_f32 v113, v49, s29, v16
    v_fma_f32 v131, -v49, s29, v17
    v_fma_f32 v114, v50, s29, v16
    v_fma_f32 v132, -v50, s29, v17
    v_fma_f32 v115, v51, s29, v16
    v_fma_f32 v133, -v51, s29, v17
    v_fma_f32 v116, v56, s29, v16
    v_fma_f32 v134, -v56, s29, v17
    v_fma_f32 v117, v57, s29, v16
    v_fma_f32 v135, -v57, s29, v17
    v_fma_f32 v118, v58, s29, v16
    v_fma_f32 v136, -v58, s29, v17
    v_fma_f32 v119, v59, s29, v16
    v_fma_f32 v137, -v59, s29, v17
    v_fma_f32 v120, v64, s29, v16
    v_fma_f32 v138, -v64, s29, v17
    v_fma_f32 v121, v65, s29, v16
    v_fma_f32 v139, -v65, s29, v17
    v_fma_f32 v122, v66, s29, v16
    v_fma_f32 v140, -v66, s29, v17
    v_fma_f32 v123, v67, s29, v16
    v_fma_f32 v141, -v67, s29, v17
    v_fma_f32 v124, v72, s29, v16
    v_fma_f32 v142, -v72, s29, v17
    v_fma_f32 v125, v73, s29, v16
    v_fma_f32 v143, -v73, s29, v17
    v_fma_f32 v126, v74, s29, v16
    v_fma_f32 v144, -v74, s29, v17
    v_fma_f32 v127, v75, s29, v16
    v_fma_f32 v145, -v75, s29, v17
    v_fma_f32 v128, v80, s29, v16
    v_fma_f32 v146, -v80, s29, v17
    v_fma_f32 v129, v81, s29, v16
    v_fma_f32 v147, -v81, s29, v17
    v_exp_f32 v112, v112
    v_exp_f32 v130, v130
    v_exp_f32 v113, v113
    v_exp_f32 v131, v131
    v_exp_f32 v114, v114
    v_exp_f32 v132, v132
    v_exp_f32 v115, v115
    v_exp_f32 v133, v133
    v_exp_f32 v116, v116
    v_exp_f32 v134, v134
    v_exp_f32 v117, v117
    v_exp_f32 v135, v135
    v_exp_f32 v118, v118
    v_exp_f32 v136, v136
    v_exp_f32 v119, v119
    v_exp_f32 v137, v137
    v_exp_f32 v120, v120
    v_exp_f32 v138, v138
    v_exp_f32 v121, v121
    v_exp_f32 v139, v139
    v_exp_f32 v122, v122
    v_exp_f32 v140, v140
    v_exp_f32 v123, v123
    v_exp_f32 v141, v141
    v_exp_f32 v124, v124
    v_exp_f32 v142, v142
    v_exp_f32 v125, v125
    v_exp_f32 v143, v143
    v_exp_f32 v126, v126
    v_exp_f32 v144, v144
    v_exp_f32 v127, v127
    v_exp_f32 v145, v145
    v_exp_f32 v128, v128
    v_exp_f32 v146, v146
    v_exp_f32 v129, v129
    v_exp_f32 v147, v147
    s_nop 0
    v_add_f32 v18, v112, v113
    v_add_f32 v19, v130, v131
    v_add_f32 v20, v114, v115
    v_add_f32 v21, v132, v133
    v_add_f32 v18, v18, v116
    v_add_f32 v19, v19, v134
    v_add_f32 v20, v20, v117
    v_add_f32 v21, v21, v135
    v_add_f32 v18, v18, v118
    v_add_f32 v19, v19, v136
    v_add_f32 v20, v20, v119
    v_add_f32 v21, v21, v137
    v_add_f32 v18, v18, v120
    v_add_f32 v19, v19, v138
    v_add_f32 v20, v20, v121
    v_add_f32 v21, v21, v139
    v_add_f32 v18, v18, v122
    v_add_f32 v19, v19, v140
    v_add_f32 v20, v20, v123
    v_add_f32 v21, v21, v141
    v_add_f32 v18, v18, v124
    v_add_f32 v19, v19, v142
    v_add_f32 v20, v20, v125
    v_add_f32 v21, v21, v143
    v_add_f32 v18, v18, v126
    v_add_f32 v19, v19, v144
    v_add_f32 v20, v20, v127
    v_add_f32 v21, v21, v145
    v_add_f32 v18, v18, v128
    v_add_f32 v19, v19, v146
    v_add_f32 v20, v20, v129
    v_add_f32 v21, v21, v147
    v_add_f32 v18, v18, v20
    v_add_f32 v19, v19, v21
    v_rcp_f32 v18, v18
    v_rcp_f32 v19, v19
    s_nop 0
    v_mul_f32 v112, v112, v18
    v_mul_f32 v130, v130, v19
    v_mul_f32 v113, v113, v18
    v_mul_f32 v131, v131, v19
    v_mul_f32 v114, v114, v18
    v_mul_f32 v132, v132, v19
    v_mul_f32 v115, v115, v18
    v_mul_f32 v133, v133, v19
    v_mul_f32 v116, v116, v18
    v_mul_f32 v134, v134, v19
    v_mul_f32 v117, v117, v18
    v_mul_f32 v135, v135, v19
    v_mul_f32 v118, v118, v18
    v_mul_f32 v136, v136, v19
    v_mul_f32 v119, v119, v18
    v_mul_f32 v137, v137, v19
    v_mul_f32 v120, v120, v18
    v_mul_f32 v138, v138, v19
    v_mul_f32 v121, v121, v18
    v_mul_f32 v139, v139, v19
    v_mul_f32 v122, v122, v18
    v_mul_f32 v140, v140, v19
    v_mul_f32 v123, v123, v18
    v_mul_f32 v141, v141, v19
    v_mul_f32 v124, v124, v18
    v_mul_f32 v142, v142, v19
    v_mul_f32 v125, v125, v18
    v_mul_f32 v143, v143, v19
    v_mul_f32 v126, v126, v18
    v_mul_f32 v144, v144, v19
    v_mul_f32 v127, v127, v18
    v_mul_f32 v145, v145, v19
    v_mul_f32 v128, v128, v18
    v_mul_f32 v146, v146, v19
    v_mul_f32 v129, v129, v18
    v_mul_f32 v147, v147, v19
    v_cvt_pk_bf16_f32 v148, v112, v113
    v_cvt_pk_bf16_f32 v157, v130, v131
    v_cvt_pk_bf16_f32 v149, v114, v115
    v_cvt_pk_bf16_f32 v158, v132, v133
    v_cvt_pk_bf16_f32 v150, v116, v117
    v_cvt_pk_bf16_f32 v159, v134, v135
    v_cvt_pk_bf16_f32 v151, v118, v119
    v_cvt_pk_bf16_f32 v160, v136, v137
    v_cvt_pk_bf16_f32 v152, v120, v121
    v_cvt_pk_bf16_f32 v161, v138, v139
    v_cvt_pk_bf16_f32 v153, v122, v123
    v_cvt_pk_bf16_f32 v162, v140, v141
    v_cvt_pk_bf16_f32 v154, v124, v125
    v_cvt_pk_bf16_f32 v163, v142, v143
    v_cvt_pk_bf16_f32 v155, v126, v127
    v_cvt_pk_bf16_f32 v164, v144, v145
    v_cvt_pk_bf16_f32 v156, v128, v129
    v_cvt_pk_bf16_f32 v165, v146, v147
    v_max3_f32 v16, v52, v53, v54
    v_min3_f32 v17, v52, v53, v54
    v_max3_f32 v16, v16, v55, v60
    v_min3_f32 v17, v17, v55, v60
    v_max3_f32 v16, v16, v61, v62
    v_min3_f32 v17, v17, v61, v62
    v_max3_f32 v16, v16, v63, v68
    v_min3_f32 v17, v17, v63, v68
    v_max3_f32 v16, v16, v69, v70
    v_min3_f32 v17, v17, v69, v70
    v_max3_f32 v16, v16, v71, v76
    v_min3_f32 v17, v17, v71, v76
    v_max3_f32 v16, v16, v77, v78
    v_min3_f32 v17, v17, v77, v78
    v_max3_f32 v16, v16, v79, v84
    v_min3_f32 v17, v17, v79, v84
    v_max_f32 v16, v16, v85
    v_min_f32 v17, v17, v85
    v_mul_f32 v16, s29, v16
    v_mul_f32 v17, s29, v17
    v_sub_f32 v16, 0, v16
    v_fma_f32 v112, v52, s29, v16
    v_fma_f32 v130, -v52, s29, v17
    v_fma_f32 v113, v53, s29, v16
    v_fma_f32 v131, -v53, s29, v17
    v_fma_f32 v114, v54, s29, v16
    v_fma_f32 v132, -v54, s29, v17
    v_fma_f32 v115, v55, s29, v16
    v_fma_f32 v133, -v55, s29, v17
    v_fma_f32 v116, v60, s29, v16
    v_fma_f32 v134, -v60, s29, v17
    v_fma_f32 v117, v61, s29, v16
    v_fma_f32 v135, -v61, s29, v17
    v_fma_f32 v118, v62, s29, v16
    v_fma_f32 v136, -v62, s29, v17
    v_fma_f32 v119, v63, s29, v16
    v_fma_f32 v137, -v63, s29, v17
    v_fma_f32 v120, v68, s29, v16
    v_fma_f32 v138, -v68, s29, v17
    v_fma_f32 v121, v69, s29, v16
    v_fma_f32 v139, -v69, s29, v17
    v_fma_f32 v122, v70, s29, v16
    v_fma_f32 v140, -v70, s29, v17
    v_fma_f32 v123, v71, s29, v16
    v_fma_f32 v141, -v71, s29, v17
    v_fma_f32 v124, v76, s29, v16
    v_fma_f32 v142, -v76, s29, v17
    v_fma_f32 v125, v77, s29, v16
    v_fma_f32 v143, -v77, s29, v17
    v_fma_f32 v126, v78, s29, v16
    v_fma_f32 v144, -v78, s29, v17
    v_fma_f32 v127, v79, s29, v16
    v_fma_f32 v145, -v79, s29, v17
    v_fma_f32 v128, v84, s29, v16
    v_fma_f32 v146, -v84, s29, v17
    v_fma_f32 v129, v85, s29, v16
    v_fma_f32 v147, -v85, s29, v17
    v_exp_f32 v112, v112
    v_exp_f32 v130, v130
    v_exp_f32 v113, v113
    v_exp_f32 v131, v131
    v_exp_f32 v114, v114
    v_exp_f32 v132, v132
    v_exp_f32 v115, v115
    v_exp_f32 v133, v133
    v_exp_f32 v116, v116
    v_exp_f32 v134, v134
    v_exp_f32 v117, v117
    v_exp_f32 v135, v135
    v_exp_f32 v118, v118
    v_exp_f32 v136, v136
    v_exp_f32 v119, v119
    v_exp_f32 v137, v137
    v_exp_f32 v120, v120
    v_exp_f32 v138, v138
    v_exp_f32 v121, v121
    v_exp_f32 v139, v139
    v_exp_f32 v122, v122
    v_exp_f32 v140, v140
    v_exp_f32 v123, v123
    v_exp_f32 v141, v141
    v_exp_f32 v124, v124
    v_exp_f32 v142, v142
    v_exp_f32 v125, v125
    v_exp_f32 v143, v143
    v_exp_f32 v126, v126
    v_exp_f32 v144, v144
    v_exp_f32 v127, v127
    v_exp_f32 v145, v145
    v_exp_f32 v128, v128
    v_exp_f32 v146, v146
    v_exp_f32 v129, v129
    v_exp_f32 v147, v147
    s_nop 0
    v_add_f32 v18, v112, v113
    v_add_f32 v19, v130, v131
    v_add_f32 v20, v114, v115
    v_add_f32 v21, v132, v133
    v_add_f32 v18, v18, v116
    v_add_f32 v19, v19, v134
    v_add_f32 v20, v20, v117
    v_add_f32 v21, v21, v135
    v_add_f32 v18, v18, v118
    v_add_f32 v19, v19, v136
    v_add_f32 v20, v20, v119
    v_add_f32 v21, v21, v137
    v_add_f32 v18, v18, v120
    v_add_f32 v19, v19, v138
    v_add_f32 v20, v20, v121
    v_add_f32 v21, v21, v139
    v_add_f32 v18, v18, v122
    v_add_f32 v19, v19, v140
    v_add_f32 v20, v20, v123
    v_add_f32 v21, v21, v141
    v_add_f32 v18, v18, v124
    v_add_f32 v19, v19, v142
    v_add_f32 v20, v20, v125
    v_add_f32 v21, v21, v143
    v_add_f32 v18, v18, v126
    v_add_f32 v19, v19, v144
    v_add_f32 v20, v20, v127
    v_add_f32 v21, v21, v145
    v_add_f32 v18, v18, v128
    v_add_f32 v19, v19, v146
    v_add_f32 v20, v20, v129
    v_add_f32 v21, v21, v147
    v_add_f32 v18, v18, v20
    v_add_f32 v19, v19, v21
    v_rcp_f32 v18, v18
    v_rcp_f32 v19, v19
    s_nop 0
    v_mul_f32 v112, v112, v18
    v_mul_f32 v130, v130, v19
    v_mul_f32 v113, v113, v18
    v_mul_f32 v131, v131, v19
    v_mul_f32 v114, v114, v18
    v_mul_f32 v132, v132, v19
    v_mul_f32 v115, v115, v18
    v_mul_f32 v133, v133, v19
    v_mul_f32 v116, v116, v18
    v_mul_f32 v134, v134, v19
    v_mul_f32 v117, v117, v18
    v_mul_f32 v135, v135, v19
    v_mul_f32 v118, v118, v18
    v_mul_f32 v136, v136, v19
    v_mul_f32 v119, v119, v18
    v_mul_f32 v137, v137, v19
    v_mul_f32 v120, v120, v18
    v_mul_f32 v138, v138, v19
    v_mul_f32 v121, v121, v18
    v_mul_f32 v139, v139, v19
    v_mul_f32 v122, v122, v18
    v_mul_f32 v140, v140, v19
    v_mul_f32 v123, v123, v18
    v_mul_f32 v141, v141, v19
    v_mul_f32 v124, v124, v18
    v_mul_f32 v142, v142, v19
    v_mul_f32 v125, v125, v18
    v_mul_f32 v143, v143, v19
    v_mul_f32 v126, v126, v18
    v_mul_f32 v144, v144, v19
    v_mul_f32 v127, v127, v18
    v_mul_f32 v145, v145, v19
    v_mul_f32 v128, v128, v18
    v_mul_f32 v146, v146, v19
    v_mul_f32 v129, v129, v18
    v_mul_f32 v147, v147, v19
    v_cvt_pk_bf16_f32 v168, v112, v113
    v_cvt_pk_bf16_f32 v177, v130, v131
    v_cvt_pk_bf16_f32 v169, v114, v115
    v_cvt_pk_bf16_f32 v178, v132, v133
    v_cvt_pk_bf16_f32 v170, v116, v117
    v_cvt_pk_bf16_f32 v179, v134, v135
    v_cvt_pk_bf16_f32 v171, v118, v119
    v_cvt_pk_bf16_f32 v180, v136, v137
    v_cvt_pk_bf16_f32 v172, v120, v121
    v_cvt_pk_bf16_f32 v181, v138, v139
    v_cvt_pk_bf16_f32 v173, v122, v123
    v_cvt_pk_bf16_f32 v182, v140, v141
    v_cvt_pk_bf16_f32 v174, v124, v125
    v_cvt_pk_bf16_f32 v183, v142, v143
    v_cvt_pk_bf16_f32 v175, v126, v127
    v_cvt_pk_bf16_f32 v184, v144, v145
    v_cvt_pk_bf16_f32 v176, v128, v129
    v_cvt_pk_bf16_f32 v185, v146, v147
    v_and_b32 v16, 1, v7
    v_mul_u32_u24 v17, 1152, v16
    v_lshlrev_b32 v18, 4, v6
    v_add_u32 v18, v18, v17
    v_lshlrev_b32 v19, 3, v6
    v_add_u32 v19, v19, v17
    v_add_u32 v19, 1024, v19
    s_lshl_b32 s21, s18, 5
    s_lshl_b32 s23, s14, 1
    s_add_u32 s21, s21, s23
    s_mul_i32 s21, s21, 1152
    s_add_u32 s21, s21, 0x800000
    v_mul_u32_u24 v20, 152, v6
    v_mul_u32_u24 v21, 72, v16
    v_add_u32 v20, v20, v21
    s_mul_i32 s23, s12, 4864
    v_add_u32 v20, s23, v20
    s_mov_b32 exec_lo, 0
    s_mov_b32 exec_hi, -1
    ds_write_b64 v20, v[148:149] offset:0
    ds_write_b64 v20, v[150:151] offset:8
    ds_write_b64 v20, v[152:153] offset:16
    ds_write_b64 v20, v[154:155] offset:24
    ds_write_b64 v20, v[156:157] offset:32
    ds_write_b64 v20, v[158:159] offset:40
    ds_write_b64 v20, v[160:161] offset:48
    ds_write_b64 v20, v[162:163] offset:56
    ds_write_b64 v20, v[164:165] offset:64
    ds_write_b64 v20, v[168:169] offset:2432
    ds_write_b64 v20, v[170:171] offset:2440
    ds_write_b64 v20, v[172:173] offset:2448
    ds_write_b64 v20, v[174:175] offset:2456
    ds_write_b64 v20, v[176:177] offset:2464
    ds_write_b64 v20, v[178:179] offset:2472
    ds_write_b64 v20, v[180:181] offset:2480
    ds_write_b64 v20, v[182:183] offset:2488
    ds_write_b64 v20, v[184:185] offset:2496
    s_mov_b64 exec, -1
    v_cvt_pk_bf16_f32 v24, v88, v89
    v_cvt_pk_bf16_f32 v25, v90, v91
    v_cvt_pk_bf16_f32 v26, v92, v93
    v_cvt_pk_bf16_f32 v27, v94, v95
    v_cvt_pk_bf16_f32 v28, v96, v97
    v_cvt_pk_bf16_f32 v29, v98, v99
    v_cvt_pk_bf16_f32 v30, v100, v101
    v_cvt_pk_bf16_f32 v31, v102, v103
    v_cvt_pk_bf16_f32 v32, v104, v105
    v_cvt_pk_bf16_f32 v33, v106, v107
    v_cvt_pk_bf16_f32 v34, v108, v109
    v_cvt_pk_bf16_f32 v35, v110, v111
    v_mov_b32 v21, 0x3f803f80
    v_cmp_eq_u32 vcc, 4, v6
    s_nop 1
    v_cndmask_b32 v32, v32, v21, vcc
    v_cndmask_b32 v33, v33, v21, vcc
    v_cndmask_b32 v34, v34, v21, vcc
    v_cndmask_b32 v35, v35, v21, vcc
    s_mul_i32 s23, s12, 3072
    s_add_u32 s23, s23, 20480
    v_add_u32 v22, s23, v1
    ds_write_b128 v22, v[24:27] offset:0
    ds_write_b128 v22, v[28:31] offset:1024
    ds_write_b128 v22, v[32:35] offset:2048
    s_mov_b32 exec_lo, -1
    s_mov_b32 exec_hi, 0
    s_add_u32 s30, s21, 0
    buffer_store_dwordx4 v[148:151], v18, s[8:11], s30 offen offset:0 sc1
    buffer_store_dwordx4 v[152:155], v18, s[8:11], s30 offen offset:256 sc1
    buffer_store_dwordx4 v[156:159], v18, s[8:11], s30 offen offset:512 sc1
    buffer_store_dwordx4 v[160:163], v18, s[8:11], s30 offen offset:768 sc1
    buffer_store_dwordx2 v[164:165], v19, s[8:11], s30 offen sc1
    s_add_u32 s30, s21, 36864
    buffer_store_dwordx4 v[168:171], v18, s[8:11], s30 offen offset:0 sc1
    buffer_store_dwordx4 v[172:175], v18, s[8:11], s30 offen offset:256 sc1
    buffer_store_dwordx4 v[176:179], v18, s[8:11], s30 offen offset:512 sc1
    buffer_store_dwordx4 v[180:183], v18, s[8:11], s30 offen offset:768 sc1
    buffer_store_dwordx2 v[184:185], v19, s[8:11], s30 offen sc1
    s_mov_b64 exec, -1
    s_waitcnt lgkmcnt(0)
    s_barrier
    v_bfe_u32 v16, v0, 2, 2
    v_lshlrev_b32 v17, 2, v7
    v_add_u32 v16, v16, v17
    v_mul_u32_u24 v16, 152, v16
    v_and_b32 v17, 3, v0
    v_lshlrev_b32 v17, 3, v17
    v_add_u32 v16, v16, v17
    s_add_u32 s26, s12, 0
    s_min_u32 s26, s26, 14
    s_mul_i32 s30, s26, 43
    s_lshr_b32 s30, s30, 7
    s_mul_i32 s31, s30, 3
    s_sub_u32 s31, s26, s31
    s_lshl_b32 s27, s30, 5
    v_add_u32 v36, s27, v16
    s_lshl_b32 s27, s31, 10
    s_add_u32 s27, s27, 20480
    v_add_u32 v37, s27, v1
    s_add_u32 s26, s12, 4
    s_min_u32 s26, s26, 14
    s_mul_i32 s32, s26, 43
    s_lshr_b32 s32, s32, 7
    s_mul_i32 s33, s32, 3
    s_sub_u32 s33, s26, s33
    s_lshl_b32 s27, s32, 5
    v_add_u32 v38, s27, v16
    s_lshl_b32 s27, s33, 10
    s_add_u32 s27, s27, 20480
    v_add_u32 v39, s27, v1
    s_add_u32 s26, s12, 8
    s_min_u32 s26, s26, 14
    s_mul_i32 s34, s26, 43
    s_lshr_b32 s34, s34, 7
    s_mul_i32 s35, s34, 3
    s_sub_u32 s35, s26, s35
    s_lshl_b32 s27, s34, 5
    v_add_u32 v40, s27, v16
    s_lshl_b32 s27, s35, 10
    s_add_u32 s27, s27, 20480
    v_add_u32 v41, s27, v1
    s_add_u32 s26, s12, 12
    s_min_u32 s26, s26, 14
    s_mul_i32 s36, s26, 43
    s_lshr_b32 s36, s36, 7
    s_mul_i32 s37, s36, 3
    s_sub_u32 s37, s26, s37
    s_lshl_b32 s27, s36, 5
    v_add_u32 v42, s27, v16
    s_lshl_b32 s27, s37, 10
    s_add_u32 s27, s27, 20480
    v_add_u32 v43, s27, v1
    ds_read_b64_tr_b16 v[64:65], v36 offset:0
    ds_read_b64_tr_b16 v[66:67], v36 offset:2432
    ds_read_b128 v[68:71], v37 offset:0
    ds_read_b64_tr_b16 v[72:73], v36 offset:4864
    ds_read_b64_tr_b16 v[74:75], v36 offset:7296
    ds_read_b128 v[76:79], v37 offset:3072
    ds_read_b64_tr_b16 v[80:81], v36 offset:9728
    ds_read_b64_tr_b16 v[82:83], v36 offset:12160
    ds_read_b128 v[84:87], v37 offset:6144
    ds_read_b64_tr_b16 v[88:89], v36 offset:14592
    ds_read_b64_tr_b16 v[90:91], v36 offset:17024
    ds_read_b128 v[92:95], v37 offset:9216
    ds_read_b64_tr_b16 v[96:97], v38 offset:0
    ds_read_b64_tr_b16 v[98:99], v38 offset:2432
    ds_read_b128 v[100:103], v39 offset:0
    ds_read_b64_tr_b16 v[104:105], v38 offset:4864
    ds_read_b64_tr_b16 v[106:107], v38 offset:7296
    ds_read_b128 v[108:111], v39 offset:3072
    ds_read_b64_tr_b16 v[112:113], v38 offset:9728
    ds_read_b64_tr_b16 v[114:115], v38 offset:12160
    ds_read_b128 v[116:119], v39 offset:6144
    ds_read_b64_tr_b16 v[120:121], v38 offset:14592
    ds_read_b64_tr_b16 v[122:123], v38 offset:17024
    ds_read_b128 v[124:127], v39 offset:9216
    s_waitcnt lgkmcnt(12)
    v_mfma_f32_16x16x32_bf16 v[48:51], v[64:67], v[68:71], 0
    v_mfma_f32_16x16x32_bf16 v[48:51], v[72:75], v[76:79], v[48:51]
    v_mfma_f32_16x16x32_bf16 v[48:51], v[80:83], v[84:87], v[48:51]
    v_mfma_f32_16x16x32_bf16 v[48:51], v[88:91], v[92:95], v[48:51]
    ds_read_b64_tr_b16 v[128:129], v40 offset:0
    ds_read_b64_tr_b16 v[130:131], v40 offset:2432
    ds_read_b128 v[132:135], v41 offset:0
    ds_read_b64_tr_b16 v[136:137], v40 offset:4864
    ds_read_b64_tr_b16 v[138:139], v40 offset:7296
    ds_read_b128 v[140:143], v41 offset:3072
    ds_read_b64_tr_b16 v[144:145], v40 offset:9728
    ds_read_b64_tr_b16 v[146:147], v40 offset:12160
    ds_read_b128 v[148:151], v41 offset:6144
    ds_read_b64_tr_b16 v[152:153], v40 offset:14592
    ds_read_b64_tr_b16 v[154:155], v40 offset:17024
    ds_read_b128 v[156:159], v41 offset:9216
    s_waitcnt lgkmcnt(12)
    v_mfma_f32_16x16x32_bf16 v[52:55], v[96:99], v[100:103], 0
    v_mfma_f32_16x16x32_bf16 v[52:55], v[104:107], v[108:111], v[52:55]
    v_mfma_f32_16x16x32_bf16 v[52:55], v[112:115], v[116:119], v[52:55]
    v_mfma_f32_16x16x32_bf16 v[52:55], v[120:123], v[124:127], v[52:55]
    ds_read_b64_tr_b16 v[160:161], v42 offset:0
    ds_read_b64_tr_b16 v[162:163], v42 offset:2432
    ds_read_b128 v[164:167], v43 offset:0
    ds_read_b64_tr_b16 v[168:169], v42 offset:4864
    ds_read_b64_tr_b16 v[170:171], v42 offset:7296
    ds_read_b128 v[172:175], v43 offset:3072
    ds_read_b64_tr_b16 v[176:177], v42 offset:9728
    ds_read_b64_tr_b16 v[178:179], v42 offset:12160
    ds_read_b128 v[180:183], v43 offset:6144
    ds_read_b64_tr_b16 v[184:185], v42 offset:14592
    ds_read_b64_tr_b16 v[186:187], v42 offset:17024
    ds_read_b128 v[188:191], v43 offset:9216
    s_waitcnt lgkmcnt(12)
    v_mfma_f32_16x16x32_bf16 v[56:59], v[128:131], v[132:135], 0
    v_mfma_f32_16x16x32_bf16 v[56:59], v[136:139], v[140:143], v[56:59]
    v_mfma_f32_16x16x32_bf16 v[56:59], v[144:147], v[148:151], v[56:59]
    v_mfma_f32_16x16x32_bf16 v[56:59], v[152:155], v[156:159], v[56:59]
    s_lshl_b32 s26, s30, 4
    s_lshl_b32 s27, s31, 4
    v_lshlrev_b32 v17, 2, v7
    v_add_u32 v17, s26, v17
    v_add_u32 v18, s27, v6
    v_cmp_le_u32 vcc, 36, v17
    s_nop 1
    v_cndmask_b32 v19, 0, 1, vcc
    v_mul_u32_u24 v20, 36, v19
    v_sub_u32 v20, v17, v20
    v_mul_u32_u24 v21, 18, v19
    v_sub_u32 v21, v18, v21
    v_cmp_gt_u32 s[38:39], 18, v21
    v_cmp_eq_u32 s[40:41], 36, v18
    v_mov_b32 v22, 18
    s_nop 0
    v_cndmask_b32 v21, v21, v22, s[40:41]
    s_or_b64 s[38:39], s[38:39], s[40:41]
    v_cmp_gt_u32 vcc, 72, v17
    s_nop 1
    s_and_b64 s[38:39], s[38:39], vcc
    v_mul_u32_u24 v19, 684, v19
    v_mul_u32_u24 v21, 36, v21
    v_add3_u32 v19, v19, v21, v20
    v_lshlrev_b32 v19, 2, v19
    v_add_u32 v19, 36864, v19
    v_mov_b32 v22, 42368
    v_cndmask_b32 v24, v22, v19, s[38:39]
    s_waitcnt lgkmcnt(0)
    v_mfma_f32_16x16x32_bf16 v[60:63], v[160:163], v[164:167], 0
    v_mfma_f32_16x16x32_bf16 v[60:63], v[168:171], v[172:175], v[60:63]
    v_mfma_f32_16x16x32_bf16 v[60:63], v[176:179], v[180:183], v[60:63]
    v_mfma_f32_16x16x32_bf16 v[60:63], v[184:187], v[188:191], v[60:63]
    s_lshl_b32 s26, s32, 4
    s_lshl_b32 s27, s33, 4
    v_lshlrev_b32 v17, 2, v7
    v_add_u32 v17, s26, v17
    v_add_u32 v18, s27, v6
    v_cmp_le_u32 vcc, 36, v17
    s_nop 1
    v_cndmask_b32 v19, 0, 1, vcc
    v_mul_u32_u24 v20, 36, v19
    v_sub_u32 v20, v17, v20
    v_mul_u32_u24 v21, 18, v19
    v_sub_u32 v21, v18, v21
    v_cmp_gt_u32 s[38:39], 18, v21
    v_cmp_eq_u32 s[40:41], 36, v18
    v_mov_b32 v22, 18
    s_nop 0
    v_cndmask_b32 v21, v21, v22, s[40:41]
    s_or_b64 s[38:39], s[38:39], s[40:41]
    v_cmp_gt_u32 vcc, 72, v17
    s_nop 1
    s_and_b64 s[38:39], s[38:39], vcc
    v_mul_u32_u24 v19, 684, v19
    v_mul_u32_u24 v21, 36, v21
    v_add3_u32 v19, v19, v21, v20
    v_lshlrev_b32 v19, 2, v19
    v_add_u32 v19, 36864, v19
    v_mov_b32 v22, 42368
    v_cndmask_b32 v25, v22, v19, s[38:39]
    s_lshl_b32 s26, s34, 4
    s_lshl_b32 s27, s35, 4
    v_lshlrev_b32 v17, 2, v7
    v_add_u32 v17, s26, v17
    v_add_u32 v18, s27, v6
    v_cmp_le_u32 vcc, 36, v17
    s_nop 1
    v_cndmask_b32 v19, 0, 1, vcc
    v_mul_u32_u24 v20, 36, v19
    v_sub_u32 v20, v17, v20
    v_mul_u32_u24 v21, 18, v19
    v_sub_u32 v21, v18, v21
    v_cmp_gt_u32 s[38:39], 18, v21
    v_cmp_eq_u32 s[40:41], 36, v18
    v_mov_b32 v22, 18
    s_nop 0
    v_cndmask_b32 v21, v21, v22, s[40:41]
    s_or_b64 s[38:39], s[38:39], s[40:41]
    v_cmp_gt_u32 vcc, 72, v17
    s_nop 1
    s_and_b64 s[38:39], s[38:39], vcc
    v_mul_u32_u24 v19, 684, v19
    v_mul_u32_u24 v21, 36, v21
    v_add3_u32 v19, v19, v21, v20
    v_lshlrev_b32 v19, 2, v19
    v_add_u32 v19, 36864, v19
    v_mov_b32 v22, 42368
    v_cndmask_b32 v26, v22, v19, s[38:39]
    s_lshl_b32 s26, s36, 4
    s_lshl_b32 s27, s37, 4
    v_lshlrev_b32 v17, 2, v7
    v_add_u32 v17, s26, v17
    v_add_u32 v18, s27, v6
    v_cmp_le_u32 vcc, 36, v17
    s_nop 1
    v_cndmask_b32 v19, 0, 1, vcc
    v_mul_u32_u24 v20, 36, v19
    v_sub_u32 v20, v17, v20
    v_mul_u32_u24 v21, 18, v19
    v_sub_u32 v21, v18, v21
    v_cmp_gt_u32 s[38:39], 18, v21
    v_cmp_eq_u32 s[40:41], 36, v18
    v_mov_b32 v22, 18
    s_nop 0
    v_cndmask_b32 v21, v21, v22, s[40:41]
    s_or_b64 s[38:39], s[38:39], s[40:41]
    v_cmp_gt_u32 vcc, 72, v17
    s_nop 1
    s_and_b64 s[38:39], s[38:39], vcc
    v_mul_u32_u24 v19, 684, v19
    v_mul_u32_u24 v21, 36, v21
    v_add3_u32 v19, v19, v21, v20
    v_lshlrev_b32 v19, 2, v19
    v_add_u32 v19, 36864, v19
    v_mov_b32 v22, 42368
    v_cndmask_b32 v27, v22, v19, s[38:39]
    ds_write_b128 v24, v[48:51]
    ds_write_b128 v25, v[52:55]
    ds_write_b128 v26, v[56:59]
    ds_write_b128 v27, v[60:63]
    s_waitcnt lgkmcnt(0)
    s_barrier
    v_lshlrev_b32 v16, 2, v15
    v_add_u32 v17, 36864, v16
    s_mul_i32 s30, s14, 5472
    s_add_u32 s30, s30, 0x400000
    ds_read_b32 v24, v17 offset:0
    ds_read_b32 v25, v17 offset:1024
    ds_read_b32 v26, v17 offset:2048
    ds_read_b32 v27, v17 offset:3072
    ds_read_b32 v28, v17 offset:4096
    ds_read_b32 v29, v17 offset:5120
    v_mov_b32 v18, 0x7f000000
    v_cmp_gt_u32 vcc, 88, v15
    s_nop 1
    v_add_u32 v19, 1024, v16
    v_cndmask_b32 v19, v18, v19, vcc
    s_waitcnt lgkmcnt(0)
    buffer_atomic_add_f32 v24, v16, s[8:11], s30 offen offset:0
    buffer_atomic_add_f32 v25, v16, s[8:11], s30 offen offset:1024
    buffer_atomic_add_f32 v26, v16, s[8:11], s30 offen offset:2048
    buffer_atomic_add_f32 v27, v16, s[8:11], s30 offen offset:3072
    s_add_u32 s30, s30, 4096
    buffer_atomic_add_f32 v28, v16, s[8:11], s30 offen
    buffer_atomic_add_f32 v29, v19, s[8:11], s30 offen
    s_add_u32 s2, s2, 72
    s_endpgm
L_k1_kernel_bg:
    s_cmp_lt_u32 s2, 72
    s_cbranch_scc1 L_k1_kernel_fold
    s_cmp_lt_u32 s2, 348
    s_cbranch_scc1 L_k1_kernel_wbar
    s_cmp_lt_u32 s2, 364
    s_cbranch_scc1 L_k1_kernel_wo
    s_cmp_lt_u32 s2, 508
    s_cbranch_scc1 L_k1_kernel_wgu
    s_cmp_lt_u32 s2, 580
    s_cbranch_scc1 L_k1_kernel_wd
    s_endpgm
L_k1_kernel_fold:
    s_sub_u32 s3, s2, 0
    s_setprio 3
    s_lshr_b32 s13, s3, 2
    s_and_b32 s15, s3, 3
    s_lshl_b32 s14, s15, 2
    s_add_u32 s14, s14, s12
    v_mul_u32_u24 v4, 3641, v0
    v_lshrrev_b32 v4, 16, v4
    v_mul_u32_u24 v5, 18, v4
    v_sub_u32 v5, v0, v5
    v_mul_u32_u24 v6, 1152, v4
    v_lshlrev_b32 v5, 4, v5
    v_add_u32 v6, v6, v5
    v_mov_b32 v7, 0x7f000000
    v_cmp_gt_u32 vcc, 54, v0
    s_nop 1
    v_cndmask_b32 v6, v7, v6, vcc
    s_mul_i32 s24, s13, 110592
    s_mul_i32 s25, s15, 288
    s_add_u32 s24, s24, s25
    s_mul_i32 s25, s12, 27648
    s_add_u32 s24, s24, s25
    s_mul_i32 s25, s12, 8320
    s_add_u32 s25, s25, 2048
    s_waitcnt lgkmcnt(0)
    s_mov_b32 s16, s36
    s_mov_b32 s17, s37
    s_mov_b32 s18, 1990656
    s_mov_b32 s19, 0x00020000
    s_mov_b32 s20, s38
    s_mov_b32 s21, s39
    s_mov_b32 s22, 20736
    s_mov_b32 s23, 0x00020000
    s_add_u32 m0, s25, 0
    s_add_u32 s26, s24, 0
    buffer_load_dwordx4 v6, s[16:19], s26 offen nt lds
    s_add_u32 m0, s25, 1040
    s_add_u32 s26, s24, 3456
    buffer_load_dwordx4 v6, s[16:19], s26 offen nt lds
    s_add_u32 m0, s25, 2080
    s_add_u32 s26, s24, 6912
    buffer_load_dwordx4 v6, s[16:19], s26 offen nt lds
    s_add_u32 m0, s25, 3120
    s_add_u32 s26, s24, 10368
    buffer_load_dwordx4 v6, s[16:19], s26 offen nt lds
    s_add_u32 m0, s25, 4160
    s_add_u32 s26, s24, 13824
    buffer_load_dwordx4 v6, s[16:19], s26 offen nt lds
    s_add_u32 m0, s25, 5200
    s_add_u32 s26, s24, 17280
    buffer_load_dwordx4 v6, s[16:19], s26 offen nt lds
    s_add_u32 m0, s25, 6240
    s_add_u32 s26, s24, 20736
    buffer_load_dwordx4 v6, s[16:19], s26 offen nt lds
    s_add_u32 m0, s25, 7280
    s_add_u32 s26, s24, 24192
    buffer_load_dwordx4 v6, s[16:19], s26 offen nt lds
    s_mul_i32 s26, s14, 1296
    v_add_u32 v64, 0, v0
    v_mul_u32_u24 v65, 7282, v64
    v_lshrrev_b32 v65, 16, v65
    v_mul_u32_u24 v66, 9, v65
    v_sub_u32 v66, v64, v66
    v_mul_u32_u24 v67, 36, v65
    v_lshlrev_b32 v68, 2, v66
    v_add_u32 v67, v67, v68
    v_mul_u32_u24 v80, 40, v65
    v_add_u32 v80, v80, v68
    buffer_load_dword v72, v67, s[20:23], s26 offen
    v_add_u32 v64, 64, v0
    v_mul_u32_u24 v65, 7282, v64
    v_lshrrev_b32 v65, 16, v65
    v_mul_u32_u24 v66, 9, v65
    v_sub_u32 v66, v64, v66
    v_mul_u32_u24 v67, 36, v65
    v_lshlrev_b32 v68, 2, v66
    v_add_u32 v67, v67, v68
    v_mul_u32_u24 v81, 40, v65
    v_add_u32 v81, v81, v68
    buffer_load_dword v73, v67, s[20:23], s26 offen
    v_add_u32 v64, 128, v0
    v_mul_u32_u24 v65, 7282, v64
    v_lshrrev_b32 v65, 16, v65
    v_mul_u32_u24 v66, 9, v65
    v_sub_u32 v66, v64, v66
    v_mul_u32_u24 v67, 36, v65
    v_lshlrev_b32 v68, 2, v66
    v_add_u32 v67, v67, v68
    v_mul_u32_u24 v82, 40, v65
    v_add_u32 v82, v82, v68
    buffer_load_dword v74, v67, s[20:23], s26 offen
    v_add_u32 v64, 192, v0
    v_mul_u32_u24 v65, 7282, v64
    v_lshrrev_b32 v65, 16, v65
    v_mul_u32_u24 v66, 9, v65
    v_sub_u32 v66, v64, v66
    v_mul_u32_u24 v67, 36, v65
    v_lshlrev_b32 v68, 2, v66
    v_add_u32 v67, v67, v68
    v_mul_u32_u24 v83, 40, v65
    v_add_u32 v83, v83, v68
    buffer_load_dword v75, v67, s[20:23], s26 offen
    v_add_u32 v64, 256, v0
    v_mul_u32_u24 v65, 7282, v64
    v_lshrrev_b32 v65, 16, v65
    v_mul_u32_u24 v66, 9, v65
    v_sub_u32 v66, v64, v66
    v_mul_u32_u24 v67, 36, v65
    v_lshlrev_b32 v68, 2, v66
    v_add_u32 v67, v67, v68
    v_mul_u32_u24 v84, 40, v65
    v_add_u32 v84, v84, v68
    buffer_load_dword v76, v67, s[20:23], s26 offen
    v_add_u32 v64, 320, v0
    v_mul_u32_u24 v65, 7282, v64
    v_lshrrev_b32 v65, 16, v65
    v_mul_u32_u24 v66, 9, v65
    v_sub_u32 v66, v64, v66
    v_mul_u32_u24 v67, 36, v65
    v_lshlrev_b32 v68, 2, v66
    v_add_u32 v67, v67, v68
    v_mul_u32_u24 v85, 40, v65
    v_add_u32 v85, v85, v68
    v_mov_b32 v69, 0x7f000000
    v_cmp_gt_u32 vcc, 324, v64
    s_nop 1
    v_cndmask_b32 v67, v69, v67, vcc
    v_mov_b32 v69, 1500
    v_cndmask_b32 v85, v69, v85, vcc
    buffer_load_dword v77, v67, s[20:23], s26 offen
    s_cmp_lg_u32 s12, 0
    s_cbranch_scc1 L_ni5
    v_mov_b32 v13, 0
    buffer_load_dword v14, v13, s[92:95], 0 offen sc1
L_ni5:
    v_mov_b32 v100, 0
    v_mov_b32 v101, 0
    v_mov_b32 v102, 0
    v_mov_b32 v103, 0
    s_mul_i32 s29, s15, 21888
    s_mul_i32 s30, s13, 1216
    s_add_u32 s29, s29, s30
    s_add_u32 s29, s29, 0x400000
    s_movk_i32 s31, 76
    s_cmp_eq_u32 s3, 71
    s_cselect_b32 s30, 236, s31
    v_lshlrev_b32 v104, 4, v15
    v_mov_b32 v105, 0x7f000000
    v_cmp_gt_u32 vcc, s30, v15
    s_nop 1
    v_cndmask_b32 v104, v105, v104, vcc
    buffer_store_dwordx4 v[100:103], v104, s[8:11], s29 offen sc1
    s_mul_i32 s27, s12, 1536
    s_add_u32 s27, s27, 35328
    v_mov_b32 v12, 0
    v_lshlrev_b32 v13, 2, v0
    v_add_u32 v13, s27, v13
    ds_write_b32 v13, v12 offset:0
    ds_write_b32 v13, v12 offset:256
    ds_write_b32 v13, v12 offset:512
    ds_write_b32 v13, v12 offset:768
    ds_write_b32 v13, v12 offset:1024
    ds_write_b32 v13, v12 offset:1280
    v_add_u32 v80, s27, v80
    v_add_u32 v81, s27, v81
    v_add_u32 v82, s27, v82
    v_add_u32 v83, s27, v83
    v_add_u32 v84, s27, v84
    v_add_u32 v85, s27, v85
    v_lshrrev_b32 v7, 4, v0
    v_bfe_u32 v4, v0, 2, 2
    v_and_b32 v5, 3, v0
    v_lshlrev_b32 v6, 3, v7
    v_add_u32 v6, v6, v4
    v_and_b32 v8, 1, v5
    v_mul_u32_u24 v9, 18, v8
    v_lshrrev_b32 v10, 1, v5
    v_mul_u32_u24 v10, 48, v10
    v_add_u32 v9, v9, v10
    v_mul_u32_u24 v10, 720, v8
    v_add_u32 v11, 0, v6
    v_sub_u32 v11, v11, v9
    v_mul_u32_u24 v12, 40, v11
    v_add_u32 v12, v12, v10
    v_mov_b32 v13, 1440
    v_cmp_gt_u32 vcc, 18, v11
    s_nop 1
    v_cndmask_b32 v200, v13, v12, vcc
    v_add_u32 v200, s27, v200
    v_add_u32 v11, 4, v6
    v_sub_u32 v11, v11, v9
    v_mul_u32_u24 v12, 40, v11
    v_add_u32 v12, v12, v10
    v_mov_b32 v13, 1440
    v_cmp_gt_u32 vcc, 18, v11
    s_nop 1
    v_cndmask_b32 v201, v13, v12, vcc
    v_add_u32 v201, s27, v201
    v_add_u32 v11, 32, v6
    v_sub_u32 v11, v11, v9
    v_mul_u32_u24 v12, 40, v11
    v_add_u32 v12, v12, v10
    v_mov_b32 v13, 1440
    v_cmp_gt_u32 vcc, 18, v11
    s_nop 1
    v_cndmask_b32 v202, v13, v12, vcc
    v_add_u32 v202, s27, v202
    v_add_u32 v11, 36, v6
    v_sub_u32 v11, v11, v9
    v_mul_u32_u24 v12, 40, v11
    v_add_u32 v12, v12, v10
    v_mov_b32 v13, 1440
    v_cmp_gt_u32 vcc, 18, v11
    s_nop 1
    v_cndmask_b32 v203, v13, v12, vcc
    v_add_u32 v203, s27, v203
    v_add_u32 v11, 64, v6
    v_sub_u32 v11, v11, v9
    v_mul_u32_u24 v12, 40, v11
    v_add_u32 v12, v12, v10
    v_mov_b32 v13, 1440
    v_cmp_gt_u32 vcc, 18, v11
    s_nop 1
    v_cndmask_b32 v204, v13, v12, vcc
    v_add_u32 v204, s27, v204
    v_add_u32 v11, 68, v6
    v_sub_u32 v11, v11, v9
    v_mul_u32_u24 v12, 40, v11
    v_add_u32 v12, v12, v10
    v_mov_b32 v13, 1440
    v_cmp_gt_u32 vcc, 18, v11
    s_nop 1
    v_cndmask_b32 v205, v13, v12, vcc
    v_add_u32 v205, s27, v205
    v_bfe_u32 v4, v0, 2, 2
    v_and_b32 v5, 3, v0
    v_lshlrev_b32 v4, 3, v4
    v_add_u32 v4, v4, v5
    v_mul_u32_u24 v4, 1040, v4
    v_lshlrev_b32 v8, 4, v7
    v_add_u32 v4, v4, v8
    s_mul_i32 s28, s12, 72
    s_add_u32 s28, s28, 2048
    v_add_u32 v206, s28, v4
    v_add_u32 v10, 64, v206
    v_add_u32 v11, 256, v206
    v_cmp_gt_u32 vcc, 2, v7
    s_nop 1
    v_cndmask_b32 v207, v11, v10, vcc
    v_and_b32 v4, 15, v0
    v_lshlrev_b32 v5, 3, v7
    v_sub_u32 v4, v4, v5
    v_mov_b32 v8, 0x3f80
    v_mov_b32 v9, 0x3f800000
    v_add_u32 v5, 0, v4
    v_cmp_eq_u32 vcc, 0, v5
    v_cmp_eq_u32 s[28:29], 1, v5
    s_nop 1
    v_cndmask_b32 v124, 0, v8, vcc
    v_cndmask_b32 v124, v124, v9, s[28:29]
    v_cmp_eq_u32 vcc, 2, v5
    v_cmp_eq_u32 s[28:29], 3, v5
    s_nop 1
    v_cndmask_b32 v125, 0, v8, vcc
    v_cndmask_b32 v125, v125, v9, s[28:29]
    v_cmp_eq_u32 vcc, 4, v5
    v_cmp_eq_u32 s[28:29], 5, v5
    s_nop 1
    v_cndmask_b32 v126, 0, v8, vcc
    v_cndmask_b32 v126, v126, v9, s[28:29]
    v_cmp_eq_u32 vcc, 6, v5
    v_cmp_eq_u32 s[28:29], 7, v5
    s_nop 1
    v_cndmask_b32 v127, 0, v8, vcc
    v_cndmask_b32 v127, v127, v9, s[28:29]
    v_add_u32 v5, 16, v4
    v_cmp_eq_u32 vcc, 0, v5
    v_cmp_eq_u32 s[28:29], 1, v5
    s_nop 1
    v_cndmask_b32 v128, 0, v8, vcc
    v_cndmask_b32 v128, v128, v9, s[28:29]
    v_cmp_eq_u32 vcc, 2, v5
    v_cmp_eq_u32 s[28:29], 3, v5
    s_nop 1
    v_cndmask_b32 v129, 0, v8, vcc
    v_cndmask_b32 v129, v129, v9, s[28:29]
    v_cmp_eq_u32 vcc, 4, v5
    v_cmp_eq_u32 s[28:29], 5, v5
    s_nop 1
    v_cndmask_b32 v130, 0, v8, vcc
    v_cndmask_b32 v130, v130, v9, s[28:29]
    v_cmp_eq_u32 vcc, 6, v5
    v_cmp_eq_u32 s[28:29], 7, v5
    s_nop 1
    v_cndmask_b32 v131, 0, v8, vcc
    v_cndmask_b32 v131, v131, v9, s[28:29]
    v_add_u32 v5, 0, v4
    v_and_b32 v6, 15, v0
    v_cmp_lt_u32 vcc, 3, v6
    v_mov_b32 v10, 99
    s_nop 0
    v_cndmask_b32 v5, v5, v10, vcc
    v_cmp_eq_u32 vcc, 0, v5
    v_cmp_eq_u32 s[28:29], 1, v5
    s_nop 1
    v_cndmask_b32 v132, 0, v8, vcc
    v_cndmask_b32 v132, v132, v9, s[28:29]
    v_cmp_eq_u32 vcc, 2, v5
    v_cmp_eq_u32 s[28:29], 3, v5
    s_nop 1
    v_cndmask_b32 v133, 0, v8, vcc
    v_cndmask_b32 v133, v133, v9, s[28:29]
    v_cmp_eq_u32 vcc, 4, v5
    v_cmp_eq_u32 s[28:29], 5, v5
    s_nop 1
    v_cndmask_b32 v134, 0, v8, vcc
    v_cndmask_b32 v134, v134, v9, s[28:29]
    v_cmp_eq_u32 vcc, 6, v5
    v_cmp_eq_u32 s[28:29], 7, v5
    s_nop 1
    v_cndmask_b32 v135, 0, v8, vcc
    v_cndmask_b32 v135, v135, v9, s[28:29]
    s_waitcnt vmcnt(0) lgkmcnt(0)
    ds_write_b32 v80, v72
    ds_write_b32 v81, v73
    ds_write_b32 v82, v74
    ds_write_b32 v83, v75
    ds_write_b32 v84, v76
    ds_write_b32 v85, v77
    s_waitcnt lgkmcnt(0)
    s_barrier
    ds_read_b64 v[16:17], v206 offset:0
    ds_read_b64 v[18:19], v206 offset:8
    ds_read_b64 v[24:25], v207 offset:0
    ds_read_b64 v[26:27], v207 offset:8
    ds_read_b64 v[32:33], v206 offset:320
    ds_read_b64 v[34:35], v206 offset:328
    s_waitcnt lgkmcnt(6)
    ds_read_b64 v[40:41], v206 offset:576
    ds_read_b64 v[42:43], v206 offset:584
    ds_read_b64 v[48:49], v206 offset:640
    ds_read_b64 v[50:51], v206 offset:648
    s_waitcnt lgkmcnt(4)
    ds_read_b64 v[20:21], v206 offset:4160
    ds_read_b64 v[22:23], v206 offset:4168
    ds_read_b64 v[28:29], v207 offset:4160
    ds_read_b64 v[30:31], v207 offset:4168
    ds_read_b64 v[36:37], v206 offset:4480
    ds_read_b64 v[38:39], v206 offset:4488
    s_waitcnt lgkmcnt(6)
    ds_read_b64 v[44:45], v206 offset:4736
    ds_read_b64 v[46:47], v206 offset:4744
    ds_read_b64 v[52:53], v206 offset:4800
    ds_read_b64 v[54:55], v206 offset:4808
    s_waitcnt lgkmcnt(4)
    ds_read_b64_tr_b16 v[64:65], v200 offset:0
    ds_read_b64_tr_b16 v[76:77], v200 offset:8
    ds_read_b64_tr_b16 v[88:89], v200 offset:16
    ds_read_b64_tr_b16 v[100:101], v200 offset:24
    ds_read_b64_tr_b16 v[112:113], v200 offset:32
    ds_read_b64_tr_b16 v[66:67], v201 offset:0
    ds_read_b64_tr_b16 v[78:79], v201 offset:8
    ds_read_b64_tr_b16 v[90:91], v201 offset:16
    ds_read_b64_tr_b16 v[102:103], v201 offset:24
    ds_read_b64_tr_b16 v[114:115], v201 offset:32
    s_waitcnt lgkmcnt(4)
    ds_read_b64_tr_b16 v[68:69], v202 offset:0
    ds_read_b64_tr_b16 v[80:81], v202 offset:8
    ds_read_b64_tr_b16 v[92:93], v202 offset:16
    ds_read_b64_tr_b16 v[104:105], v202 offset:24
    ds_read_b64_tr_b16 v[116:117], v202 offset:32
    ds_read_b64_tr_b16 v[70:71], v203 offset:0
    ds_read_b64_tr_b16 v[82:83], v203 offset:8
    ds_read_b64_tr_b16 v[94:95], v203 offset:16
    ds_read_b64_tr_b16 v[106:107], v203 offset:24
    ds_read_b64_tr_b16 v[118:119], v203 offset:32
    s_waitcnt lgkmcnt(4)
    ds_read_b64_tr_b16 v[72:73], v204 offset:0
    ds_read_b64_tr_b16 v[84:85], v204 offset:8
    ds_read_b64_tr_b16 v[96:97], v204 offset:16
    ds_read_b64_tr_b16 v[108:109], v204 offset:24
    ds_read_b64_tr_b16 v[120:121], v204 offset:32
    ds_read_b64_tr_b16 v[74:75], v205 offset:0
    ds_read_b64_tr_b16 v[86:87], v205 offset:8
    ds_read_b64_tr_b16 v[98:99], v205 offset:16
    ds_read_b64_tr_b16 v[110:111], v205 offset:24
    ds_read_b64_tr_b16 v[122:123], v205 offset:32
    s_waitcnt lgkmcnt(0)
    v_mfma_f32_16x16x32_bf16 v[136:139], v[16:19], v[64:67], 0
    v_mfma_f32_16x16x32_bf16 v[140:143], v[20:23], v[64:67], 0
    v_mfma_f32_16x16x32_bf16 v[136:139], v[24:27], v[68:71], v[136:139]
    v_mfma_f32_16x16x32_bf16 v[140:143], v[28:31], v[68:71], v[140:143]
    v_mfma_f32_16x16x32_bf16 v[136:139], v[32:35], v[72:75], v[136:139]
    v_mfma_f32_16x16x32_bf16 v[140:143], v[36:39], v[72:75], v[140:143]
    v_mfma_f32_16x16x32_bf16 v[144:147], v[16:19], v[76:79], 0
    v_mfma_f32_16x16x32_bf16 v[148:151], v[20:23], v[76:79], 0
    v_mfma_f32_16x16x32_bf16 v[144:147], v[24:27], v[80:83], v[144:147]
    v_mfma_f32_16x16x32_bf16 v[148:151], v[28:31], v[80:83], v[148:151]
    v_mfma_f32_16x16x32_bf16 v[144:147], v[32:35], v[84:87], v[144:147]
    v_mfma_f32_16x16x32_bf16 v[148:151], v[36:39], v[84:87], v[148:151]
    v_mfma_f32_16x16x32_bf16 v[152:155], v[16:19], v[88:91], 0
    v_mfma_f32_16x16x32_bf16 v[156:159], v[20:23], v[88:91], 0
    v_mfma_f32_16x16x32_bf16 v[152:155], v[24:27], v[92:95], v[152:155]
    v_mfma_f32_16x16x32_bf16 v[156:159], v[28:31], v[92:95], v[156:159]
    v_mfma_f32_16x16x32_bf16 v[152:155], v[32:35], v[96:99], v[152:155]
    v_mfma_f32_16x16x32_bf16 v[156:159], v[36:39], v[96:99], v[156:159]
    v_mfma_f32_16x16x32_bf16 v[160:163], v[16:19], v[100:103], 0
    v_mfma_f32_16x16x32_bf16 v[164:167], v[20:23], v[100:103], 0
    v_mfma_f32_16x16x32_bf16 v[160:163], v[24:27], v[104:107], v[160:163]
    v_mfma_f32_16x16x32_bf16 v[164:167], v[28:31], v[104:107], v[164:167]
    v_mfma_f32_16x16x32_bf16 v[160:163], v[32:35], v[108:111], v[160:163]
    v_mfma_f32_16x16x32_bf16 v[164:167], v[36:39], v[108:111], v[164:167]
    v_mfma_f32_16x16x32_bf16 v[168:171], v[16:19], v[112:115], 0
    v_mfma_f32_16x16x32_bf16 v[172:175], v[20:23], v[112:115], 0
    v_mfma_f32_16x16x32_bf16 v[168:171], v[24:27], v[116:119], v[168:171]
    v_mfma_f32_16x16x32_bf16 v[172:175], v[28:31], v[116:119], v[172:175]
    v_mfma_f32_16x16x32_bf16 v[168:171], v[32:35], v[120:123], v[168:171]
    v_mfma_f32_16x16x32_bf16 v[172:175], v[36:39], v[120:123], v[172:175]
    v_mfma_f32_16x16x32_bf16 v[176:179], v[40:43], v[124:127], 0
    v_mfma_f32_16x16x32_bf16 v[180:183], v[44:47], v[124:127], 0
    v_mfma_f32_16x16x32_bf16 v[184:187], v[40:43], v[128:131], 0
    v_mfma_f32_16x16x32_bf16 v[188:191], v[44:47], v[128:131], 0
    v_mfma_f32_16x16x32_bf16 v[192:195], v[48:51], v[132:135], 0
    v_mfma_f32_16x16x32_bf16 v[196:199], v[52:55], v[132:135], 0
    s_mul_i32 s26, s14, 147456
    s_lshl_b32 s27, s13, 13
    s_add_u32 s26, s26, s27
    s_add_u32 s26, s26, 0x0
    s_nop 3
    v_cvt_pk_bf16_f32 v16, v136, v137
    v_cvt_pk_bf16_f32 v17, v138, v139
    v_cvt_pk_bf16_f32 v18, v140, v141
    v_cvt_pk_bf16_f32 v19, v142, v143
    buffer_store_dwordx4 v[16:19], v1, s[8:11], s26 offen offset:0 sc1
    v_cvt_pk_bf16_f32 v20, v144, v145
    v_cvt_pk_bf16_f32 v21, v146, v147
    v_cvt_pk_bf16_f32 v22, v148, v149
    v_cvt_pk_bf16_f32 v23, v150, v151
    buffer_store_dwordx4 v[20:23], v1, s[8:11], s26 offen offset:1024 sc1
    v_cvt_pk_bf16_f32 v24, v152, v153
    v_cvt_pk_bf16_f32 v25, v154, v155
    v_cvt_pk_bf16_f32 v26, v156, v157
    v_cvt_pk_bf16_f32 v27, v158, v159
    buffer_store_dwordx4 v[24:27], v1, s[8:11], s26 offen offset:2048 sc1
    v_cvt_pk_bf16_f32 v28, v160, v161
    v_cvt_pk_bf16_f32 v29, v162, v163
    v_cvt_pk_bf16_f32 v30, v164, v165
    v_cvt_pk_bf16_f32 v31, v166, v167
    buffer_store_dwordx4 v[28:31], v1, s[8:11], s26 offen offset:3072 sc1
    v_cvt_pk_bf16_f32 v32, v168, v169
    v_cvt_pk_bf16_f32 v33, v170, v171
    v_cvt_pk_bf16_f32 v34, v172, v173
    v_cvt_pk_bf16_f32 v35, v174, v175
    s_add_u32 s26, s26, 4096
    buffer_store_dwordx4 v[32:35], v1, s[8:11], s26 offen offset:0 sc1
    v_cvt_pk_bf16_f32 v36, v176, v177
    v_cvt_pk_bf16_f32 v37, v178, v179
    v_cvt_pk_bf16_f32 v38, v180, v181
    v_cvt_pk_bf16_f32 v39, v182, v183
    buffer_store_dwordx4 v[36:39], v1, s[8:11], s26 offen offset:1024 sc1
    v_cvt_pk_bf16_f32 v40, v184, v185
    v_cvt_pk_bf16_f32 v41, v186, v187
    v_cvt_pk_bf16_f32 v42, v188, v189
    v_cvt_pk_bf16_f32 v43, v190, v191
    buffer_store_dwordx4 v[40:43], v1, s[8:11], s26 offen offset:2048 sc1
    v_cvt_pk_bf16_f32 v44, v192, v193
    v_cvt_pk_bf16_f32 v45, v194, v195
    v_cvt_pk_bf16_f32 v46, v196, v197
    v_cvt_pk_bf16_f32 v47, v198, v199
    buffer_store_dwordx4 v[44:47], v1, s[8:11], s26 offen offset:3072 sc1
    s_lshl_b32 s87, s3, 7
    s_add_u32 s87, s87, 0x4804000
    s_cmp_lg_u32 s12, 0
    s_cbranch_scc1 L_gn6
    s_waitcnt vmcnt(0)
    s_mov_b32 s88, 0
    v_mov_b32 v13, 0
L_gl6:
    v_readfirstlane_b32 s86, v14
    s_nop 3
    s_cmp_lg_u32 s86, 0
    s_cbranch_scc1 L_gn6
    buffer_load_dword v14, v13, s[92:95], 0 offen sc1
    s_add_u32 s88, s88, 1
    s_waitcnt vmcnt(0)
    s_cmp_lt_u32 s88, 1048576
    s_cbranch_scc1 L_gl6
L_gn6:
    s_waitcnt vmcnt(0)
    s_barrier
    s_cmp_lg_u32 s12, 0
    s_cbranch_scc1 L_sig7
    v_mov_b32 v4, 0
    v_mov_b32 v5, s86
    s_mov_b64 exec, 1
    buffer_store_dword v5, v4, s[8:11], s87 offen sc1
    s_mov_b64 exec, -1
L_sig7:
    s_endpgm
L_k1_kernel_wbar:
    s_sub_u32 s3, s2, 328
    s_cmp_lg_u32 s12, 0
    s_cbranch_scc1 L_k1_kernel_wbar_done
    s_mul_i32 s14, s3, 52429
    s_lshr_b32 s14, s14, 18
    s_mul_i32 s15, s14, 5
    s_sub_u32 s15, s3, s15
    s_load_dwordx2 s[16:17], s[0:1], 24
    s_waitcnt lgkmcnt(0)
    s_mov_b32 s18, 663552
    s_mov_b32 s19, 0x00020000
    v_bfe_u32 v4, v0, 2, 2
    v_and_b32 v5, 3, v0
    v_lshrrev_b32 v7, 4, v0
    v_lshlrev_b32 v7, 4, v7
    s_lshl_b32 s24, s15, 3
    s_add_u32 s24, s24, 0
    v_add_u32 v8, s24, v5
    v_mul_u32_u24 v9, 13108, v8
    v_lshrrev_b32 v9, 16, v9
    v_mul_u32_u24 v10, 5, v9
    v_sub_u32 v10, v8, v10
    v_mul_u32_u24 v11, 5, v4
    v_add_u32 v10, v10, v11
    s_lshl_b32 s25, s14, 3
    v_add_u32 v9, s25, v9
    v_mul_u32_u24 v9, 18, v9
    v_add_u32 v9, v9, v10
    v_mul_u32_u24 v9, 1152, v9
    v_add_u32 v9, v9, v7
    v_mov_b32 v11, 0x7f000000
    v_cmp_gt_u32 vcc, 18, v10
    s_nop 1
    v_cndmask_b32 v12, v11, v9, vcc
    s_lshl_b32 s24, s15, 3
    s_add_u32 s24, s24, 4
    v_add_u32 v8, s24, v5
    v_mul_u32_u24 v9, 13108, v8
    v_lshrrev_b32 v9, 16, v9
    v_mul_u32_u24 v10, 5, v9
    v_sub_u32 v10, v8, v10
    v_mul_u32_u24 v11, 5, v4
    v_add_u32 v10, v10, v11
    s_lshl_b32 s25, s14, 3
    v_add_u32 v9, s25, v9
    v_mul_u32_u24 v9, 18, v9
    v_add_u32 v9, v9, v10
    v_mul_u32_u24 v9, 1152, v9
    v_add_u32 v9, v9, v7
    v_mov_b32 v11, 0x7f000000
    v_cmp_gt_u32 vcc, 18, v10
    s_nop 1
    v_cndmask_b32 v13, v11, v9, vcc
    buffer_load_dwordx4 v[16:19], v12, s[16:19], 0 offen offset:0
    buffer_load_dwordx4 v[20:23], v12, s[16:19], 0 offen offset:64
    buffer_load_dwordx4 v[24:27], v12, s[16:19], 0 offen offset:128
    buffer_load_dwordx4 v[28:31], v12, s[16:19], 0 offen offset:192
    buffer_load_dwordx4 v[32:35], v12, s[16:19], 0 offen offset:256
    buffer_load_dwordx4 v[36:39], v12, s[16:19], 0 offen offset:320
    buffer_load_dwordx4 v[40:43], v12, s[16:19], 0 offen offset:384
    buffer_load_dwordx4 v[44:47], v12, s[16:19], 0 offen offset:448
    buffer_load_dwordx4 v[48:51], v12, s[16:19], 0 offen offset:512
    buffer_load_dwordx4 v[52:55], v12, s[16:19], 0 offen offset:576
    buffer_load_dwordx4 v[56:59], v12, s[16:19], 0 offen offset:640
    buffer_load_dwordx4 v[60:63], v12, s[16:19], 0 offen offset:704
    buffer_load_dwordx4 v[64:67], v12, s[16:19], 0 offen offset:768
    buffer_load_dwordx4 v[68:71], v12, s[16:19], 0 offen offset:832
    buffer_load_dwordx4 v[72:75], v12, s[16:19], 0 offen offset:896
    buffer_load_dwordx4 v[76:79], v12, s[16:19], 0 offen offset:960
    buffer_load_dwordx4 v[80:83], v12, s[16:19], 0 offen offset:1024
    buffer_load_dwordx4 v[84:87], v12, s[16:19], 0 offen offset:1088
    buffer_load_dwordx4 v[88:91], v13, s[16:19], 0 offen offset:0
    buffer_load_dwordx4 v[92:95], v13, s[16:19], 0 offen offset:64
    buffer_load_dwordx4 v[96:99], v13, s[16:19], 0 offen offset:128
    buffer_load_dwordx4 v[100:103], v13, s[16:19], 0 offen offset:192
    buffer_load_dwordx4 v[104:107], v13, s[16:19], 0 offen offset:256
    buffer_load_dwordx4 v[108:111], v13, s[16:19], 0 offen offset:320
    buffer_load_dwordx4 v[112:115], v13, s[16:19], 0 offen offset:384
    buffer_load_dwordx4 v[116:119], v13, s[16:19], 0 offen offset:448
    buffer_load_dwordx4 v[120:123], v13, s[16:19], 0 offen offset:512
    buffer_load_dwordx4 v[124:127], v13, s[16:19], 0 offen offset:576
    buffer_load_dwordx4 v[128:131], v13, s[16:19], 0 offen offset:640
    buffer_load_dwordx4 v[132:135], v13, s[16:19], 0 offen offset:704
    buffer_load_dwordx4 v[136:139], v13, s[16:19], 0 offen offset:768
    buffer_load_dwordx4 v[140:143], v13, s[16:19], 0 offen offset:832
    buffer_load_dwordx4 v[144:147], v13, s[16:19], 0 offen offset:896
    buffer_load_dwordx4 v[148:151], v13, s[16:19], 0 offen offset:960
    buffer_load_dwordx4 v[152:155], v13, s[16:19], 0 offen offset:1024
    buffer_load_dwordx4 v[156:159], v13, s[16:19], 0 offen offset:1088
    v_mov_b32 v160, 0x3f803f80
    v_mov_b32 v161, 0x3f803f80
    v_mov_b32 v162, 0x3f803f80
    v_mov_b32 v163, 0x3f803f80
    s_waitcnt vmcnt(0)
    v_mfma_f32_16x16x32_bf16 v[164:167], v[16:19], v[160:163], 0
    v_mfma_f32_16x16x32_bf16 v[164:167], v[20:23], v[160:163], v[164:167]
    v_mfma_f32_16x16x32_bf16 v[164:167], v[24:27], v[160:163], v[164:167]
    v_mfma_f32_16x16x32_bf16 v[164:167], v[28:31], v[160:163], v[164:167]
    v_mfma_f32_16x16x32_bf16 v[164:167], v[32:35], v[160:163], v[164:167]
    v_mfma_f32_16x16x32_bf16 v[164:167], v[36:39], v[160:163], v[164:167]
    v_mfma_f32_16x16x32_bf16 v[164:167], v[40:43], v[160:163], v[164:167]
    v_mfma_f32_16x16x32_bf16 v[164:167], v[44:47], v[160:163], v[164:167]
    v_mfma_f32_16x16x32_bf16 v[164:167], v[48:51], v[160:163], v[164:167]
    v_mfma_f32_16x16x32_bf16 v[164:167], v[52:55], v[160:163], v[164:167]
    v_mfma_f32_16x16x32_bf16 v[164:167], v[56:59], v[160:163], v[164:167]
    v_mfma_f32_16x16x32_bf16 v[164:167], v[60:63], v[160:163], v[164:167]
    v_mfma_f32_16x16x32_bf16 v[164:167], v[64:67], v[160:163], v[164:167]
    v_mfma_f32_16x16x32_bf16 v[164:167], v[68:71], v[160:163], v[164:167]
    v_mfma_f32_16x16x32_bf16 v[164:167], v[72:75], v[160:163], v[164:167]
    v_mfma_f32_16x16x32_bf16 v[164:167], v[76:79], v[160:163], v[164:167]
    v_mfma_f32_16x16x32_bf16 v[164:167], v[80:83], v[160:163], v[164:167]
    v_mfma_f32_16x16x32_bf16 v[164:167], v[84:87], v[160:163], v[164:167]
    v_mfma_f32_16x16x32_bf16 v[168:171], v[88:91], v[160:163], 0
    v_mfma_f32_16x16x32_bf16 v[168:171], v[92:95], v[160:163], v[168:171]
    v_mfma_f32_16x16x32_bf16 v[168:171], v[96:99], v[160:163], v[168:171]
    v_mfma_f32_16x16x32_bf16 v[168:171], v[100:103], v[160:163], v[168:171]
    v_mfma_f32_16x16x32_bf16 v[168:171], v[104:107], v[160:163], v[168:171]
    v_mfma_f32_16x16x32_bf16 v[168:171], v[108:111], v[160:163], v[168:171]
    v_mfma_f32_16x16x32_bf16 v[168:171], v[112:115], v[160:163], v[168:171]
    v_mfma_f32_16x16x32_bf16 v[168:171], v[116:119], v[160:163], v[168:171]
    v_mfma_f32_16x16x32_bf16 v[168:171], v[120:123], v[160:163], v[168:171]
    v_mfma_f32_16x16x32_bf16 v[168:171], v[124:127], v[160:163], v[168:171]
    v_mfma_f32_16x16x32_bf16 v[168:171], v[128:131], v[160:163], v[168:171]
    v_mfma_f32_16x16x32_bf16 v[168:171], v[132:135], v[160:163], v[168:171]
    v_mfma_f32_16x16x32_bf16 v[168:171], v[136:139], v[160:163], v[168:171]
    v_mfma_f32_16x16x32_bf16 v[168:171], v[140:143], v[160:163], v[168:171]
    v_mfma_f32_16x16x32_bf16 v[168:171], v[144:147], v[160:163], v[168:171]
    v_mfma_f32_16x16x32_bf16 v[168:171], v[148:151], v[160:163], v[168:171]
    v_mfma_f32_16x16x32_bf16 v[168:171], v[152:155], v[160:163], v[168:171]
    v_mfma_f32_16x16x32_bf16 v[168:171], v[156:159], v[160:163], v[168:171]
    s_nop 7
    v_mul_f32 v164, 0x3ae38e39, v164
    v_mul_f32 v165, 0x3ae38e39, v165
    v_mul_f32 v166, 0x3ae38e39, v166
    v_mul_f32 v167, 0x3ae38e39, v167
    v_mul_f32 v168, 0x3ae38e39, v168
    v_mul_f32 v169, 0x3ae38e39, v169
    v_mul_f32 v170, 0x3ae38e39, v170
    v_mul_f32 v171, 0x3ae38e39, v171
    v_cvt_pk_bf16_f32 v16, v164, v165
    v_cvt_pk_bf16_f32 v17, v166, v167
    v_cvt_pk_bf16_f32 v18, v168, v169
    v_cvt_pk_bf16_f32 v19, v170, v171
    s_mul_i32 s24, s14, 50
    s_mul_i32 s25, s15, 10
    s_add_u32 s24, s24, s25
    s_add_u32 s24, s24, 9
    s_lshl_b32 s24, s24, 10
    s_add_u32 s24, s24, 0x300000
    buffer_store_dwordx4 v[16:19], v1, s[8:11], s24 offen sc1
    s_add_u32 s24, s24, 204800
    buffer_store_dwordx4 v[16:19], v1, s[8:11], s24 offen sc1
    s_add_u32 s24, s24, 204800
    buffer_store_dwordx4 v[16:19], v1, s[8:11], s24 offen sc1
    s_add_u32 s24, s24, 204800
    buffer_store_dwordx4 v[16:19], v1, s[8:11], s24 offen sc1
L_k1_kernel_wbar_done:
    s_endpgm
L_k1_kernel_wo:
    s_sub_u32 s3, s2, 348
    s_lshr_b32 s14, s3, 2
    s_and_b32 s15, s3, 3
    s_load_dwordx2 s[16:17], s[0:1], 24
    s_waitcnt lgkmcnt(0)
    s_mov_b32 s18, 663552
    s_mov_b32 s19, 0x00020000
    v_mul_u32_u24 v4, 3641, v0
    v_lshrrev_b32 v4, 16, v4
    v_mul_u32_u24 v5, 18, v4
    v_sub_u32 v5, v0, v5
    v_mul_u32_u24 v6, 1152, v4
    v_lshlrev_b32 v5, 4, v5
    v_add_u32 v6, v6, v5
    v_mov_b32 v7, 0x7f000000
    v_cmp_gt_u32 vcc, 54, v0
    s_nop 1
    v_cndmask_b32 v6, v7, v6, vcc
    s_mul_i32 s24, s14, 165888
    s_mul_i32 s25, s15, 288
    s_add_u32 s24, s24, s25
    s_mul_i32 s25, s12, 12
    s_add_u32 s26, s25, 0
    s_lshl_b32 m0, s26, 10
    s_mul_i32 s27, s26, 3456
    s_add_u32 s27, s27, s24
    buffer_load_dwordx4 v6, s[16:19], s27 offen nt lds
    s_add_u32 s26, s25, 1
    s_lshl_b32 m0, s26, 10
    s_mul_i32 s27, s26, 3456
    s_add_u32 s27, s27, s24
    buffer_load_dwordx4 v6, s[16:19], s27 offen nt lds
    s_add_u32 s26, s25, 2
    s_lshl_b32 m0, s26, 10
    s_mul_i32 s27, s26, 3456
    s_add_u32 s27, s27, s24
    buffer_load_dwordx4 v6, s[16:19], s27 offen nt lds
    s_add_u32 s26, s25, 3
    s_lshl_b32 m0, s26, 10
    s_mul_i32 s27, s26, 3456
    s_add_u32 s27, s27, s24
    buffer_load_dwordx4 v6, s[16:19], s27 offen nt lds
    s_add_u32 s26, s25, 4
    s_lshl_b32 m0, s26, 10
    s_mul_i32 s27, s26, 3456
    s_add_u32 s27, s27, s24
    buffer_load_dwordx4 v6, s[16:19], s27 offen nt lds
    s_add_u32 s26, s25, 5
    s_lshl_b32 m0, s26, 10
    s_mul_i32 s27, s26, 3456
    s_add_u32 s27, s27, s24
    buffer_load_dwordx4 v6, s[16:19], s27 offen nt lds
    s_add_u32 s26, s25, 6
    s_lshl_b32 m0, s26, 10
    s_mul_i32 s27, s26, 3456
    s_add_u32 s27, s27, s24
    buffer_load_dwordx4 v6, s[16:19], s27 offen nt lds
    s_add_u32 s26, s25, 7
    s_lshl_b32 m0, s26, 10
    s_mul_i32 s27, s26, 3456
    s_add_u32 s27, s27, s24
    buffer_load_dwordx4 v6, s[16:19], s27 offen nt lds
    s_add_u32 s26, s25, 8
    s_lshl_b32 m0, s26, 10
    s_mul_i32 s27, s26, 3456
    s_add_u32 s27, s27, s24
    buffer_load_dwordx4 v6, s[16:19], s27 offen nt lds
    s_add_u32 s26, s25, 9
    s_lshl_b32 m0, s26, 10
    s_mul_i32 s27, s26, 3456
    s_add_u32 s27, s27, s24
    buffer_load_dwordx4 v6, s[16:19], s27 offen nt lds
    s_add_u32 s26, s25, 10
    s_lshl_b32 m0, s26, 10
    s_mul_i32 s27, s26, 3456
    s_add_u32 s27, s27, s24
    buffer_load_dwordx4 v6, s[16:19], s27 offen nt lds
    s_add_u32 s26, s25, 11
    s_lshl_b32 m0, s26, 10
    s_mul_i32 s27, s26, 3456
    s_add_u32 s27, s27, s24
    buffer_load_dwordx4 v6, s[16:19], s27 offen nt lds
    v_mov_b32 v8, 0
    v_lshlrev_b32 v9, 2, v15
    ds_write_b32 v9, v8 offset:49152
    v_lshrrev_b32 v4, 4, v0
    v_bfe_u32 v5, v0, 2, 2
    v_and_b32 v7, 3, v0
    v_lshlrev_b32 v7, 3, v7
    v_add_u32 v8, 0, v5
    v_mul_u32_u24 v9, 13108, v8
    v_lshrrev_b32 v9, 16, v9
    v_mul_u32_u24 v10, 5, v9
    v_sub_u32 v10, v8, v10
    v_mul_u32_u24 v11, 5, v4
    v_add_u32 v10, v10, v11
    v_mul_u32_u24 v9, 18, v9
    v_add_u32 v9, v9, v10
    v_mul_u32_u24 v11, 21846, v9
    v_lshrrev_b32 v11, 16, v11
    v_mul_u32_u24 v12, 3, v11
    v_sub_u32 v12, v9, v12
    v_mul_u32_u24 v12, 288, v12
    v_lshlrev_b32 v11, 10, v11
    v_add_u32 v11, v11, v12
    v_mov_b32 v12, 49152
    v_cmp_gt_u32 vcc, 18, v10
    s_nop 1
    v_cndmask_b32 v11, v12, v11, vcc
    v_add_u32 v16, v11, v7
    v_add_u32 v8, 4, v5
    v_mul_u32_u24 v9, 13108, v8
    v_lshrrev_b32 v9, 16, v9
    v_mul_u32_u24 v10, 5, v9
    v_sub_u32 v10, v8, v10
    v_mul_u32_u24 v11, 5, v4
    v_add_u32 v10, v10, v11
    v_mul_u32_u24 v9, 18, v9
    v_add_u32 v9, v9, v10
    v_mul_u32_u24 v11, 21846, v9
    v_lshrrev_b32 v11, 16, v11
    v_mul_u32_u24 v12, 3, v11
    v_sub_u32 v12, v9, v12
    v_mul_u32_u24 v12, 288, v12
    v_lshlrev_b32 v11, 10, v11
    v_add_u32 v11, v11, v12
    v_mov_b32 v12, 49152
    v_cmp_gt_u32 vcc, 18, v10
    s_nop 1
    v_cndmask_b32 v11, v12, v11, vcc
    v_add_u32 v17, v11, v7
    v_add_u32 v8, 8, v5
    v_mul_u32_u24 v9, 13108, v8
    v_lshrrev_b32 v9, 16, v9
    v_mul_u32_u24 v10, 5, v9
    v_sub_u32 v10, v8, v10
    v_mul_u32_u24 v11, 5, v4
    v_add_u32 v10, v10, v11
    v_mul_u32_u24 v9, 18, v9
    v_add_u32 v9, v9, v10
    v_mul_u32_u24 v11, 21846, v9
    v_lshrrev_b32 v11, 16, v11
    v_mul_u32_u24 v12, 3, v11
    v_sub_u32 v12, v9, v12
    v_mul_u32_u24 v12, 288, v12
    v_lshlrev_b32 v11, 10, v11
    v_add_u32 v11, v11, v12
    v_mov_b32 v12, 49152
    v_cmp_gt_u32 vcc, 18, v10
    s_nop 1
    v_cndmask_b32 v11, v12, v11, vcc
    v_add_u32 v18, v11, v7
    v_add_u32 v8, 12, v5
    v_mul_u32_u24 v9, 13108, v8
    v_lshrrev_b32 v9, 16, v9
    v_mul_u32_u24 v10, 5, v9
    v_sub_u32 v10, v8, v10
    v_mul_u32_u24 v11, 5, v4
    v_add_u32 v10, v10, v11
    v_mul_u32_u24 v9, 18, v9
    v_add_u32 v9, v9, v10
    v_mul_u32_u24 v11, 21846, v9
    v_lshrrev_b32 v11, 16, v11
    v_mul_u32_u24 v12, 3, v11
    v_sub_u32 v12, v9, v12
    v_mul_u32_u24 v12, 288, v12
    v_lshlrev_b32 v11, 10, v11
    v_add_u32 v11, v11, v12
    v_mov_b32 v12, 49152
    v_cmp_gt_u32 vcc, 18, v10
    s_nop 1
    v_cndmask_b32 v11, v12, v11, vcc
    v_add_u32 v19, v11, v7
    v_add_u32 v8, 16, v5
    v_mul_u32_u24 v9, 13108, v8
    v_lshrrev_b32 v9, 16, v9
    v_mul_u32_u24 v10, 5, v9
    v_sub_u32 v10, v8, v10
    v_mul_u32_u24 v11, 5, v4
    v_add_u32 v10, v10, v11
    v_mul_u32_u24 v9, 18, v9
    v_add_u32 v9, v9, v10
    v_mul_u32_u24 v11, 21846, v9
    v_lshrrev_b32 v11, 16, v11
    v_mul_u32_u24 v12, 3, v11
    v_sub_u32 v12, v9, v12
    v_mul_u32_u24 v12, 288, v12
    v_lshlrev_b32 v11, 10, v11
    v_add_u32 v11, v11, v12
    v_mov_b32 v12, 49152
    v_cmp_gt_u32 vcc, 18, v10
    s_nop 1
    v_cndmask_b32 v11, v12, v11, vcc
    v_add_u32 v20, v11, v7
    v_add_u32 v8, 20, v5
    v_mul_u32_u24 v9, 13108, v8
    v_lshrrev_b32 v9, 16, v9
    v_mul_u32_u24 v10, 5, v9
    v_sub_u32 v10, v8, v10
    v_mul_u32_u24 v11, 5, v4
    v_add_u32 v10, v10, v11
    v_mul_u32_u24 v9, 18, v9
    v_add_u32 v9, v9, v10
    v_mul_u32_u24 v11, 21846, v9
    v_lshrrev_b32 v11, 16, v11
    v_mul_u32_u24 v12, 3, v11
    v_sub_u32 v12, v9, v12
    v_mul_u32_u24 v12, 288, v12
    v_lshlrev_b32 v11, 10, v11
    v_add_u32 v11, v11, v12
    v_mov_b32 v12, 49152
    v_cmp_gt_u32 vcc, 18, v10
    s_nop 1
    v_cndmask_b32 v11, v12, v11, vcc
    v_add_u32 v21, v11, v7
    v_add_u32 v8, 24, v5
    v_mul_u32_u24 v9, 13108, v8
    v_lshrrev_b32 v9, 16, v9
    v_mul_u32_u24 v10, 5, v9
    v_sub_u32 v10, v8, v10
    v_mul_u32_u24 v11, 5, v4
    v_add_u32 v10, v10, v11
    v_mul_u32_u24 v9, 18, v9
    v_add_u32 v9, v9, v10
    v_mul_u32_u24 v11, 21846, v9
    v_lshrrev_b32 v11, 16, v11
    v_mul_u32_u24 v12, 3, v11
    v_sub_u32 v12, v9, v12
    v_mul_u32_u24 v12, 288, v12
    v_lshlrev_b32 v11, 10, v11
    v_add_u32 v11, v11, v12
    v_mov_b32 v12, 49152
    v_cmp_gt_u32 vcc, 18, v10
    s_nop 1
    v_cndmask_b32 v11, v12, v11, vcc
    v_add_u32 v22, v11, v7
    v_add_u32 v8, 28, v5
    v_mul_u32_u24 v9, 13108, v8
    v_lshrrev_b32 v9, 16, v9
    v_mul_u32_u24 v10, 5, v9
    v_sub_u32 v10, v8, v10
    v_mul_u32_u24 v11, 5, v4
    v_add_u32 v10, v10, v11
    v_mul_u32_u24 v9, 18, v9
    v_add_u32 v9, v9, v10
    v_mul_u32_u24 v11, 21846, v9
    v_lshrrev_b32 v11, 16, v11
    v_mul_u32_u24 v12, 3, v11
    v_sub_u32 v12, v9, v12
    v_mul_u32_u24 v12, 288, v12
    v_lshlrev_b32 v11, 10, v11
    v_add_u32 v11, v11, v12
    v_mov_b32 v12, 49152
    v_cmp_gt_u32 vcc, 18, v10
    s_nop 1
    v_cndmask_b32 v11, v12, v11, vcc
    v_add_u32 v23, v11, v7
    v_add_u32 v8, 32, v5
    v_mul_u32_u24 v9, 13108, v8
    v_lshrrev_b32 v9, 16, v9
    v_mul_u32_u24 v10, 5, v9
    v_sub_u32 v10, v8, v10
    v_mul_u32_u24 v11, 5, v4
    v_add_u32 v10, v10, v11
    v_mul_u32_u24 v9, 18, v9
    v_add_u32 v9, v9, v10
    v_mul_u32_u24 v11, 21846, v9
    v_lshrrev_b32 v11, 16, v11
    v_mul_u32_u24 v12, 3, v11
    v_sub_u32 v12, v9, v12
    v_mul_u32_u24 v12, 288, v12
    v_lshlrev_b32 v11, 10, v11
    v_add_u32 v11, v11, v12
    v_mov_b32 v12, 49152
    v_cmp_gt_u32 vcc, 18, v10
    s_nop 1
    v_cndmask_b32 v11, v12, v11, vcc
    v_add_u32 v24, v11, v7
    v_add_u32 v8, 36, v5
    v_mul_u32_u24 v9, 13108, v8
    v_lshrrev_b32 v9, 16, v9
    v_mul_u32_u24 v10, 5, v9
    v_sub_u32 v10, v8, v10
    v_mul_u32_u24 v11, 5, v4
    v_add_u32 v10, v10, v11
    v_mul_u32_u24 v9, 18, v9
    v_add_u32 v9, v9, v10
    v_mul_u32_u24 v11, 21846, v9
    v_lshrrev_b32 v11, 16, v11
    v_mul_u32_u24 v12, 3, v11
    v_sub_u32 v12, v9, v12
    v_mul_u32_u24 v12, 288, v12
    v_lshlrev_b32 v11, 10, v11
    v_add_u32 v11, v11, v12
    v_mov_b32 v12, 49152
    v_cmp_gt_u32 vcc, 18, v10
    s_nop 1
    v_cndmask_b32 v11, v12, v11, vcc
    v_add_u32 v25, v11, v7
    s_waitcnt vmcnt(0) lgkmcnt(0)
    s_barrier
    s_lshl_b32 s24, s15, 2
    s_add_u32 s24, s24, s14
    s_mul_i32 s24, s24, 51200
    s_add_u32 s24, s24, 0x300000
    s_mov_b32 s25, s12
L_k1_kernel_wo_loop:
    s_lshl_b32 s26, s25, 5
    v_add_u32 v30, s26, v16
    ds_read_b64_tr_b16 v[32:33], v30
    v_add_u32 v30, s26, v17
    ds_read_b64_tr_b16 v[34:35], v30
    v_add_u32 v30, s26, v18
    ds_read_b64_tr_b16 v[36:37], v30
    v_add_u32 v30, s26, v19
    ds_read_b64_tr_b16 v[38:39], v30
    v_add_u32 v30, s26, v20
    ds_read_b64_tr_b16 v[40:41], v30
    v_add_u32 v30, s26, v21
    ds_read_b64_tr_b16 v[42:43], v30
    v_add_u32 v30, s26, v22
    ds_read_b64_tr_b16 v[44:45], v30
    v_add_u32 v30, s26, v23
    ds_read_b64_tr_b16 v[46:47], v30
    v_add_u32 v30, s26, v24
    ds_read_b64_tr_b16 v[48:49], v30
    v_add_u32 v30, s26, v25
    ds_read_b64_tr_b16 v[50:51], v30
    s_lshl_b32 s27, s25, 10
    s_add_u32 s27, s27, s24
    s_waitcnt lgkmcnt(0)
    buffer_store_dwordx4 v[32:35], v1, s[8:11], s27 offen sc1
    s_add_u32 s27, s27, 10240
    buffer_store_dwordx4 v[36:39], v1, s[8:11], s27 offen sc1
    s_add_u32 s27, s27, 10240
    buffer_store_dwordx4 v[40:43], v1, s[8:11], s27 offen sc1
    s_add_u32 s27, s27, 10240
    buffer_store_dwordx4 v[44:47], v1, s[8:11], s27 offen sc1
    s_add_u32 s27, s27, 10240
    buffer_store_dwordx4 v[48:51], v1, s[8:11], s27 offen sc1
    s_add_u32 s25, s25, 4
    s_cmp_lt_u32 s25, 9
    s_cbranch_scc1 L_k1_kernel_wo_loop
    s_endpgm
L_k1_kernel_wgu:
    s_sub_u32 s3, s2, 364
    s_getpc_b64 s[90:91]
L_k1_kernel_pc2:
    s_add_u32 s90, s90, k2_kernel-L_k1_kernel_pc2
    s_addc_u32 s91, s91, 0
    v_lshlrev_b32 v250, 7, v15
    v_min_u32 v251, L_k2_kernel_codeend-k2_kernel-4, v250
    global_load_dword v252, v251, s[90:91]
    v_add_u32 v250, 32768, v250
    v_min_u32 v251, L_k2_kernel_codeend-k2_kernel-4, v250
    global_load_dword v252, v251, s[90:91]
    v_mov_b32 v16, 0
    v_lshlrev_b32 v17, 7, v15
    v_mov_b32 v18, 0x7f000000
    s_cmp_lt_u32 s3, 128
    s_cselect_b32 s24, 8, 0
    v_cmp_gt_u32 vcc, s24, v15
    s_nop 1
    v_cndmask_b32 v17, v18, v17, vcc
    s_lshl_b32 s24, s3, 10
    s_add_u32 s24, s24, 0x4808000
    buffer_store_dword v16, v17, s[8:11], s24 offen
    s_waitcnt vmcnt(0)
    s_lshr_b32 s14, s3, 1
    s_and_b32 s15, s3, 1
    s_load_dwordx2 s[16:17], s[0:1], 40
    s_waitcnt lgkmcnt(0)
    s_mov_b32 s18, 5308416
    s_mov_b32 s19, 0x00020000
    s_load_dwordx2 s[20:21], s[0:1], 48
    s_waitcnt lgkmcnt(0)
    s_mov_b32 s22, 5308416
    s_mov_b32 s23, 0x00020000
    v_lshrrev_b32 v4, 3, v0
    v_mul_u32_u24 v4, 9216, v4
    v_and_b32 v5, 7, v0
    v_lshlrev_b32 v5, 4, v5
    v_add_u32 v4, v4, v5
    s_mul_i32 s24, s15, 2654208
    s_lshl_b32 s25, s14, 7
    s_add_u32 s24, s24, s25
    s_mul_i32 s25, s12, 9
    s_add_u32 s26, s25, 0
    s_lshl_b32 s27, s26, 10
    s_add_u32 m0, s27, 0
    s_mul_i32 s27, s26, 73728
    s_add_u32 s27, s27, s24
    buffer_load_dwordx4 v4, s[16:19], s27 offen nt lds
    s_add_u32 s26, s25, 1
    s_lshl_b32 s27, s26, 10
    s_add_u32 m0, s27, 0
    s_mul_i32 s27, s26, 73728
    s_add_u32 s27, s27, s24
    buffer_load_dwordx4 v4, s[16:19], s27 offen nt lds
    s_add_u32 s26, s25, 2
    s_lshl_b32 s27, s26, 10
    s_add_u32 m0, s27, 0
    s_mul_i32 s27, s26, 73728
    s_add_u32 s27, s27, s24
    buffer_load_dwordx4 v4, s[16:19], s27 offen nt lds
    s_add_u32 s26, s25, 3
    s_lshl_b32 s27, s26, 10
    s_add_u32 m0, s27, 0
    s_mul_i32 s27, s26, 73728
    s_add_u32 s27, s27, s24
    buffer_load_dwordx4 v4, s[16:19], s27 offen nt lds
    s_add_u32 s26, s25, 4
    s_lshl_b32 s27, s26, 10
    s_add_u32 m0, s27, 0
    s_mul_i32 s27, s26, 73728
    s_add_u32 s27, s27, s24
    buffer_load_dwordx4 v4, s[16:19], s27 offen nt lds
    s_add_u32 s26, s25, 5
    s_lshl_b32 s27, s26, 10
    s_add_u32 m0, s27, 0
    s_mul_i32 s27, s26, 73728
    s_add_u32 s27, s27, s24
    buffer_load_dwordx4 v4, s[16:19], s27 offen nt lds
    s_add_u32 s26, s25, 6
    s_lshl_b32 s27, s26, 10
    s_add_u32 m0, s27, 0
    s_mul_i32 s27, s26, 73728
    s_add_u32 s27, s27, s24
    buffer_load_dwordx4 v4, s[16:19], s27 offen nt lds
    s_add_u32 s26, s25, 7
    s_lshl_b32 s27, s26, 10
    s_add_u32 m0, s27, 0
    s_mul_i32 s27, s26, 73728
    s_add_u32 s27, s27, s24
    buffer_load_dwordx4 v4, s[16:19], s27 offen nt lds
    s_add_u32 s26, s25, 8
    s_lshl_b32 s27, s26, 10
    s_add_u32 m0, s27, 0
    s_mul_i32 s27, s26, 73728
    s_add_u32 s27, s27, s24
    buffer_load_dwordx4 v4, s[16:19], s27 offen nt lds
    s_add_u32 s26, s25, 0
    s_lshl_b32 s27, s26, 10
    s_add_u32 m0, s27, 36864
    s_mul_i32 s27, s26, 73728
    s_add_u32 s27, s27, s24
    buffer_load_dwordx4 v4, s[20:23], s27 offen nt lds
    s_add_u32 s26, s25, 1
    s_lshl_b32 s27, s26, 10
    s_add_u32 m0, s27, 36864
    s_mul_i32 s27, s26, 73728
    s_add_u32 s27, s27, s24
    buffer_load_dwordx4 v4, s[20:23], s27 offen nt lds
    s_add_u32 s26, s25, 2
    s_lshl_b32 s27, s26, 10
    s_add_u32 m0, s27, 36864
    s_mul_i32 s27, s26, 73728
    s_add_u32 s27, s27, s24
    buffer_load_dwordx4 v4, s[20:23], s27 offen nt lds
    s_add_u32 s26, s25, 3
    s_lshl_b32 s27, s26, 10
    s_add_u32 m0, s27, 36864
    s_mul_i32 s27, s26, 73728
    s_add_u32 s27, s27, s24
    buffer_load_dwordx4 v4, s[20:23], s27 offen nt lds
    s_add_u32 s26, s25, 4
    s_lshl_b32 s27, s26, 10
    s_add_u32 m0, s27, 36864
    s_mul_i32 s27, s26, 73728
    s_add_u32 s27, s27, s24
    buffer_load_dwordx4 v4, s[20:23], s27 offen nt lds
    s_add_u32 s26, s25, 5
    s_lshl_b32 s27, s26, 10
    s_add_u32 m0, s27, 36864
    s_mul_i32 s27, s26, 73728
    s_add_u32 s27, s27, s24
    buffer_load_dwordx4 v4, s[20:23], s27 offen nt lds
    s_add_u32 s26, s25, 6
    s_lshl_b32 s27, s26, 10
    s_add_u32 m0, s27, 36864
    s_mul_i32 s27, s26, 73728
    s_add_u32 s27, s27, s24
    buffer_load_dwordx4 v4, s[20:23], s27 offen nt lds
    s_add_u32 s26, s25, 7
    s_lshl_b32 s27, s26, 10
    s_add_u32 m0, s27, 36864
    s_mul_i32 s27, s26, 73728
    s_add_u32 s27, s27, s24
    buffer_load_dwordx4 v4, s[20:23], s27 offen nt lds
    s_add_u32 s26, s25, 8
    s_lshl_b32 s27, s26, 10
    s_add_u32 m0, s27, 36864
    s_mul_i32 s27, s26, 73728
    s_add_u32 s27, s27, s24
    buffer_load_dwordx4 v4, s[20:23], s27 offen nt lds
    v_bfe_u32 v5, v0, 4, 1
    v_mul_u32_u24 v5, 36864, v5
    v_bfe_u32 v6, v0, 5, 1
    v_lshlrev_b32 v6, 3, v6
    v_bfe_u32 v7, v0, 2, 2
    v_add_u32 v6, v6, v7
    v_lshlrev_b32 v6, 7, v6
    v_add_u32 v5, v5, v6
    v_and_b32 v7, 3, v0
    v_lshlrev_b32 v7, 3, v7
    v_add_u32 v5, v5, v7
    s_lshl_b32 s26, s12, 5
    v_add_u32 v5, s26, v5
    s_lshl_b32 s26, s14, 2
    s_add_u32 s26, s26, s12
    s_mul_i32 s26, s26, 36
    s_mul_i32 s27, s15, 18
    s_add_u32 s26, s26, s27
    s_lshl_b32 s26, s26, 10
    s_add_u32 s26, s26, 0xd00000
    s_waitcnt vmcnt(0)
    s_barrier
    ds_read_b64_tr_b16 v[16:17], v5 offset:0
    ds_read_b64_tr_b16 v[18:19], v5 offset:512
    ds_read_b64_tr_b16 v[20:21], v5 offset:2048
    ds_read_b64_tr_b16 v[22:23], v5 offset:2560
    ds_read_b64_tr_b16 v[24:25], v5 offset:4096
    ds_read_b64_tr_b16 v[26:27], v5 offset:4608
    ds_read_b64_tr_b16 v[28:29], v5 offset:6144
    ds_read_b64_tr_b16 v[30:31], v5 offset:6656
    ds_read_b64_tr_b16 v[32:33], v5 offset:8192
    ds_read_b64_tr_b16 v[34:35], v5 offset:8704
    ds_read_b64_tr_b16 v[36:37], v5 offset:10240
    ds_read_b64_tr_b16 v[38:39], v5 offset:10752
    s_waitcnt lgkmcnt(0)
    buffer_store_dwordx4 v[16:19], v1, s[8:11], s26 offen offset:0 sc1
    buffer_store_dwordx4 v[20:23], v1, s[8:11], s26 offen offset:1024 sc1
    buffer_store_dwordx4 v[24:27], v1, s[8:11], s26 offen offset:2048 sc1
    buffer_store_dwordx4 v[28:31], v1, s[8:11], s26 offen offset:3072 sc1
    s_add_u32 s26, s26, 4096
    buffer_store_dwordx4 v[32:35], v1, s[8:11], s26 offen offset:0 sc1
    buffer_store_dwordx4 v[36:39], v1, s[8:11], s26 offen offset:1024 sc1
    s_nop 1
    ds_read_b64_tr_b16 v[16:17], v5 offset:12288
    ds_read_b64_tr_b16 v[18:19], v5 offset:12800
    ds_read_b64_tr_b16 v[20:21], v5 offset:14336
    ds_read_b64_tr_b16 v[22:23], v5 offset:14848
    ds_read_b64_tr_b16 v[24:25], v5 offset:16384
    ds_read_b64_tr_b16 v[26:27], v5 offset:16896
    ds_read_b64_tr_b16 v[28:29], v5 offset:18432
    ds_read_b64_tr_b16 v[30:31], v5 offset:18944
    ds_read_b64_tr_b16 v[32:33], v5 offset:20480
    ds_read_b64_tr_b16 v[34:35], v5 offset:20992
    ds_read_b64_tr_b16 v[36:37], v5 offset:22528
    ds_read_b64_tr_b16 v[38:39], v5 offset:23040
    s_waitcnt lgkmcnt(0)
    buffer_store_dwordx4 v[16:19], v1, s[8:11], s26 offen offset:2048 sc1
    buffer_store_dwordx4 v[20:23], v1, s[8:11], s26 offen offset:3072 sc1
    s_add_u32 s26, s26, 4096
    buffer_store_dwordx4 v[24:27], v1, s[8:11], s26 offen offset:0 sc1
    buffer_store_dwordx4 v[28:31], v1, s[8:11], s26 offen offset:1024 sc1
    buffer_store_dwordx4 v[32:35], v1, s[8:11], s26 offen offset:2048 sc1
    buffer_store_dwordx4 v[36:39], v1, s[8:11], s26 offen offset:3072 sc1
    s_nop 1
    ds_read_b64_tr_b16 v[16:17], v5 offset:24576
    ds_read_b64_tr_b16 v[18:19], v5 offset:25088
    ds_read_b64_tr_b16 v[20:21], v5 offset:26624
    ds_read_b64_tr_b16 v[22:23], v5 offset:27136
    ds_read_b64_tr_b16 v[24:25], v5 offset:28672
    ds_read_b64_tr_b16 v[26:27], v5 offset:29184
    ds_read_b64_tr_b16 v[28:29], v5 offset:30720
    ds_read_b64_tr_b16 v[30:31], v5 offset:31232
    ds_read_b64_tr_b16 v[32:33], v5 offset:32768
    ds_read_b64_tr_b16 v[34:35], v5 offset:33280
    ds_read_b64_tr_b16 v[36:37], v5 offset:34816
    ds_read_b64_tr_b16 v[38:39], v5 offset:35328
    s_waitcnt lgkmcnt(0)
    s_add_u32 s26, s26, 4096
    buffer_store_dwordx4 v[16:19], v1, s[8:11], s26 offen offset:0 sc1
    buffer_store_dwordx4 v[20:23], v1, s[8:11], s26 offen offset:1024 sc1
    buffer_store_dwordx4 v[24:27], v1, s[8:11], s26 offen offset:2048 sc1
    buffer_store_dwordx4 v[28:31], v1, s[8:11], s26 offen offset:3072 sc1
    s_add_u32 s26, s26, 4096
    buffer_store_dwordx4 v[32:35], v1, s[8:11], s26 offen offset:0 sc1
    buffer_store_dwordx4 v[36:39], v1, s[8:11], s26 offen offset:1024 sc1
    s_endpgm
L_k1_kernel_wd:
    s_sub_u32 s3, s2, 508
    s_load_dwordx2 s[16:17], s[0:1], 56
    s_waitcnt lgkmcnt(0)
    s_mov_b32 s18, 5308416
    s_mov_b32 s19, 0x00020000
    s_mul_i32 s24, s3, 73728
    s_mul_i32 s25, s12, 18432
    s_add_u32 s24, s24, s25
    s_add_u32 m0, s25, 0
    s_add_u32 s26, s24, 0
    buffer_load_dwordx4 v1, s[16:19], s26 offen offset:0 nt lds
    buffer_load_dwordx4 v1, s[16:19], s26 offen offset:1024 nt lds
    buffer_load_dwordx4 v1, s[16:19], s26 offen offset:2048 nt lds
    buffer_load_dwordx4 v1, s[16:19], s26 offen offset:3072 nt lds
    s_add_u32 m0, s25, 4096
    s_add_u32 s26, s24, 4096
    buffer_load_dwordx4 v1, s[16:19], s26 offen offset:0 nt lds
    buffer_load_dwordx4 v1, s[16:19], s26 offen offset:1024 nt lds
    buffer_load_dwordx4 v1, s[16:19], s26 offen offset:2048 nt lds
    buffer_load_dwordx4 v1, s[16:19], s26 offen offset:3072 nt lds
    s_add_u32 m0, s25, 8192
    s_add_u32 s26, s24, 8192
    buffer_load_dwordx4 v1, s[16:19], s26 offen offset:0 nt lds
    buffer_load_dwordx4 v1, s[16:19], s26 offen offset:1024 nt lds
    buffer_load_dwordx4 v1, s[16:19], s26 offen offset:2048 nt lds
    buffer_load_dwordx4 v1, s[16:19], s26 offen offset:3072 nt lds
    s_add_u32 m0, s25, 12288
    s_add_u32 s26, s24, 12288
    buffer_load_dwordx4 v1, s[16:19], s26 offen offset:0 nt lds
    buffer_load_dwordx4 v1, s[16:19], s26 offen offset:1024 nt lds
    buffer_load_dwordx4 v1, s[16:19], s26 offen offset:2048 nt lds
    buffer_load_dwordx4 v1, s[16:19], s26 offen offset:3072 nt lds
    s_add_u32 m0, s25, 16384
    s_add_u32 s26, s24, 16384
    buffer_load_dwordx4 v1, s[16:19], s26 offen offset:0 nt lds
    buffer_load_dwordx4 v1, s[16:19], s26 offen offset:1024 nt lds
    v_bfe_u32 v5, v0, 5, 1
    v_lshlrev_b32 v5, 4, v5
    v_bfe_u32 v6, v0, 4, 1
    v_lshlrev_b32 v6, 2, v6
    v_add_u32 v5, v5, v6
    v_bfe_u32 v6, v0, 2, 2
    v_add_u32 v5, v5, v6
    v_mul_u32_u24 v5, 1152, v5
    v_and_b32 v6, 3, v0
    v_lshlrev_b32 v6, 3, v6
    v_add_u32 v5, v5, v6
    s_mul_i32 s26, s12, 288
    v_add_u32 v5, s26, v5
    s_lshl_b32 s36, s3, 1
    s_add_u32 s36, s36, 0
    s_mul_i32 s27, s36, 1821
    s_lshr_b32 s27, s27, 16
    s_mul_i32 s28, s27, 36
    s_sub_u32 s28, s36, s28
    s_mul_i32 s29, s28, 57
    s_lshr_b32 s29, s29, 9
    s_mul_i32 s30, s29, 9
    s_sub_u32 s30, s28, s30
    s_mov_b32 s32, 0x54376210
    s_mov_b32 s33, 0x8
    s_lshl_b32 s30, s30, 2
    s_lshr_b64 s[32:33], s[32:33], s30
    s_and_b32 s32, s32, 15
    s_mul_i32 s34, s29, 6
    s_add_u32 s34, s34, s32
    s_mul_i32 s35, s29, 3
    s_add_u32 s35, s35, s32
    s_add_u32 s35, s35, 18
    s_cmp_lt_u32 s32, 6
    s_cselect_b32 s34, s34, s35
    s_lshl_b32 s26, s12, 2
    s_add_u32 s26, s26, s27
    s_mul_i32 s26, s26, 331776
    s_add_u32 s38, s26, 0x1800000
    s_mov_b32 s40, s34
    s_mov_b32 s42, s27
    s_lshl_b32 s36, s3, 1
    s_add_u32 s36, s36, 1
    s_mul_i32 s27, s36, 1821
    s_lshr_b32 s27, s27, 16
    s_mul_i32 s28, s27, 36
    s_sub_u32 s28, s36, s28
    s_mul_i32 s29, s28, 57
    s_lshr_b32 s29, s29, 9
    s_mul_i32 s30, s29, 9
    s_sub_u32 s30, s28, s30
    s_mov_b32 s32, 0x54376210
    s_mov_b32 s33, 0x8
    s_lshl_b32 s30, s30, 2
    s_lshr_b64 s[32:33], s[32:33], s30
    s_and_b32 s32, s32, 15
    s_mul_i32 s34, s29, 6
    s_add_u32 s34, s34, s32
    s_mul_i32 s35, s29, 3
    s_add_u32 s35, s35, s32
    s_add_u32 s35, s35, 18
    s_cmp_lt_u32 s32, 6
    s_cselect_b32 s34, s34, s35
    s_lshl_b32 s26, s12, 2
    s_add_u32 s26, s26, s27
    s_mul_i32 s26, s26, 331776
    s_add_u32 s39, s26, 0x1800000
    s_mov_b32 s41, s34
    s_mov_b32 s43, s27
    s_waitcnt vmcnt(0)
    s_barrier
    ds_read_b64_tr_b16 v[16:17], v5 offset:0
    ds_read_b64_tr_b16 v[18:19], v5 offset:9216
    ds_read_b64_tr_b16 v[20:21], v5 offset:32
    ds_read_b64_tr_b16 v[22:23], v5 offset:9248
    ds_read_b64_tr_b16 v[24:25], v5 offset:64
    ds_read_b64_tr_b16 v[26:27], v5 offset:9280
    ds_read_b64_tr_b16 v[28:29], v5 offset:96
    ds_read_b64_tr_b16 v[30:31], v5 offset:9312
    s_waitcnt lgkmcnt(4)
    ds_read_b64_tr_b16 v[32:33], v5 offset:128
    ds_read_b64_tr_b16 v[34:35], v5 offset:9344
    ds_read_b64_tr_b16 v[36:37], v5 offset:160
    ds_read_b64_tr_b16 v[38:39], v5 offset:9376
    ds_read_b64_tr_b16 v[40:41], v5 offset:192
    ds_read_b64_tr_b16 v[42:43], v5 offset:9408
    ds_read_b64_tr_b16 v[44:45], v5 offset:224
    ds_read_b64_tr_b16 v[46:47], v5 offset:9440
    s_waitcnt lgkmcnt(4)
    ds_read_b64_tr_b16 v[48:49], v5 offset:256
    ds_read_b64_tr_b16 v[50:51], v5 offset:9472
    ds_read_b64_tr_b16 v[52:53], v5 offset:36864
    ds_read_b64_tr_b16 v[54:55], v5 offset:46080
    ds_read_b64_tr_b16 v[56:57], v5 offset:36896
    ds_read_b64_tr_b16 v[58:59], v5 offset:46112
    ds_read_b64_tr_b16 v[60:61], v5 offset:36928
    ds_read_b64_tr_b16 v[62:63], v5 offset:46144
    ds_read_b64_tr_b16 v[64:65], v5 offset:36960
    ds_read_b64_tr_b16 v[66:67], v5 offset:46176
    s_waitcnt lgkmcnt(4)
    ds_read_b64_tr_b16 v[68:69], v5 offset:36992
    ds_read_b64_tr_b16 v[70:71], v5 offset:46208
    ds_read_b64_tr_b16 v[72:73], v5 offset:37024
    ds_read_b64_tr_b16 v[74:75], v5 offset:46240
    ds_read_b64_tr_b16 v[76:77], v5 offset:37056
    ds_read_b64_tr_b16 v[78:79], v5 offset:46272
    ds_read_b64_tr_b16 v[80:81], v5 offset:37088
    ds_read_b64_tr_b16 v[82:83], v5 offset:46304
    s_waitcnt lgkmcnt(4)
    ds_read_b64_tr_b16 v[84:85], v5 offset:37120
    ds_read_b64_tr_b16 v[86:87], v5 offset:46336
    s_waitcnt lgkmcnt(0)
    s_mul_i32 s28, s40, 7
    s_lshl_b32 s29, s40, 1
    s_add_u32 s29, s29, 252
    s_lshl_b32 s30, s42, 1
    s_cmp_gt_u32 s30, 0
    s_cselect_b32 s31, 0, 0
    s_add_u32 s31, s31, s28
    s_add_u32 s32, s29, 0
    s_cmp_eq_u32 s42, 0
    s_cselect_b32 s31, s32, s31
    s_lshl_b32 s31, s31, 10
    s_add_u32 s31, s31, s38
    buffer_store_dwordx4 v[16:19], v1, s[8:11], s31 offen sc1
    s_cmp_gt_u32 s30, 1
    s_cselect_b32 s31, 1, 0
    s_add_u32 s31, s31, s28
    s_add_u32 s32, s29, 1
    s_cmp_eq_u32 s42, 0
    s_cselect_b32 s31, s32, s31
    s_lshl_b32 s31, s31, 10
    s_add_u32 s31, s31, s38
    buffer_store_dwordx4 v[20:23], v1, s[8:11], s31 offen sc1
    s_cmp_gt_u32 s30, 2
    s_cselect_b32 s31, 2, 0
    s_add_u32 s31, s31, s28
    s_add_u32 s32, s29, 0
    s_cmp_eq_u32 s42, 1
    s_cselect_b32 s31, s32, s31
    s_lshl_b32 s31, s31, 10
    s_add_u32 s31, s31, s38
    buffer_store_dwordx4 v[24:27], v1, s[8:11], s31 offen sc1
    s_cmp_gt_u32 s30, 3
    s_cselect_b32 s31, 3, 1
    s_add_u32 s31, s31, s28
    s_add_u32 s32, s29, 1
    s_cmp_eq_u32 s42, 1
    s_cselect_b32 s31, s32, s31
    s_lshl_b32 s31, s31, 10
    s_add_u32 s31, s31, s38
    buffer_store_dwordx4 v[28:31], v1, s[8:11], s31 offen sc1
    s_cmp_gt_u32 s30, 4
    s_cselect_b32 s31, 4, 2
    s_add_u32 s31, s31, s28
    s_add_u32 s32, s29, 0
    s_cmp_eq_u32 s42, 2
    s_cselect_b32 s31, s32, s31
    s_lshl_b32 s31, s31, 10
    s_add_u32 s31, s31, s38
    buffer_store_dwordx4 v[32:35], v1, s[8:11], s31 offen sc1
    s_cmp_gt_u32 s30, 5
    s_cselect_b32 s31, 5, 3
    s_add_u32 s31, s31, s28
    s_add_u32 s32, s29, 1
    s_cmp_eq_u32 s42, 2
    s_cselect_b32 s31, s32, s31
    s_lshl_b32 s31, s31, 10
    s_add_u32 s31, s31, s38
    buffer_store_dwordx4 v[36:39], v1, s[8:11], s31 offen sc1
    s_cmp_gt_u32 s30, 6
    s_cselect_b32 s31, 6, 4
    s_add_u32 s31, s31, s28
    s_add_u32 s32, s29, 0
    s_cmp_eq_u32 s42, 3
    s_cselect_b32 s31, s32, s31
    s_lshl_b32 s31, s31, 10
    s_add_u32 s31, s31, s38
    buffer_store_dwordx4 v[40:43], v1, s[8:11], s31 offen sc1
    s_cmp_gt_u32 s30, 7
    s_cselect_b32 s31, 7, 5
    s_add_u32 s31, s31, s28
    s_add_u32 s32, s29, 1
    s_cmp_eq_u32 s42, 3
    s_cselect_b32 s31, s32, s31
    s_lshl_b32 s31, s31, 10
    s_add_u32 s31, s31, s38
    buffer_store_dwordx4 v[44:47], v1, s[8:11], s31 offen sc1
    s_add_u32 s31, s28, 6
    s_lshl_b32 s31, s31, 10
    s_add_u32 s31, s31, s38
    buffer_store_dwordx4 v[48:51], v1, s[8:11], s31 offen sc1
    s_mul_i32 s28, s41, 7
    s_lshl_b32 s29, s41, 1
    s_add_u32 s29, s29, 252
    s_lshl_b32 s30, s43, 1
    s_cmp_gt_u32 s30, 0
    s_cselect_b32 s31, 0, 0
    s_add_u32 s31, s31, s28
    s_add_u32 s32, s29, 0
    s_cmp_eq_u32 s43, 0
    s_cselect_b32 s31, s32, s31
    s_lshl_b32 s31, s31, 10
    s_add_u32 s31, s31, s39
    buffer_store_dwordx4 v[52:55], v1, s[8:11], s31 offen sc1
    s_cmp_gt_u32 s30, 1
    s_cselect_b32 s31, 1, 0
    s_add_u32 s31, s31, s28
    s_add_u32 s32, s29, 1
    s_cmp_eq_u32 s43, 0
    s_cselect_b32 s31, s32, s31
    s_lshl_b32 s31, s31, 10
    s_add_u32 s31, s31, s39
    buffer_store_dwordx4 v[56:59], v1, s[8:11], s31 offen sc1
    s_cmp_gt_u32 s30, 2
    s_cselect_b32 s31, 2, 0
    s_add_u32 s31, s31, s28
    s_add_u32 s32, s29, 0
    s_cmp_eq_u32 s43, 1
    s_cselect_b32 s31, s32, s31
    s_lshl_b32 s31, s31, 10
    s_add_u32 s31, s31, s39
    buffer_store_dwordx4 v[60:63], v1, s[8:11], s31 offen sc1
    s_cmp_gt_u32 s30, 3
    s_cselect_b32 s31, 3, 1
    s_add_u32 s31, s31, s28
    s_add_u32 s32, s29, 1
    s_cmp_eq_u32 s43, 1
    s_cselect_b32 s31, s32, s31
    s_lshl_b32 s31, s31, 10
    s_add_u32 s31, s31, s39
    buffer_store_dwordx4 v[64:67], v1, s[8:11], s31 offen sc1
    s_cmp_gt_u32 s30, 4
    s_cselect_b32 s31, 4, 2
    s_add_u32 s31, s31, s28
    s_add_u32 s32, s29, 0
    s_cmp_eq_u32 s43, 2
    s_cselect_b32 s31, s32, s31
    s_lshl_b32 s31, s31, 10
    s_add_u32 s31, s31, s39
    buffer_store_dwordx4 v[68:71], v1, s[8:11], s31 offen sc1
    s_cmp_gt_u32 s30, 5
    s_cselect_b32 s31, 5, 3
    s_add_u32 s31, s31, s28
    s_add_u32 s32, s29, 1
    s_cmp_eq_u32 s43, 2
    s_cselect_b32 s31, s32, s31
    s_lshl_b32 s31, s31, 10
    s_add_u32 s31, s31, s39
    buffer_store_dwordx4 v[72:75], v1, s[8:11], s31 offen sc1
    s_cmp_gt_u32 s30, 6
    s_cselect_b32 s31, 6, 4
    s_add_u32 s31, s31, s28
    s_add_u32 s32, s29, 0
    s_cmp_eq_u32 s43, 3
    s_cselect_b32 s31, s32, s31
    s_lshl_b32 s31, s31, 10
    s_add_u32 s31, s31, s39
    buffer_store_dwordx4 v[76:79], v1, s[8:11], s31 offen sc1
    s_cmp_gt_u32 s30, 7
    s_cselect_b32 s31, 7, 5
    s_add_u32 s31, s31, s28
    s_add_u32 s32, s29, 1
    s_cmp_eq_u32 s43, 3
    s_cselect_b32 s31, s32, s31
    s_lshl_b32 s31, s31, 10
    s_add_u32 s31, s31, s39
    buffer_store_dwordx4 v[80:83], v1, s[8:11], s31 offen sc1
    s_add_u32 s31, s28, 6
    s_lshl_b32 s31, s31, 10
    s_add_u32 s31, s31, s39
    buffer_store_dwordx4 v[84:87], v1, s[8:11], s31 offen sc1
    s_endpgm
L_k1_kernel_end:
    s_endpgm
.section .rodata,"a"
.p2align 6
.amdhsa_kernel k1_kernel
  .amdhsa_next_free_vgpr 256
  .amdhsa_next_free_sgpr 102
  .amdhsa_accum_offset 256
  .amdhsa_group_segment_fixed_size 0
  .amdhsa_kernarg_size 88
  .amdhsa_user_sgpr_count 2
  .amdhsa_user_sgpr_kernarg_segment_ptr 1
  .amdhsa_system_sgpr_workgroup_id_x 1
  .amdhsa_float_denorm_mode_32 3
  .amdhsa_float_denorm_mode_16_64 3
.end_amdhsa_kernel
.text
.globl k2_kernel
.p2align 8
.type k2_kernel,@function
k2_kernel:

    s_cmp_ge_u32 s2, 256
    s_cbranch_scc1 L_k2_kernel_end
    s_load_dwordx2 s[4:5], s[0:1], 80
    s_load_dwordx2 s[6:7], s[0:1], 0
    v_lshrrev_b32 v3, 6, v0
    v_mov_b32 v15, v0
    v_and_b32 v0, 63, v0
    v_readfirstlane_b32 s12, v3
    v_lshlrev_b32 v1, 4, v0
    s_waitcnt lgkmcnt(0)
    s_mov_b32 s8, s4
    s_mov_b32 s9, s5
    s_mov_b32 s10, 0x10000000
    s_mov_b32 s11, 0x00020000
    s_mov_b32 s24, s6
    s_mov_b32 s25, s7
    s_mov_b32 s26, 2359296
    s_mov_b32 s27, 0x00020000
    s_bfe_u32 s14, s2, 0x20003
    s_and_b32 s13, s2, 7
    s_lshr_b32 s15, s2, 5
    s_lshl_b32 s15, s15, 3
    s_add_u32 s13, s13, s15
    s_lshl_b32 s16, s14, 2
    s_add_u32 s16, s16, s12
    s_mul_i32 s16, s16, 51200
    s_add_u32 s16, s16, 0x300000
    s_mul_i32 s17, s12, 21888
    s_add_u32 s17, s17, 0x400000
    s_lshl_b32 s18, s13, 6
    s_lshl_b32 s19, s12, 3
    s_add_u32 s18, s18, s19
    s_mul_i32 s18, s18, 1152
    s_add_u32 s18, s18, 0x800000
    v_lshlrev_b32 v2, 3, v0
    v_add_u32 v2, 1024, v2
    v_mov_b32 v4, 0x7f000000
    v_cmp_gt_u32 vcc, 16, v0
    s_nop 1
    v_cndmask_b32 v2, v4, v2, vcc
    s_add_u32 s20, s17, 0
    buffer_load_dwordx4 v[16:19], v1, s[8:11], s20 offen offset:0
    buffer_load_dwordx4 v[20:23], v1, s[8:11], s20 offen offset:1024
    buffer_load_dwordx4 v[24:27], v1, s[8:11], s20 offen offset:2048
    buffer_load_dwordx4 v[28:31], v1, s[8:11], s20 offen offset:3072
    s_add_u32 s20, s17, 4096
    buffer_load_dwordx4 v[32:35], v1, s[8:11], s20 offen offset:0
    buffer_load_dwordx4 v[36:39], v1, s[8:11], s20 offen offset:1024
    buffer_load_dwordx4 v[40:43], v1, s[8:11], s20 offen offset:2048
    buffer_load_dwordx4 v[44:47], v1, s[8:11], s20 offen offset:3072
    s_add_u32 s20, s17, 8192
    buffer_load_dwordx4 v[48:51], v1, s[8:11], s20 offen offset:0
    buffer_load_dwordx4 v[52:55], v1, s[8:11], s20 offen offset:1024
    buffer_load_dwordx4 v[56:59], v1, s[8:11], s20 offen offset:2048
    buffer_load_dwordx4 v[60:63], v1, s[8:11], s20 offen offset:3072
    s_add_u32 s20, s17, 12288
    buffer_load_dwordx4 v[64:67], v1, s[8:11], s20 offen offset:0
    buffer_load_dwordx4 v[68:71], v1, s[8:11], s20 offen offset:1024
    buffer_load_dwordx4 v[72:75], v1, s[8:11], s20 offen offset:2048
    buffer_load_dwordx4 v[76:79], v1, s[8:11], s20 offen offset:3072
    s_add_u32 s20, s17, 16384
    buffer_load_dwordx4 v[80:83], v1, s[8:11], s20 offen offset:0
    buffer_load_dwordx4 v[84:87], v1, s[8:11], s20 offen offset:1024
    buffer_load_dwordx4 v[88:91], v1, s[8:11], s20 offen offset:2048
    buffer_load_dwordx4 v[92:95], v1, s[8:11], s20 offen offset:3072
    s_add_u32 s20, s17, 20480
    buffer_load_dwordx4 v[96:99], v1, s[8:11], s20 offen offset:0
    buffer_load_dwordx4 v[100:103], v1, s[8:11], s20 offen offset:1024
    s_and_b32 s28, s12, 1
    s_lshr_b32 s29, s12, 1
    v_and_b32 v251, 15, v0
    v_mul_u32_u24 v252, 1152, v251
    v_lshrrev_b32 v253, 4, v0
    v_lshlrev_b32 v253, 3, v253
    v_add_u32 v252, v252, v253
    s_lshl_b32 s30, s13, 1
    s_add_u32 s30, s30, s28
    s_mul_i32 s31, s30, 18432
    s_mul_i32 s32, s14, 288
    s_add_u32 s31, s31, s32
    s_mul_i32 s32, s29, 160
    s_add_u32 s31, s31, s32
    s_add_u32 s20, s18, 0
    buffer_load_dwordx4 v[104:107], v1, s[8:11], s20 offen
    buffer_load_dwordx2 v[168:169], v2, s[8:11], s20 offen
    s_add_u32 s20, s18, 36864
    buffer_load_dwordx4 v[108:111], v1, s[8:11], s20 offen
    buffer_load_dwordx2 v[170:171], v2, s[8:11], s20 offen
    s_add_u32 s20, s18, 1152
    buffer_load_dwordx4 v[112:115], v1, s[8:11], s20 offen
    buffer_load_dwordx2 v[172:173], v2, s[8:11], s20 offen
    s_add_u32 s20, s18, 38016
    buffer_load_dwordx4 v[116:119], v1, s[8:11], s20 offen
    buffer_load_dwordx2 v[174:175], v2, s[8:11], s20 offen
    s_mul_i32 s21, s12, 11264
    v_lshlrev_b32 v5, 3, v0
    v_add_u32 v5, s21, v5
    v_bfe_u32 v6, v0, 2, 2
    v_and_b32 v7, 3, v0
    v_mul_u32_u24 v8, 5, v6
    v_add_u32 v9, v8, v7
    v_subrev_u32 v9, 1, v9
    v_mov_b32 v10, 18
    v_cmp_eq_u32 vcc, 0, v7
    s_nop 1
    v_cndmask_b32 v9, v9, v10, vcc
    v_add_u32 v11, v8, v7
    v_add_u32 v11, 3, v11
    v_min_u32 v11, 18, v11
    v_mul_u32_u24 v9, 72, v9
    v_mul_u32_u24 v11, 72, v11
    v_lshrrev_b32 v12, 4, v0
    v_lshlrev_b32 v13, 4, v12
    v_lshlrev_b32 v14, 3, v12
    v_add_u32 v9, s21, v9
    v_add_u32 v11, s21, v11
    v_add_u32 v6, v9, v13
    v_add_u32 v7, v11, v13
    v_add_u32 v8, v9, v14
    v_add_u32 v10, v11, v14
    s_waitcnt vmcnt(8)
    v_cvt_pk_bf16_f32 v16, v16, v17
    v_cvt_pk_bf16_f32 v17, v18, v19
    ds_write_b64 v5, v[16:17] offset:0
    s_add_u32 s20, s18, 2304
    buffer_load_dwordx4 v[120:123], v1, s[8:11], s20 offen
    buffer_load_dwordx2 v[176:177], v2, s[8:11], s20 offen
    v_cvt_pk_bf16_f32 v20, v20, v21
    v_cvt_pk_bf16_f32 v21, v22, v23
    ds_write_b64 v5, v[20:21] offset:512
    s_add_u32 s20, s18, 39168
    buffer_load_dwordx4 v[124:127], v1, s[8:11], s20 offen
    buffer_load_dwordx2 v[178:179], v2, s[8:11], s20 offen
    v_cvt_pk_bf16_f32 v24, v24, v25
    v_cvt_pk_bf16_f32 v25, v26, v27
    ds_write_b64 v5, v[24:25] offset:1024
    s_add_u32 s20, s18, 3456
    buffer_load_dwordx4 v[128:131], v1, s[8:11], s20 offen
    buffer_load_dwordx2 v[180:181], v2, s[8:11], s20 offen
    v_cvt_pk_bf16_f32 v28, v28, v29
    v_cvt_pk_bf16_f32 v29, v30, v31
    ds_write_b64 v5, v[28:29] offset:1536
    s_add_u32 s20, s18, 40320
    buffer_load_dwordx4 v[132:135], v1, s[8:11], s20 offen
    buffer_load_dwordx2 v[182:183], v2, s[8:11], s20 offen
    v_cvt_pk_bf16_f32 v32, v32, v33
    v_cvt_pk_bf16_f32 v33, v34, v35
    ds_write_b64 v5, v[32:33] offset:2048
    s_add_u32 s20, s18, 4608
    buffer_load_dwordx4 v[136:139], v1, s[8:11], s20 offen
    buffer_load_dwordx2 v[184:185], v2, s[8:11], s20 offen
    v_cvt_pk_bf16_f32 v36, v36, v37
    v_cvt_pk_bf16_f32 v37, v38, v39
    ds_write_b64 v5, v[36:37] offset:2560
    s_add_u32 s20, s18, 41472
    buffer_load_dwordx4 v[140:143], v1, s[8:11], s20 offen
    buffer_load_dwordx2 v[186:187], v2, s[8:11], s20 offen
    v_cvt_pk_bf16_f32 v40, v40, v41
    v_cvt_pk_bf16_f32 v41, v42, v43
    ds_write_b64 v5, v[40:41] offset:3072
    s_add_u32 s20, s18, 5760
    buffer_load_dwordx4 v[144:147], v1, s[8:11], s20 offen
    buffer_load_dwordx2 v[188:189], v2, s[8:11], s20 offen
    v_cvt_pk_bf16_f32 v44, v44, v45
    v_cvt_pk_bf16_f32 v45, v46, v47
    ds_write_b64 v5, v[44:45] offset:3584
    s_add_u32 s20, s18, 42624
    buffer_load_dwordx4 v[148:151], v1, s[8:11], s20 offen
    buffer_load_dwordx2 v[190:191], v2, s[8:11], s20 offen
    v_cvt_pk_bf16_f32 v48, v48, v49
    v_cvt_pk_bf16_f32 v49, v50, v51
    ds_write_b64 v5, v[48:49] offset:4096
    s_add_u32 s20, s18, 6912
    buffer_load_dwordx4 v[152:155], v1, s[8:11], s20 offen
    buffer_load_dwordx2 v[192:193], v2, s[8:11], s20 offen
    v_cvt_pk_bf16_f32 v52, v52, v53
    v_cvt_pk_bf16_f32 v53, v54, v55
    ds_write_b64 v5, v[52:53] offset:4608
    s_add_u32 s20, s18, 43776
    buffer_load_dwordx4 v[156:159], v1, s[8:11], s20 offen
    buffer_load_dwordx2 v[194:195], v2, s[8:11], s20 offen
    v_cvt_pk_bf16_f32 v56, v56, v57
    v_cvt_pk_bf16_f32 v57, v58, v59
    ds_write_b64 v5, v[56:57] offset:5120
    s_add_u32 s20, s18, 8064
    buffer_load_dwordx4 v[160:163], v1, s[8:11], s20 offen
    buffer_load_dwordx2 v[196:197], v2, s[8:11], s20 offen
    v_cvt_pk_bf16_f32 v60, v60, v61
    v_cvt_pk_bf16_f32 v61, v62, v63
    ds_write_b64 v5, v[60:61] offset:5632
    s_add_u32 s20, s18, 44928
    buffer_load_dwordx4 v[164:167], v1, s[8:11], s20 offen
    buffer_load_dwordx2 v[198:199], v2, s[8:11], s20 offen
    v_cvt_pk_bf16_f32 v64, v64, v65
    v_cvt_pk_bf16_f32 v65, v66, v67
    ds_write_b64 v5, v[64:65] offset:6144
    buffer_load_dwordx2 v[240:241], v252, s[24:27], s31 offen offset:0
    buffer_load_dwordx2 v[242:243], v252, s[24:27], s31 offen offset:32
    v_cvt_pk_bf16_f32 v68, v68, v69
    v_cvt_pk_bf16_f32 v69, v70, v71
    ds_write_b64 v5, v[68:69] offset:6656
    buffer_load_dwordx2 v[244:245], v252, s[24:27], s31 offen offset:64
    buffer_load_dwordx2 v[246:247], v252, s[24:27], s31 offen offset:96
    v_cvt_pk_bf16_f32 v72, v72, v73
    v_cvt_pk_bf16_f32 v73, v74, v75
    ds_write_b64 v5, v[72:73] offset:7168
    buffer_load_dwordx2 v[248:249], v252, s[24:27], s31 offen offset:128
    v_lshlrev_b32 v253, 2, v251
    s_lshl_b32 s32, s30, 6
    s_add_u32 s33, s32, 0x4a0000
    buffer_load_dword v250, v253, s[8:11], s33 offen
    v_cvt_pk_bf16_f32 v76, v76, v77
    v_cvt_pk_bf16_f32 v77, v78, v79
    ds_write_b64 v5, v[76:77] offset:7680
    s_add_u32 s22, s16, 0
    buffer_load_dwordx4 a[0:3], v1, s[8:11], s22 offen
    s_add_u32 s22, s16, 1024
    buffer_load_dwordx4 a[4:7], v1, s[8:11], s22 offen
    v_cvt_pk_bf16_f32 v80, v80, v81
    v_cvt_pk_bf16_f32 v81, v82, v83
    ds_write_b64 v5, v[80:81] offset:8192
    s_add_u32 s22, s16, 2048
    buffer_load_dwordx4 a[8:11], v1, s[8:11], s22 offen
    s_add_u32 s22, s16, 3072
    buffer_load_dwordx4 a[12:15], v1, s[8:11], s22 offen
    v_cvt_pk_bf16_f32 v84, v84, v85
    v_cvt_pk_bf16_f32 v85, v86, v87
    ds_write_b64 v5, v[84:85] offset:8704
    s_add_u32 s22, s16, 4096
    buffer_load_dwordx4 a[16:19], v1, s[8:11], s22 offen
    s_add_u32 s22, s16, 5120
    buffer_load_dwordx4 a[20:23], v1, s[8:11], s22 offen
    v_cvt_pk_bf16_f32 v88, v88, v89
    v_cvt_pk_bf16_f32 v89, v90, v91
    ds_write_b64 v5, v[88:89] offset:9216
    s_add_u32 s22, s16, 6144
    buffer_load_dwordx4 a[24:27], v1, s[8:11], s22 offen
    s_add_u32 s22, s16, 7168
    buffer_load_dwordx4 a[28:31], v1, s[8:11], s22 offen
    v_cvt_pk_bf16_f32 v92, v92, v93
    v_cvt_pk_bf16_f32 v93, v94, v95
    ds_write_b64 v5, v[92:93] offset:9728
    s_add_u32 s22, s16, 8192
    buffer_load_dwordx4 a[32:35], v1, s[8:11], s22 offen
    s_add_u32 s22, s16, 9216
    buffer_load_dwordx4 a[36:39], v1, s[8:11], s22 offen
    v_cvt_pk_bf16_f32 v96, v96, v97
    v_cvt_pk_bf16_f32 v97, v98, v99
    ds_write_b64 v5, v[96:97] offset:10240
    s_add_u32 s22, s16, 10240
    buffer_load_dwordx4 a[40:43], v1, s[8:11], s22 offen
    s_add_u32 s22, s16, 11264
    buffer_load_dwordx4 a[44:47], v1, s[8:11], s22 offen
    v_cvt_pk_bf16_f32 v100, v100, v101
    v_cvt_pk_bf16_f32 v101, v102, v103
    ds_write_b64 v5, v[100:101] offset:10752
    s_add_u32 s22, s16, 12288
    buffer_load_dwordx4 a[48:51], v1, s[8:11], s22 offen
    s_add_u32 s22, s16, 13312
    buffer_load_dwordx4 a[52:55], v1, s[8:11], s22 offen
    s_waitcnt lgkmcnt(0)
    v_mov_b32 v11, v6
    v_mov_b32 v12, v7
    ds_read2_b64 v[16:19], v11 offset0:0 offset1:1
    ds_read_b64 v[20:21], v8 offset:64
    ds_read2_b64 v[22:25], v12 offset0:0 offset1:1
    ds_read_b64 v[26:27], v10 offset:64
    v_add_u32 v11, 1368, v11
    v_add_u32 v12, 1368, v12
    ds_read2_b64 v[28:31], v11 offset0:0 offset1:1
    ds_read_b64 v[32:33], v8 offset:1432
    ds_read2_b64 v[34:37], v12 offset0:0 offset1:1
    ds_read_b64 v[38:39], v10 offset:1432
    v_add_u32 v11, 1368, v11
    v_add_u32 v12, 1368, v12
    s_waitcnt vmcnt(48)
    s_waitcnt lgkmcnt(4)
    v_mfma_f32_16x16x32_bf16 v[40:43], v[16:19], v[104:107], 0
    v_mfma_f32_16x16x32_bf16 v[44:47], v[22:25], v[104:107], 0
    v_mfma_f32_16x16x32_bf16 v[48:51], v[16:19], v[108:111], 0
    v_mfma_f32_16x16x32_bf16 v[52:55], v[22:25], v[108:111], 0
    s_nop 2
    v_mfma_f32_16x16x16_bf16 v[40:43], v[20:21], v[168:169], v[40:43]
    v_mfma_f32_16x16x16_bf16 v[44:47], v[26:27], v[168:169], v[44:47]
    v_mfma_f32_16x16x16_bf16 v[48:51], v[20:21], v[170:171], v[48:51]
    v_mfma_f32_16x16x16_bf16 v[52:55], v[26:27], v[170:171], v[52:55]
    s_add_u32 s22, s16, 14336
    buffer_load_dwordx4 a[56:59], v1, s[8:11], s22 offen
    s_add_u32 s22, s16, 15360
    buffer_load_dwordx4 a[60:63], v1, s[8:11], s22 offen
    s_add_u32 s22, s16, 16384
    buffer_load_dwordx4 a[64:67], v1, s[8:11], s22 offen
    s_add_u32 s22, s16, 17408
    buffer_load_dwordx4 a[68:71], v1, s[8:11], s22 offen
    s_add_u32 s22, s16, 18432
    buffer_load_dwordx4 a[72:75], v1, s[8:11], s22 offen
    s_add_u32 s22, s16, 19456
    buffer_load_dwordx4 a[76:79], v1, s[8:11], s22 offen
    ds_read2_b64 v[16:19], v11 offset0:0 offset1:1
    ds_read_b64 v[20:21], v8 offset:2800
    ds_read2_b64 v[22:25], v12 offset0:0 offset1:1
    ds_read_b64 v[26:27], v10 offset:2800
    v_add_u32 v11, 1368, v11
    v_add_u32 v12, 1368, v12
    s_waitcnt vmcnt(50)
    s_waitcnt lgkmcnt(4)
    v_mfma_f32_16x16x32_bf16 v[56:59], v[28:31], v[112:115], 0
    v_mfma_f32_16x16x32_bf16 v[60:63], v[34:37], v[112:115], 0
    v_mfma_f32_16x16x32_bf16 v[64:67], v[28:31], v[116:119], 0
    v_mfma_f32_16x16x32_bf16 v[68:71], v[34:37], v[116:119], 0
    s_nop 2
    v_mfma_f32_16x16x16_bf16 v[56:59], v[32:33], v[172:173], v[56:59]
    v_mfma_f32_16x16x16_bf16 v[60:63], v[38:39], v[172:173], v[60:63]
    v_mfma_f32_16x16x16_bf16 v[64:67], v[32:33], v[174:175], v[64:67]
    v_mfma_f32_16x16x16_bf16 v[68:71], v[38:39], v[174:175], v[68:71]
    s_add_u32 s22, s16, 20480
    buffer_load_dwordx4 a[80:83], v1, s[8:11], s22 offen
    s_add_u32 s22, s16, 21504
    buffer_load_dwordx4 a[84:87], v1, s[8:11], s22 offen
    s_add_u32 s22, s16, 22528
    buffer_load_dwordx4 a[88:91], v1, s[8:11], s22 offen
    s_add_u32 s22, s16, 23552
    buffer_load_dwordx4 a[92:95], v1, s[8:11], s22 offen
    s_add_u32 s22, s16, 24576
    buffer_load_dwordx4 a[96:99], v1, s[8:11], s22 offen
    s_add_u32 s22, s16, 25600
    buffer_load_dwordx4 a[100:103], v1, s[8:11], s22 offen
    v_add_f32 v40, 0x358637bd, v40
    v_add_f32 v48, 0x358637bd, v48
    v_rcp_f32 v40, v40
    v_rcp_f32 v48, v48
    s_nop 0
    v_mul_f32 v41, v41, v40
    v_mul_f32 v42, v42, v40
    v_mul_f32 v43, v43, v40
    v_mul_f32 v44, v44, v40
    v_mul_f32 v45, v45, v40
    v_mul_f32 v49, v49, v48
    v_mul_f32 v50, v50, v48
    v_mul_f32 v51, v51, v48
    v_mul_f32 v52, v52, v48
    v_mul_f32 v53, v53, v48
    v_cvt_pk_bf16_f32 v200, v41, v42
    v_cvt_pk_bf16_f32 v201, v43, v44
    v_mov_b32 v14, v45
    v_cvt_pk_bf16_f32 v220, v49, v50
    v_cvt_pk_bf16_f32 v221, v51, v52
    v_mov_b32 v15, v53
    ds_read2_b64 v[28:31], v11 offset0:0 offset1:1
    ds_read_b64 v[32:33], v8 offset:4168
    ds_read2_b64 v[34:37], v12 offset0:0 offset1:1
    ds_read_b64 v[38:39], v10 offset:4168
    v_add_u32 v11, 1368, v11
    v_add_u32 v12, 1368, v12
    s_waitcnt vmcnt(52)
    s_waitcnt lgkmcnt(4)
    v_mfma_f32_16x16x32_bf16 v[40:43], v[16:19], v[120:123], 0
    v_mfma_f32_16x16x32_bf16 v[44:47], v[22:25], v[120:123], 0
    v_mfma_f32_16x16x32_bf16 v[48:51], v[16:19], v[124:127], 0
    v_mfma_f32_16x16x32_bf16 v[52:55], v[22:25], v[124:127], 0
    s_nop 2
    v_mfma_f32_16x16x16_bf16 v[40:43], v[20:21], v[176:177], v[40:43]
    v_mfma_f32_16x16x16_bf16 v[44:47], v[26:27], v[176:177], v[44:47]
    v_mfma_f32_16x16x16_bf16 v[48:51], v[20:21], v[178:179], v[48:51]
    v_mfma_f32_16x16x16_bf16 v[52:55], v[26:27], v[178:179], v[52:55]
    s_add_u32 s22, s16, 26624
    buffer_load_dwordx4 a[104:107], v1, s[8:11], s22 offen
    s_add_u32 s22, s16, 27648
    buffer_load_dwordx4 a[108:111], v1, s[8:11], s22 offen
    s_add_u32 s22, s16, 28672
    buffer_load_dwordx4 a[112:115], v1, s[8:11], s22 offen
    s_add_u32 s22, s16, 29696
    buffer_load_dwordx4 a[116:119], v1, s[8:11], s22 offen
    s_add_u32 s22, s16, 30720
    buffer_load_dwordx4 a[120:123], v1, s[8:11], s22 offen
    s_add_u32 s22, s16, 31744
    buffer_load_dwordx4 a[124:127], v1, s[8:11], s22 offen
    v_add_f32 v56, 0x358637bd, v56
    v_add_f32 v64, 0x358637bd, v64
    v_rcp_f32 v56, v56
    v_rcp_f32 v64, v64
    s_nop 0
    v_mul_f32 v57, v57, v56
    v_mul_f32 v58, v58, v56
    v_mul_f32 v59, v59, v56
    v_mul_f32 v60, v60, v56
    v_mul_f32 v61, v61, v56
    v_mul_f32 v65, v65, v64
    v_mul_f32 v66, v66, v64
    v_mul_f32 v67, v67, v64
    v_mul_f32 v68, v68, v64
    v_mul_f32 v69, v69, v64
    v_cvt_pk_bf16_f32 v202, v14, v57
    v_cvt_pk_bf16_f32 v203, v58, v59
    v_cvt_pk_bf16_f32 v204, v60, v61
    v_cvt_pk_bf16_f32 v222, v15, v65
    v_cvt_pk_bf16_f32 v223, v66, v67
    v_cvt_pk_bf16_f32 v224, v68, v69
    ds_read2_b64 v[16:19], v11 offset0:0 offset1:1
    ds_read_b64 v[20:21], v8 offset:5536
    ds_read2_b64 v[22:25], v12 offset0:0 offset1:1
    ds_read_b64 v[26:27], v10 offset:5536
    v_add_u32 v11, 1368, v11
    v_add_u32 v12, 1368, v12
    s_waitcnt vmcnt(54)
    s_waitcnt lgkmcnt(4)
    v_mfma_f32_16x16x32_bf16 v[56:59], v[28:31], v[128:131], 0
    v_mfma_f32_16x16x32_bf16 v[60:63], v[34:37], v[128:131], 0
    v_mfma_f32_16x16x32_bf16 v[64:67], v[28:31], v[132:135], 0
    v_mfma_f32_16x16x32_bf16 v[68:71], v[34:37], v[132:135], 0
    s_nop 2
    v_mfma_f32_16x16x16_bf16 v[56:59], v[32:33], v[180:181], v[56:59]
    v_mfma_f32_16x16x16_bf16 v[60:63], v[38:39], v[180:181], v[60:63]
    v_mfma_f32_16x16x16_bf16 v[64:67], v[32:33], v[182:183], v[64:67]
    v_mfma_f32_16x16x16_bf16 v[68:71], v[38:39], v[182:183], v[68:71]
    s_add_u32 s22, s16, 32768
    buffer_load_dwordx4 a[128:131], v1, s[8:11], s22 offen
    s_add_u32 s22, s16, 33792
    buffer_load_dwordx4 a[132:135], v1, s[8:11], s22 offen
    s_add_u32 s22, s16, 34816
    buffer_load_dwordx4 a[136:139], v1, s[8:11], s22 offen
    s_add_u32 s22, s16, 35840
    buffer_load_dwordx4 a[140:143], v1, s[8:11], s22 offen
    s_add_u32 s22, s16, 36864
    buffer_load_dwordx4 a[144:147], v1, s[8:11], s22 offen
    s_add_u32 s22, s16, 37888
    buffer_load_dwordx4 a[148:151], v1, s[8:11], s22 offen
    v_add_f32 v40, 0x358637bd, v40
    v_add_f32 v48, 0x358637bd, v48
    v_rcp_f32 v40, v40
    v_rcp_f32 v48, v48
    s_nop 0
    v_mul_f32 v41, v41, v40
    v_mul_f32 v42, v42, v40
    v_mul_f32 v43, v43, v40
    v_mul_f32 v44, v44, v40
    v_mul_f32 v45, v45, v40
    v_mul_f32 v49, v49, v48
    v_mul_f32 v50, v50, v48
    v_mul_f32 v51, v51, v48
    v_mul_f32 v52, v52, v48
    v_mul_f32 v53, v53, v48
    v_cvt_pk_bf16_f32 v205, v41, v42
    v_cvt_pk_bf16_f32 v206, v43, v44
    v_mov_b32 v14, v45
    v_cvt_pk_bf16_f32 v225, v49, v50
    v_cvt_pk_bf16_f32 v226, v51, v52
    v_mov_b32 v15, v53
    ds_read2_b64 v[28:31], v11 offset0:0 offset1:1
    ds_read_b64 v[32:33], v8 offset:6904
    ds_read2_b64 v[34:37], v12 offset0:0 offset1:1
    ds_read_b64 v[38:39], v10 offset:6904
    v_add_u32 v11, 1368, v11
    v_add_u32 v12, 1368, v12
    s_waitcnt vmcnt(56)
    s_waitcnt lgkmcnt(4)
    v_mfma_f32_16x16x32_bf16 v[40:43], v[16:19], v[136:139], 0
    v_mfma_f32_16x16x32_bf16 v[44:47], v[22:25], v[136:139], 0
    v_mfma_f32_16x16x32_bf16 v[48:51], v[16:19], v[140:143], 0
    v_mfma_f32_16x16x32_bf16 v[52:55], v[22:25], v[140:143], 0
    s_nop 2
    v_mfma_f32_16x16x16_bf16 v[40:43], v[20:21], v[184:185], v[40:43]
    v_mfma_f32_16x16x16_bf16 v[44:47], v[26:27], v[184:185], v[44:47]
    v_mfma_f32_16x16x16_bf16 v[48:51], v[20:21], v[186:187], v[48:51]
    v_mfma_f32_16x16x16_bf16 v[52:55], v[26:27], v[186:187], v[52:55]
    s_add_u32 s22, s16, 38912
    buffer_load_dwordx4 a[152:155], v1, s[8:11], s22 offen
    s_add_u32 s22, s16, 39936
    buffer_load_dwordx4 a[156:159], v1, s[8:11], s22 offen
    s_add_u32 s22, s16, 40960
    buffer_load_dwordx4 a[160:163], v1, s[8:11], s22 offen
    s_add_u32 s22, s16, 41984
    buffer_load_dwordx4 a[164:167], v1, s[8:11], s22 offen
    s_add_u32 s22, s16, 43008
    buffer_load_dwordx4 a[168:171], v1, s[8:11], s22 offen
    s_add_u32 s22, s16, 44032
    buffer_load_dwordx4 a[172:175], v1, s[8:11], s22 offen
    v_add_f32 v56, 0x358637bd, v56
    v_add_f32 v64, 0x358637bd, v64
    v_rcp_f32 v56, v56
    v_rcp_f32 v64, v64
    s_nop 0
    v_mul_f32 v57, v57, v56
    v_mul_f32 v58, v58, v56
    v_mul_f32 v59, v59, v56
    v_mul_f32 v60, v60, v56
    v_mul_f32 v61, v61, v56
    v_mul_f32 v65, v65, v64
    v_mul_f32 v66, v66, v64
    v_mul_f32 v67, v67, v64
    v_mul_f32 v68, v68, v64
    v_mul_f32 v69, v69, v64
    v_cvt_pk_bf16_f32 v207, v14, v57
    v_cvt_pk_bf16_f32 v208, v58, v59
    v_cvt_pk_bf16_f32 v209, v60, v61
    v_cvt_pk_bf16_f32 v227, v15, v65
    v_cvt_pk_bf16_f32 v228, v66, v67
    v_cvt_pk_bf16_f32 v229, v68, v69
    ds_read2_b64 v[16:19], v11 offset0:0 offset1:1
    ds_read_b64 v[20:21], v8 offset:8272
    ds_read2_b64 v[22:25], v12 offset0:0 offset1:1
    ds_read_b64 v[26:27], v10 offset:8272
    v_add_u32 v11, 1368, v11
    v_add_u32 v12, 1368, v12
    s_waitcnt vmcnt(58)
    s_waitcnt lgkmcnt(4)
    v_mfma_f32_16x16x32_bf16 v[56:59], v[28:31], v[144:147], 0
    v_mfma_f32_16x16x32_bf16 v[60:63], v[34:37], v[144:147], 0
    v_mfma_f32_16x16x32_bf16 v[64:67], v[28:31], v[148:151], 0
    v_mfma_f32_16x16x32_bf16 v[68:71], v[34:37], v[148:151], 0
    s_nop 2
    v_mfma_f32_16x16x16_bf16 v[56:59], v[32:33], v[188:189], v[56:59]
    v_mfma_f32_16x16x16_bf16 v[60:63], v[38:39], v[188:189], v[60:63]
    v_mfma_f32_16x16x16_bf16 v[64:67], v[32:33], v[190:191], v[64:67]
    v_mfma_f32_16x16x16_bf16 v[68:71], v[38:39], v[190:191], v[68:71]
    s_add_u32 s22, s16, 45056
    buffer_load_dwordx4 a[176:179], v1, s[8:11], s22 offen
    s_add_u32 s22, s16, 46080
    buffer_load_dwordx4 a[180:183], v1, s[8:11], s22 offen
    s_add_u32 s22, s16, 47104
    buffer_load_dwordx4 a[184:187], v1, s[8:11], s22 offen
    s_add_u32 s22, s16, 48128
    buffer_load_dwordx4 a[188:191], v1, s[8:11], s22 offen
    v_add_f32 v40, 0x358637bd, v40
    v_add_f32 v48, 0x358637bd, v48
    v_rcp_f32 v40, v40
    v_rcp_f32 v48, v48
    s_nop 0
    v_mul_f32 v41, v41, v40
    v_mul_f32 v42, v42, v40
    v_mul_f32 v43, v43, v40
    v_mul_f32 v44, v44, v40
    v_mul_f32 v45, v45, v40
    v_mul_f32 v49, v49, v48
    v_mul_f32 v50, v50, v48
    v_mul_f32 v51, v51, v48
    v_mul_f32 v52, v52, v48
    v_mul_f32 v53, v53, v48
    v_cvt_pk_bf16_f32 v210, v41, v42
    v_cvt_pk_bf16_f32 v211, v43, v44
    v_mov_b32 v14, v45
    v_cvt_pk_bf16_f32 v230, v49, v50
    v_cvt_pk_bf16_f32 v231, v51, v52
    v_mov_b32 v15, v53
    ds_read2_b64 v[28:31], v11 offset0:0 offset1:1
    ds_read_b64 v[32:33], v8 offset:9640
    ds_read2_b64 v[34:37], v12 offset0:0 offset1:1
    ds_read_b64 v[38:39], v10 offset:9640
    s_waitcnt vmcnt(58)
    s_waitcnt lgkmcnt(4)
    v_mfma_f32_16x16x32_bf16 v[40:43], v[16:19], v[152:155], 0
    v_mfma_f32_16x16x32_bf16 v[44:47], v[22:25], v[152:155], 0
    v_mfma_f32_16x16x32_bf16 v[48:51], v[16:19], v[156:159], 0
    v_mfma_f32_16x16x32_bf16 v[52:55], v[22:25], v[156:159], 0
    s_nop 2
    v_mfma_f32_16x16x16_bf16 v[40:43], v[20:21], v[192:193], v[40:43]
    v_mfma_f32_16x16x16_bf16 v[44:47], v[26:27], v[192:193], v[44:47]
    v_mfma_f32_16x16x16_bf16 v[48:51], v[20:21], v[194:195], v[48:51]
    v_mfma_f32_16x16x16_bf16 v[52:55], v[26:27], v[194:195], v[52:55]
    s_add_u32 s22, s16, 49152
    buffer_load_dwordx4 a[192:195], v1, s[8:11], s22 offen
    s_add_u32 s22, s16, 50176
    buffer_load_dwordx4 a[196:199], v1, s[8:11], s22 offen
    v_add_f32 v56, 0x358637bd, v56
    v_add_f32 v64, 0x358637bd, v64
    v_rcp_f32 v56, v56
    v_rcp_f32 v64, v64
    s_nop 0
    v_mul_f32 v57, v57, v56
    v_mul_f32 v58, v58, v56
    v_mul_f32 v59, v59, v56
    v_mul_f32 v60, v60, v56
    v_mul_f32 v61, v61, v56
    v_mul_f32 v65, v65, v64
    v_mul_f32 v66, v66, v64
    v_mul_f32 v67, v67, v64
    v_mul_f32 v68, v68, v64
    v_mul_f32 v69, v69, v64
    v_cvt_pk_bf16_f32 v212, v14, v57
    v_cvt_pk_bf16_f32 v213, v58, v59
    v_cvt_pk_bf16_f32 v214, v60, v61
    v_cvt_pk_bf16_f32 v232, v15, v65
    v_cvt_pk_bf16_f32 v233, v66, v67
    v_cvt_pk_bf16_f32 v234, v68, v69
    s_waitcnt vmcnt(56)
    s_waitcnt lgkmcnt(0)
    v_mfma_f32_16x16x32_bf16 v[56:59], v[28:31], v[160:163], 0
    v_mfma_f32_16x16x32_bf16 v[60:63], v[34:37], v[160:163], 0
    v_mfma_f32_16x16x32_bf16 v[64:67], v[28:31], v[164:167], 0
    v_mfma_f32_16x16x32_bf16 v[68:71], v[34:37], v[164:167], 0
    s_nop 2
    v_mfma_f32_16x16x16_bf16 v[56:59], v[32:33], v[196:197], v[56:59]
    v_mfma_f32_16x16x16_bf16 v[60:63], v[38:39], v[196:197], v[60:63]
    v_mfma_f32_16x16x16_bf16 v[64:67], v[32:33], v[198:199], v[64:67]
    v_mfma_f32_16x16x16_bf16 v[68:71], v[38:39], v[198:199], v[68:71]
    v_add_f32 v40, 0x358637bd, v40
    v_add_f32 v48, 0x358637bd, v48
    v_rcp_f32 v40, v40
    v_rcp_f32 v48, v48
    s_nop 0
    v_mul_f32 v41, v41, v40
    v_mul_f32 v42, v42, v40
    v_mul_f32 v43, v43, v40
    v_mul_f32 v44, v44, v40
    v_mul_f32 v45, v45, v40
    v_mul_f32 v49, v49, v48
    v_mul_f32 v50, v50, v48
    v_mul_f32 v51, v51, v48
    v_mul_f32 v52, v52, v48
    v_mul_f32 v53, v53, v48
    v_cvt_pk_bf16_f32 v215, v41, v42
    v_cvt_pk_bf16_f32 v216, v43, v44
    v_mov_b32 v14, v45
    v_cvt_pk_bf16_f32 v235, v49, v50
    v_cvt_pk_bf16_f32 v236, v51, v52
    v_mov_b32 v15, v53
    s_nop 7
    v_add_f32 v56, 0x358637bd, v56
    v_add_f32 v64, 0x358637bd, v64
    v_rcp_f32 v56, v56
    v_rcp_f32 v64, v64
    s_nop 0
    v_mul_f32 v57, v57, v56
    v_mul_f32 v58, v58, v56
    v_mul_f32 v59, v59, v56
    v_mul_f32 v60, v60, v56
    v_mul_f32 v61, v61, v56
    v_mul_f32 v65, v65, v64
    v_mul_f32 v66, v66, v64
    v_mul_f32 v67, v67, v64
    v_mul_f32 v68, v68, v64
    v_mul_f32 v69, v69, v64
    v_cvt_pk_bf16_f32 v217, v14, v57
    v_cvt_pk_bf16_f32 v218, v58, v59
    v_cvt_pk_bf16_f32 v219, v60, v61
    v_cvt_pk_bf16_f32 v237, v15, v65
    v_cvt_pk_bf16_f32 v238, v66, v67
    v_cvt_pk_bf16_f32 v239, v68, v69
    s_waitcnt vmcnt(40)
    s_nop 1
    v_mfma_f32_16x16x32_bf16 v[16:19], a[0:3], v[200:203], 0
    v_mfma_f32_16x16x32_bf16 v[20:23], a[0:3], v[220:223], 0
    v_mfma_f32_16x16x32_bf16 v[24:27], a[4:7], v[200:203], 0
    v_mfma_f32_16x16x32_bf16 v[28:31], a[4:7], v[220:223], 0
    v_mfma_f32_16x16x32_bf16 v[32:35], a[8:11], v[200:203], 0
    v_mfma_f32_16x16x32_bf16 v[36:39], a[8:11], v[220:223], 0
    v_mfma_f32_16x16x32_bf16 v[40:43], a[12:15], v[200:203], 0
    v_mfma_f32_16x16x32_bf16 v[44:47], a[12:15], v[220:223], 0
    v_mfma_f32_16x16x32_bf16 v[48:51], a[16:19], v[200:203], 0
    v_mfma_f32_16x16x32_bf16 v[52:55], a[16:19], v[220:223], 0
    v_mfma_f32_16x16x32_bf16 v[56:59], a[20:23], v[200:203], 0
    v_mfma_f32_16x16x32_bf16 v[60:63], a[20:23], v[220:223], 0
    v_mfma_f32_16x16x32_bf16 v[64:67], a[24:27], v[200:203], 0
    v_mfma_f32_16x16x32_bf16 v[68:71], a[24:27], v[220:223], 0
    v_mfma_f32_16x16x32_bf16 v[72:75], a[28:31], v[200:203], 0
    v_mfma_f32_16x16x32_bf16 v[76:79], a[28:31], v[220:223], 0
    v_mfma_f32_16x16x32_bf16 v[80:83], a[32:35], v[200:203], 0
    v_mfma_f32_16x16x32_bf16 v[84:87], a[32:35], v[220:223], 0
    v_mfma_f32_16x16x32_bf16 v[88:91], a[36:39], v[200:203], 0
    v_mfma_f32_16x16x32_bf16 v[92:95], a[36:39], v[220:223], 0
    s_waitcnt vmcnt(30)
    v_mfma_f32_16x16x32_bf16 v[16:19], a[40:43], v[204:207], v[16:19]
    v_mfma_f32_16x16x32_bf16 v[20:23], a[40:43], v[224:227], v[20:23]
    v_mfma_f32_16x16x32_bf16 v[24:27], a[44:47], v[204:207], v[24:27]
    v_mfma_f32_16x16x32_bf16 v[28:31], a[44:47], v[224:227], v[28:31]
    v_mfma_f32_16x16x32_bf16 v[32:35], a[48:51], v[204:207], v[32:35]
    v_mfma_f32_16x16x32_bf16 v[36:39], a[48:51], v[224:227], v[36:39]
    v_mfma_f32_16x16x32_bf16 v[40:43], a[52:55], v[204:207], v[40:43]
    v_mfma_f32_16x16x32_bf16 v[44:47], a[52:55], v[224:227], v[44:47]
    v_mfma_f32_16x16x32_bf16 v[48:51], a[56:59], v[204:207], v[48:51]
    v_mfma_f32_16x16x32_bf16 v[52:55], a[56:59], v[224:227], v[52:55]
    v_mfma_f32_16x16x32_bf16 v[56:59], a[60:63], v[204:207], v[56:59]
    v_mfma_f32_16x16x32_bf16 v[60:63], a[60:63], v[224:227], v[60:63]
    v_mfma_f32_16x16x32_bf16 v[64:67], a[64:67], v[204:207], v[64:67]
    v_mfma_f32_16x16x32_bf16 v[68:71], a[64:67], v[224:227], v[68:71]
    v_mfma_f32_16x16x32_bf16 v[72:75], a[68:71], v[204:207], v[72:75]
    v_mfma_f32_16x16x32_bf16 v[76:79], a[68:71], v[224:227], v[76:79]
    v_mfma_f32_16x16x32_bf16 v[80:83], a[72:75], v[204:207], v[80:83]
    v_mfma_f32_16x16x32_bf16 v[84:87], a[72:75], v[224:227], v[84:87]
    v_mfma_f32_16x16x32_bf16 v[88:91], a[76:79], v[204:207], v[88:91]
    v_mfma_f32_16x16x32_bf16 v[92:95], a[76:79], v[224:227], v[92:95]
    s_waitcnt vmcnt(20)
    v_mfma_f32_16x16x32_bf16 v[16:19], a[80:83], v[208:211], v[16:19]
    v_mfma_f32_16x16x32_bf16 v[20:23], a[80:83], v[228:231], v[20:23]
    v_mfma_f32_16x16x32_bf16 v[24:27], a[84:87], v[208:211], v[24:27]
    v_mfma_f32_16x16x32_bf16 v[28:31], a[84:87], v[228:231], v[28:31]
    v_mfma_f32_16x16x32_bf16 v[32:35], a[88:91], v[208:211], v[32:35]
    v_mfma_f32_16x16x32_bf16 v[36:39], a[88:91], v[228:231], v[36:39]
    v_mfma_f32_16x16x32_bf16 v[40:43], a[92:95], v[208:211], v[40:43]
    v_mfma_f32_16x16x32_bf16 v[44:47], a[92:95], v[228:231], v[44:47]
    v_mfma_f32_16x16x32_bf16 v[48:51], a[96:99], v[208:211], v[48:51]
    v_mfma_f32_16x16x32_bf16 v[52:55], a[96:99], v[228:231], v[52:55]
    v_mfma_f32_16x16x32_bf16 v[56:59], a[100:103], v[208:211], v[56:59]
    v_mfma_f32_16x16x32_bf16 v[60:63], a[100:103], v[228:231], v[60:63]
    v_mfma_f32_16x16x32_bf16 v[64:67], a[104:107], v[208:211], v[64:67]
    v_mfma_f32_16x16x32_bf16 v[68:71], a[104:107], v[228:231], v[68:71]
    v_mfma_f32_16x16x32_bf16 v[72:75], a[108:111], v[208:211], v[72:75]
    v_mfma_f32_16x16x32_bf16 v[76:79], a[108:111], v[228:231], v[76:79]
    v_mfma_f32_16x16x32_bf16 v[80:83], a[112:115], v[208:211], v[80:83]
    v_mfma_f32_16x16x32_bf16 v[84:87], a[112:115], v[228:231], v[84:87]
    v_mfma_f32_16x16x32_bf16 v[88:91], a[116:119], v[208:211], v[88:91]
    v_mfma_f32_16x16x32_bf16 v[92:95], a[116:119], v[228:231], v[92:95]
    s_waitcnt vmcnt(10)
    v_mfma_f32_16x16x32_bf16 v[16:19], a[120:123], v[212:215], v[16:19]
    v_mfma_f32_16x16x32_bf16 v[20:23], a[120:123], v[232:235], v[20:23]
    v_mfma_f32_16x16x32_bf16 v[24:27], a[124:127], v[212:215], v[24:27]
    v_mfma_f32_16x16x32_bf16 v[28:31], a[124:127], v[232:235], v[28:31]
    v_mfma_f32_16x16x32_bf16 v[32:35], a[128:131], v[212:215], v[32:35]
    v_mfma_f32_16x16x32_bf16 v[36:39], a[128:131], v[232:235], v[36:39]
    v_mfma_f32_16x16x32_bf16 v[40:43], a[132:135], v[212:215], v[40:43]
    v_mfma_f32_16x16x32_bf16 v[44:47], a[132:135], v[232:235], v[44:47]
    v_mfma_f32_16x16x32_bf16 v[48:51], a[136:139], v[212:215], v[48:51]
    v_mfma_f32_16x16x32_bf16 v[52:55], a[136:139], v[232:235], v[52:55]
    v_mfma_f32_16x16x32_bf16 v[56:59], a[140:143], v[212:215], v[56:59]
    v_mfma_f32_16x16x32_bf16 v[60:63], a[140:143], v[232:235], v[60:63]
    v_mfma_f32_16x16x32_bf16 v[64:67], a[144:147], v[212:215], v[64:67]
    v_mfma_f32_16x16x32_bf16 v[68:71], a[144:147], v[232:235], v[68:71]
    v_mfma_f32_16x16x32_bf16 v[72:75], a[148:151], v[212:215], v[72:75]
    v_mfma_f32_16x16x32_bf16 v[76:79], a[148:151], v[232:235], v[76:79]
    v_mfma_f32_16x16x32_bf16 v[80:83], a[152:155], v[212:215], v[80:83]
    v_mfma_f32_16x16x32_bf16 v[84:87], a[152:155], v[232:235], v[84:87]
    v_mfma_f32_16x16x32_bf16 v[88:91], a[156:159], v[212:215], v[88:91]
    v_mfma_f32_16x16x32_bf16 v[92:95], a[156:159], v[232:235], v[92:95]
    s_waitcnt vmcnt(0)
    v_mfma_f32_16x16x32_bf16 v[16:19], a[160:163], v[216:219], v[16:19]
    v_mfma_f32_16x16x32_bf16 v[20:23], a[160:163], v[236:239], v[20:23]
    v_mfma_f32_16x16x32_bf16 v[24:27], a[164:167], v[216:219], v[24:27]
    v_mfma_f32_16x16x32_bf16 v[28:31], a[164:167], v[236:239], v[28:31]
    v_mfma_f32_16x16x32_bf16 v[32:35], a[168:171], v[216:219], v[32:35]
    v_mfma_f32_16x16x32_bf16 v[36:39], a[168:171], v[236:239], v[36:39]
    v_mfma_f32_16x16x32_bf16 v[40:43], a[172:175], v[216:219], v[40:43]
    v_mfma_f32_16x16x32_bf16 v[44:47], a[172:175], v[236:239], v[44:47]
    v_mfma_f32_16x16x32_bf16 v[48:51], a[176:179], v[216:219], v[48:51]
    v_mfma_f32_16x16x32_bf16 v[52:55], a[176:179], v[236:239], v[52:55]
    v_mfma_f32_16x16x32_bf16 v[56:59], a[180:183], v[216:219], v[56:59]
    v_mfma_f32_16x16x32_bf16 v[60:63], a[180:183], v[236:239], v[60:63]
    v_mfma_f32_16x16x32_bf16 v[64:67], a[184:187], v[216:219], v[64:67]
    v_mfma_f32_16x16x32_bf16 v[68:71], a[184:187], v[236:239], v[68:71]
    v_mfma_f32_16x16x32_bf16 v[72:75], a[188:191], v[216:219], v[72:75]
    v_mfma_f32_16x16x32_bf16 v[76:79], a[188:191], v[236:239], v[76:79]
    v_mfma_f32_16x16x32_bf16 v[80:83], a[192:195], v[216:219], v[80:83]
    v_mfma_f32_16x16x32_bf16 v[84:87], a[192:195], v[236:239], v[84:87]
    v_mfma_f32_16x16x32_bf16 v[88:91], a[196:199], v[216:219], v[88:91]
    v_mfma_f32_16x16x32_bf16 v[92:95], a[196:199], v[236:239], v[92:95]
    s_mul_i32 s21, s12, 20480
    s_add_u32 s21, s21, 45056
    v_add_u32 v5, s21, v1
    s_nop 7
    ds_write_b128 v5, v[16:19] offset:0
    ds_write_b128 v5, v[20:23] offset:1024
    ds_write_b128 v5, v[24:27] offset:2048
    ds_write_b128 v5, v[28:31] offset:3072
    ds_write_b128 v5, v[32:35] offset:4096
    ds_write_b128 v5, v[36:39] offset:5120
    ds_write_b128 v5, v[40:43] offset:6144
    ds_write_b128 v5, v[44:47] offset:7168
    ds_write_b128 v5, v[48:51] offset:8192
    ds_write_b128 v5, v[52:55] offset:9216
    ds_write_b128 v5, v[56:59] offset:10240
    ds_write_b128 v5, v[60:63] offset:11264
    ds_write_b128 v5, v[64:67] offset:12288
    ds_write_b128 v5, v[68:71] offset:13312
    ds_write_b128 v5, v[72:75] offset:14336
    ds_write_b128 v5, v[76:79] offset:15360
    ds_write_b128 v5, v[80:83] offset:16384
    ds_write_b128 v5, v[84:87] offset:17408
    ds_write_b128 v5, v[88:91] offset:18432
    ds_write_b128 v5, v[92:95] offset:19456
    s_mul_i32 s34, s29, 10240
    s_lshl_b32 s35, s28, 10
    s_add_u32 s34, s34, s35
    s_add_u32 s34, s34, 45056
    s_add_u32 s36, s35, 63488
    s_waitcnt lgkmcnt(0)
    s_barrier
    v_add_u32 v5, s34, v1
    v_add_u32 v9, s36, v1
    v_add_u32 v111, 40960, v5
    ds_read_b128 v[112:115], v9 offset:0
    ds_read_b128 v[116:119], v9 offset:20480
    ds_read_b128 v[120:123], v9 offset:40960
    ds_read_b128 v[124:127], v9 offset:61440
    ds_read_b128 v[16:19], v5 offset:0
    ds_read_b128 v[20:23], v5 offset:2048
    ds_read_b128 v[24:27], v5 offset:4096
    ds_read_b128 v[28:31], v5 offset:6144
    ds_read_b128 v[32:35], v5 offset:8192
    ds_read_b128 v[36:39], v5 offset:20480
    ds_read_b128 v[40:43], v5 offset:22528
    ds_read_b128 v[44:47], v5 offset:24576
    ds_read_b128 v[48:51], v5 offset:26624
    ds_read_b128 v[52:55], v5 offset:28672
    s_waitcnt lgkmcnt(4)
    ds_read_b128 v[56:59], v111 offset:0
    ds_read_b128 v[60:63], v111 offset:2048
    ds_read_b128 v[64:67], v111 offset:4096
    ds_read_b128 v[68:71], v111 offset:6144
    ds_read_b128 v[72:75], v111 offset:8192
    ds_read_b128 v[76:79], v111 offset:20480
    ds_read_b128 v[80:83], v111 offset:22528
    ds_read_b128 v[84:87], v111 offset:24576
    ds_read_b128 v[88:91], v111 offset:26624
    ds_read_b128 v[92:95], v111 offset:28672
    s_waitcnt lgkmcnt(0)
    s_barrier
    s_and_b32 s38, s2, 7
    s_lshl_b32 s38, s38, 2
    s_bfe_u32 s39, s2, 0x20003
    s_add_u32 s38, s38, s39
    s_mul_i32 s17, s38, 331776
    s_add_u32 s17, s17, 0xd00000
    v_add_f32 v112, v112, v116
    v_add_f32 v120, v120, v124
    v_add_f32 v112, v112, v120
    v_add_f32 v112, v112, v250
    v_mov_b32 v113, 0
    s_cmp_eq_u32 s29, 0
    s_cselect_b32 s37, 1.0, 0
    v_add_f32 v16, v16, v36
    v_add_f32 v56, v56, v76
    v_add_f32 v17, v17, v37
    v_add_f32 v57, v57, v77
    v_add_f32 v18, v18, v38
    v_add_f32 v58, v58, v78
    v_add_f32 v19, v19, v39
    v_add_f32 v59, v59, v79
    v_lshlrev_b32 v114, 16, v240
    v_and_b32 v115, 0xffff0000, v240
    v_lshlrev_b32 v116, 16, v241
    v_and_b32 v117, 0xffff0000, v241
    v_add_f32 v16, v16, v56
    v_sub_f32 v114, v114, v112
    v_add_f32 v17, v17, v57
    v_sub_f32 v115, v115, v112
    v_add_f32 v18, v18, v58
    v_sub_f32 v116, v116, v112
    v_add_f32 v19, v19, v59
    v_sub_f32 v117, v117, v112
    v_add_f32 v16, v16, v114
    v_add_f32 v17, v17, v115
    v_add_f32 v18, v18, v116
    v_add_f32 v19, v19, v117
    v_cvt_pk_bf16_f32 v128, v16, v17
    v_cvt_pk_bf16_f32 v129, v18, v19
    v_fmac_f32 v113, v16, v16
    v_fmac_f32 v113, v17, v17
    v_fmac_f32 v113, v18, v18
    v_fmac_f32 v113, v19, v19
    v_add_f32 v20, v20, v40
    v_add_f32 v60, v60, v80
    v_add_f32 v21, v21, v41
    v_add_f32 v61, v61, v81
    v_add_f32 v22, v22, v42
    v_add_f32 v62, v62, v82
    v_add_f32 v23, v23, v43
    v_add_f32 v63, v63, v83
    v_lshlrev_b32 v114, 16, v242
    v_and_b32 v115, 0xffff0000, v242
    v_lshlrev_b32 v116, 16, v243
    v_and_b32 v117, 0xffff0000, v243
    v_add_f32 v20, v20, v60
    v_sub_f32 v114, v114, v112
    v_add_f32 v21, v21, v61
    v_sub_f32 v115, v115, v112
    v_add_f32 v22, v22, v62
    v_sub_f32 v116, v116, v112
    v_add_f32 v23, v23, v63
    v_sub_f32 v117, v117, v112
    v_add_f32 v20, v20, v114
    v_add_f32 v21, v21, v115
    v_add_f32 v22, v22, v116
    v_add_f32 v23, v23, v117
    v_cvt_pk_bf16_f32 v130, v20, v21
    v_cvt_pk_bf16_f32 v131, v22, v23
    v_fmac_f32 v113, v20, v20
    v_fmac_f32 v113, v21, v21
    v_fmac_f32 v113, v22, v22
    v_fmac_f32 v113, v23, v23
    v_add_f32 v24, v24, v44
    v_add_f32 v64, v64, v84
    v_add_f32 v25, v25, v45
    v_add_f32 v65, v65, v85
    v_add_f32 v26, v26, v46
    v_add_f32 v66, v66, v86
    v_add_f32 v27, v27, v47
    v_add_f32 v67, v67, v87
    v_lshlrev_b32 v114, 16, v244
    v_and_b32 v115, 0xffff0000, v244
    v_lshlrev_b32 v116, 16, v245
    v_and_b32 v117, 0xffff0000, v245
    v_add_f32 v24, v24, v64
    v_sub_f32 v114, v114, v112
    v_add_f32 v25, v25, v65
    v_sub_f32 v115, v115, v112
    v_add_f32 v26, v26, v66
    v_sub_f32 v116, v116, v112
    v_add_f32 v27, v27, v67
    v_sub_f32 v117, v117, v112
    v_add_f32 v24, v24, v114
    v_add_f32 v25, v25, v115
    v_add_f32 v26, v26, v116
    v_add_f32 v27, v27, v117
    v_cvt_pk_bf16_f32 v132, v24, v25
    v_cvt_pk_bf16_f32 v133, v26, v27
    v_fmac_f32 v113, v24, v24
    v_fmac_f32 v113, v25, v25
    v_fmac_f32 v113, v26, v26
    v_fmac_f32 v113, v27, v27
    v_add_f32 v28, v28, v48
    v_add_f32 v68, v68, v88
    v_add_f32 v29, v29, v49
    v_add_f32 v69, v69, v89
    v_add_f32 v30, v30, v50
    v_add_f32 v70, v70, v90
    v_add_f32 v31, v31, v51
    v_add_f32 v71, v71, v91
    v_lshlrev_b32 v114, 16, v246
    v_and_b32 v115, 0xffff0000, v246
    v_lshlrev_b32 v116, 16, v247
    v_and_b32 v117, 0xffff0000, v247
    v_add_f32 v28, v28, v68
    v_sub_f32 v114, v114, v112
    v_add_f32 v29, v29, v69
    v_sub_f32 v115, v115, v112
    v_add_f32 v30, v30, v70
    v_sub_f32 v116, v116, v112
    v_add_f32 v31, v31, v71
    v_sub_f32 v117, v117, v112
    v_add_f32 v28, v28, v114
    v_add_f32 v29, v29, v115
    v_add_f32 v30, v30, v116
    v_add_f32 v31, v31, v117
    v_cvt_pk_bf16_f32 v134, v28, v29
    v_cvt_pk_bf16_f32 v135, v30, v31
    v_fmac_f32 v113, v28, v28
    v_fmac_f32 v113, v29, v29
    v_fmac_f32 v113, v30, v30
    v_fmac_f32 v113, v31, v31
    v_add_f32 v32, v32, v52
    v_add_f32 v72, v72, v92
    v_add_f32 v33, v33, v53
    v_add_f32 v73, v73, v93
    v_add_f32 v34, v34, v54
    v_add_f32 v74, v74, v94
    v_add_f32 v35, v35, v55
    v_add_f32 v75, v75, v95
    v_lshlrev_b32 v114, 16, v248
    v_and_b32 v115, 0xffff0000, v248
    v_lshlrev_b32 v116, 16, v249
    v_and_b32 v117, 0xffff0000, v249
    v_add_f32 v32, v32, v72
    v_sub_f32 v114, v114, v112
    v_add_f32 v33, v33, v73
    v_sub_f32 v115, v115, v112
    v_add_f32 v34, v34, v74
    v_sub_f32 v116, v116, v112
    v_add_f32 v35, v35, v75
    v_sub_f32 v117, v117, v112
    v_add_f32 v32, v32, v114
    v_add_f32 v33, v33, v115
    v_add_f32 v34, v34, v116
    v_add_f32 v35, v35, v117
    v_cvt_pk_bf16_f32 v136, v32, v33
    v_cvt_pk_bf16_f32 v137, v34, v35
    v_mov_b32 v118, 0
    v_fmac_f32 v118, v32, v32
    v_fmac_f32 v118, v33, v33
    v_fmac_f32 v118, v34, v34
    v_fmac_f32 v118, v35, v35
    v_fmac_f32 v113, s37, v118
    v_lshlrev_b32 v119, 4, v251
    v_bfe_u32 v120, v0, 5, 1
    v_lshlrev_b32 v120, 9, v120
    v_add_u32 v119, v119, v120
    v_bfe_u32 v120, v0, 4, 1
    v_lshlrev_b32 v120, 3, v120
    v_add_u32 v119, v119, v120
    s_mul_i32 s32, s13, 36
    s_mul_i32 s33, s14, 9
    s_add_u32 s32, s32, s33
    s_mul_i32 s33, s29, 5
    s_add_u32 s32, s32, s33
    s_lshl_b32 s32, s32, 10
    s_lshl_b32 s33, s28, 8
    s_add_u32 s32, s32, s33
    s_add_u32 s32, s32, 0x500000
    buffer_store_dwordx2 v[128:129], v119, s[8:11], s32 offen offset:0 sc1
    buffer_store_dwordx2 v[130:131], v119, s[8:11], s32 offen offset:1024 sc1
    buffer_store_dwordx2 v[132:133], v119, s[8:11], s32 offen offset:2048 sc1
    buffer_store_dwordx2 v[134:135], v119, s[8:11], s32 offen offset:3072 sc1
    s_cmp_lg_u32 s29, 0
    s_cbranch_scc1 L_no5_8
    s_add_u32 s33, s32, 4096
    buffer_store_dwordx2 v[136:137], v119, s[8:11], s33 offen sc1
L_no5_8:
    v_mov_b32 v114, v113
    s_nop 1
    v_permlane32_swap_b32 v113, v114
    s_nop 1
    v_add_f32 v113, v113, v114
    v_mov_b32 v114, v113
    s_nop 1
    v_permlane16_swap_b32 v113, v114
    s_nop 1
    v_add_f32 v113, v113, v114
    v_lshlrev_b32 v115, 5, v251
    s_lshl_b32 s32, s30, 9
    s_lshl_b32 s33, s14, 3
    s_add_u32 s32, s32, s33
    s_lshl_b32 s33, s29, 2
    s_add_u32 s32, s32, s33
    s_add_u32 s32, s32, 0x480000
    s_lshl_b32 s34, s30, 6
    s_add_u32 s34, s34, 0x490000
    s_mov_b64 exec, 0xffff
    buffer_store_dword v113, v115, s[8:11], s32 offen sc1
    s_or_b32 s33, s14, s29
    s_cmp_lg_u32 s33, 0
    s_cbranch_scc1 L_nomu_8
    buffer_store_dword v112, v253, s[8:11], s34 offen sc1
L_nomu_8:
    s_mov_b64 exec, -1
    s_cmp_eq_u32 s12, 0
    s_cbranch_scc1 L_wp9
    s_sub_u32 s26, s12, 1
    s_mul_i32 s26, s26, 36864
    s_add_u32 s27, s17, s26
    s_mov_b32 m0, s26
    s_nop 0
    buffer_load_dwordx4 v1, s[8:11], s27 offen offset:0  lds
    buffer_load_dwordx4 v1, s[8:11], s27 offen offset:1024  lds
    buffer_load_dwordx4 v1, s[8:11], s27 offen offset:2048  lds
    buffer_load_dwordx4 v1, s[8:11], s27 offen offset:3072  lds
    s_add_u32 s26, s26, 4096
    s_add_u32 s27, s27, 4096
    s_mov_b32 m0, s26
    s_nop 0
    buffer_load_dwordx4 v1, s[8:11], s27 offen offset:0  lds
    buffer_load_dwordx4 v1, s[8:11], s27 offen offset:1024  lds
    buffer_load_dwordx4 v1, s[8:11], s27 offen offset:2048  lds
    buffer_load_dwordx4 v1, s[8:11], s27 offen offset:3072  lds
    s_add_u32 s26, s26, 4096
    s_add_u32 s27, s27, 4096
    s_mov_b32 m0, s26
    s_nop 0
    buffer_load_dwordx4 v1, s[8:11], s27 offen offset:0  lds
    buffer_load_dwordx4 v1, s[8:11], s27 offen offset:1024  lds
    buffer_load_dwordx4 v1, s[8:11], s27 offen offset:2048  lds
    buffer_load_dwordx4 v1, s[8:11], s27 offen offset:3072  lds
    s_add_u32 s26, s26, 4096
    s_add_u32 s27, s27, 4096
    s_mov_b32 m0, s26
    s_nop 0
    buffer_load_dwordx4 v1, s[8:11], s27 offen offset:0  lds
    buffer_load_dwordx4 v1, s[8:11], s27 offen offset:1024  lds
    buffer_load_dwordx4 v1, s[8:11], s27 offen offset:2048  lds
    buffer_load_dwordx4 v1, s[8:11], s27 offen offset:3072  lds
    s_add_u32 s26, s26, 4096
    s_add_u32 s27, s27, 4096
    s_mov_b32 m0, s26
    s_nop 0
    buffer_load_dwordx4 v1, s[8:11], s27 offen offset:0  lds
    buffer_load_dwordx4 v1, s[8:11], s27 offen offset:1024  lds
L_wp9:
    s_cmp_eq_u32 s12, 0
    s_cbranch_scc1 L_w010
    s_waitcnt vmcnt(18)
    s_branch L_w110
L_w010:
    s_waitcnt vmcnt(0)
L_w110:
    s_barrier
    s_lshl_b32 s32, s13, 2
    s_add_u32 s32, s32, s14
    s_lshl_b32 s32, s32, 7
    s_add_u32 s32, s32, 0x4808000
    s_cmp_lg_u32 s12, 0
    s_cbranch_scc1 L_s10
    v_mov_b32 v250, 0
    v_mov_b32 v251, 1
    s_mov_b64 exec, 1
    buffer_store_dword v251, v250, s[8:11], s32 offen sc1
    s_mov_b64 exec, -1
L_s10:
    s_cmp_eq_u32 s12, 0
    s_cbranch_scc1 L_wp11
    s_sub_u32 s26, s12, 1
    s_mul_i32 s26, s26, 36864
    s_add_u32 s26, s26, 18432
    s_add_u32 s27, s17, s26
    s_mov_b32 m0, s26
    s_nop 0
    buffer_load_dwordx4 v1, s[8:11], s27 offen offset:0  lds
    buffer_load_dwordx4 v1, s[8:11], s27 offen offset:1024  lds
    buffer_load_dwordx4 v1, s[8:11], s27 offen offset:2048  lds
    buffer_load_dwordx4 v1, s[8:11], s27 offen offset:3072  lds
    s_add_u32 s26, s26, 4096
    s_add_u32 s27, s27, 4096
    s_mov_b32 m0, s26
    s_nop 0
    buffer_load_dwordx4 v1, s[8:11], s27 offen offset:0  lds
    buffer_load_dwordx4 v1, s[8:11], s27 offen offset:1024  lds
    buffer_load_dwordx4 v1, s[8:11], s27 offen offset:2048  lds
    buffer_load_dwordx4 v1, s[8:11], s27 offen offset:3072  lds
    s_add_u32 s26, s26, 4096
    s_add_u32 s27, s27, 4096
    s_mov_b32 m0, s26
    s_nop 0
    buffer_load_dwordx4 v1, s[8:11], s27 offen offset:0  lds
    buffer_load_dwordx4 v1, s[8:11], s27 offen offset:1024  lds
    buffer_load_dwordx4 v1, s[8:11], s27 offen offset:2048  lds
    buffer_load_dwordx4 v1, s[8:11], s27 offen offset:3072  lds
    s_add_u32 s26, s26, 4096
    s_add_u32 s27, s27, 4096
    s_mov_b32 m0, s26
    s_nop 0
    buffer_load_dwordx4 v1, s[8:11], s27 offen offset:0  lds
    buffer_load_dwordx4 v1, s[8:11], s27 offen offset:1024  lds
    buffer_load_dwordx4 v1, s[8:11], s27 offen offset:2048  lds
    buffer_load_dwordx4 v1, s[8:11], s27 offen offset:3072  lds
    s_add_u32 s26, s26, 4096
    s_add_u32 s27, s27, 4096
    s_mov_b32 m0, s26
    s_nop 0
    buffer_load_dwordx4 v1, s[8:11], s27 offen offset:0  lds
    buffer_load_dwordx4 v1, s[8:11], s27 offen offset:1024  lds
    s_sub_u32 s26, s12, 1
    s_mul_i32 s26, s26, 12288
    s_add_u32 s26, s26, 110592
    s_add_u32 s27, s17, s26
    s_mov_b32 m0, s26
    s_nop 0
    buffer_load_dwordx4 v1, s[8:11], s27 offen offset:0  lds
    buffer_load_dwordx4 v1, s[8:11], s27 offen offset:1024  lds
    buffer_load_dwordx4 v1, s[8:11], s27 offen offset:2048  lds
    buffer_load_dwordx4 v1, s[8:11], s27 offen offset:3072  lds
    s_add_u32 s26, s26, 4096
    s_add_u32 s27, s27, 4096
    s_mov_b32 m0, s26
    s_nop 0
    buffer_load_dwordx4 v1, s[8:11], s27 offen offset:0  lds
    buffer_load_dwordx4 v1, s[8:11], s27 offen offset:1024  lds
    buffer_load_dwordx4 v1, s[8:11], s27 offen offset:2048  lds
    buffer_load_dwordx4 v1, s[8:11], s27 offen offset:3072  lds
    s_add_u32 s26, s26, 4096
    s_add_u32 s27, s27, 4096
    s_mov_b32 m0, s26
    s_nop 0
    buffer_load_dwordx4 v1, s[8:11], s27 offen offset:0  lds
    buffer_load_dwordx4 v1, s[8:11], s27 offen offset:1024  lds
    buffer_load_dwordx4 v1, s[8:11], s27 offen offset:2048  lds
    buffer_load_dwordx4 v1, s[8:11], s27 offen offset:3072  lds
L_wp11:
    s_and_b32 s14, s2, 7
    s_lshl_b32 s14, s14, 2
    s_bfe_u32 s15, s2, 0x20003
    s_add_u32 s14, s14, s15
    s_lshr_b32 s13, s2, 5
    s_lshl_b32 s15, s13, 3
    s_lshl_b32 s16, s12, 1
    s_add_u32 s15, s15, s16
    s_mul_i32 s16, s15, 36864
    s_add_u32 s16, s16, 0x500000
    s_mul_i32 s17, s14, 331776
    s_add_u32 s17, s17, 0xd00000
    s_mul_i32 s24, s12, 9216
    s_add_u32 s23, s17, s24
    s_mul_i32 s20, s15, 294912
    s_mul_i32 s25, s14, 4608
    s_add_u32 s20, s20, s25
    s_add_u32 s20, s20, 0x1e00000
    s_and_b32 s35, s2, 3
    s_bfe_u32 s33, s2, 0x10002
    s_lshl_b32 s33, s33, 3
    s_bfe_u32 s34, s2, 0x30003
    s_add_u32 s33, s33, s34
    s_lshr_b32 s34, s2, 6
    s_lshl_b32 s37, s33, 3
    s_lshl_b32 s38, s12, 1
    s_add_u32 s37, s37, s38
    s_mul_i32 s37, s37, 144
    s_mul_i32 s38, s35, 36
    s_add_u32 s37, s37, s38
    s_lshl_b32 s37, s37, 10
    s_add_u32 s37, s37, 0x1e00000
    s_lshl_b32 s36, s34, 2
    s_add_u32 s36, s36, s35
    s_mul_i32 s36, s36, 331776
    s_add_u32 s36, s36, 0x1800000
    s_mul_i32 s38, s12, 9216
    s_add_u32 s36, s36, s38
    v_and_b32 v3, 31, v0
    v_lshlrev_b32 v3, 7, v3
    s_lshl_b32 s26, s13, 12
    s_add_u32 s26, s26, 0x4808000
    v_add_u32 v3, s26, v3
    s_cmp_eq_u32 s12, 0
    s_cbranch_scc1 L_w10
    s_waitcnt vmcnt(30)
L_w10:
    s_cmp_lg_u32 s12, 0
    s_cbranch_scc1 L_pd12
    s_mov_b32 s88, 0
L_pl12:
    buffer_load_dword v252, v3, s[8:11], 0 offen sc1
    s_add_u32 s88, s88, 1
    s_waitcnt vmcnt(0)
    v_cmp_ne_u32 vcc, 1, v252
    s_nop 1
    s_cbranch_vccz L_pd12
    s_sleep 1
    s_cmp_lt_u32 s88, 1048576
    s_cbranch_scc1 L_pl12
L_pd12:
    s_barrier
    s_lshr_b32 s26, s33, 1
    s_lshl_b32 s26, s26, 5
    s_lshl_b32 s27, s35, 3
    s_add_u32 s26, s26, s27
    s_lshl_b32 s26, s26, 7
    v_and_b32 v42, 7, v0
    v_lshlrev_b32 v42, 7, v42
    v_add_u32 v42, s26, v42
    v_add_u32 v19, 0x4810000, v42
    v_add_u32 v42, 0x4818000, v42
    v_bfe_u32 v3, v0, 4, 1
    s_mov_b32 s26, 147456
    v_mul_lo_u32 v2, v3, s26
    v_and_b32 v3, 15, v0
    v_lshlrev_b32 v3, 4, v3
    v_add_u32 v2, v2, v3
    v_lshrrev_b32 v3, 5, v0
    v_lshlrev_b32 v3, 8, v3
    v_add_u32 v2, v2, v3
    v_add_u32 v36, 0, v1
    v_add_u32 v37, 36864, v1
    v_add_u32 v38, 73728, v1
    v_add_u32 v39, 110592, v1
    v_and_b32 v3, 31, v0
    v_lshlrev_b32 v3, 5, v3
    s_lshl_b32 s26, s15, 10
    s_add_u32 s26, s26, 0x480000
    s_add_u32 s28, s16, 0
    buffer_load_dwordx4 a[0:3], v1, s[8:11], s28 offen offset:0 sc1
    buffer_load_dwordx4 a[4:7], v1, s[8:11], s28 offen offset:1024 sc1
    buffer_load_dwordx4 a[8:11], v1, s[8:11], s28 offen offset:2048 sc1
    buffer_load_dwordx4 a[12:15], v1, s[8:11], s28 offen offset:3072 sc1
    s_add_u32 s28, s16, 36864
    buffer_load_dwordx4 a[144:147], v1, s[8:11], s28 offen offset:0 sc1
    buffer_load_dwordx4 a[148:151], v1, s[8:11], s28 offen offset:1024 sc1
    buffer_load_dwordx4 a[152:155], v1, s[8:11], s28 offen offset:2048 sc1
    buffer_load_dwordx4 a[156:159], v1, s[8:11], s28 offen offset:3072 sc1
    buffer_load_dwordx4 v[160:163], v3, s[8:11], s26 offen offset:0 sc1
    buffer_load_dwordx4 v[164:167], v3, s[8:11], s26 offen offset:16 sc1
    buffer_load_dwordx4 v[176:179], v3, s[8:11], s26 offen offset:1024 sc1
    buffer_load_dwordx4 v[180:183], v3, s[8:11], s26 offen offset:1040 sc1
    s_add_u32 s28, s16, 4096
    buffer_load_dwordx4 a[16:19], v1, s[8:11], s28 offen offset:0 sc1
    buffer_load_dwordx4 a[20:23], v1, s[8:11], s28 offen offset:1024 sc1
    buffer_load_dwordx4 a[24:27], v1, s[8:11], s28 offen offset:2048 sc1
    buffer_load_dwordx4 a[28:31], v1, s[8:11], s28 offen offset:3072 sc1
    s_add_u32 s28, s16, 40960
    buffer_load_dwordx4 a[160:163], v1, s[8:11], s28 offen offset:0 sc1
    buffer_load_dwordx4 a[164:167], v1, s[8:11], s28 offen offset:1024 sc1
    buffer_load_dwordx4 a[168:171], v1, s[8:11], s28 offen offset:2048 sc1
    buffer_load_dwordx4 a[172:175], v1, s[8:11], s28 offen offset:3072 sc1
    s_lshl_b32 s30, s13, 5
    s_add_u32 s30, s30, s14
    s_lshl_b32 s30, s30, 7
    s_add_u32 s31, s30, 0x4818000
    s_add_u32 s30, s30, 0x4810000
    ds_read_b128 v[20:23], v36 offset:0
    ds_read_b128 v[24:27], v37 offset:0
    ds_read_b128 v[28:31], v38 offset:0
    s_waitcnt lgkmcnt(2)
    s_waitcnt vmcnt(15)
    v_mfma_f32_32x32x16_bf16 v[64:79], v[20:23], a[0:3], 0
    ds_read_b128 v[32:35], v36 offset:1024
    s_add_u32 s28, s16, 8192
    buffer_load_dwordx4 a[32:35], v1, s[8:11], s28 offen offset:0 sc1
    v_mfma_f32_32x32x16_bf16 v[80:95], v[20:23], a[144:147], 0
    s_waitcnt vmcnt(9)
    v_add_f32 v160, v160, v161
    v_add_f32 v162, v162, v163
    v_add_f32 v164, v164, v165
    v_add_f32 v166, v166, v167
    v_add_f32 v160, v160, v162
    s_waitcnt lgkmcnt(2)
    v_mfma_f32_32x32x16_bf16 v[96:111], v[24:27], a[0:3], 0
    ds_read_b128 v[20:23], v37 offset:1024
    buffer_load_dwordx4 a[36:39], v1, s[8:11], s28 offen offset:1024 sc1
    v_add_f32 v164, v164, v166
    v_mfma_f32_32x32x16_bf16 v[112:127], v[24:27], a[144:147], 0
    v_add_f32 v160, v160, v164
    v_mov_b32 v161, 0x3727c5ac
    v_fmac_f32 v161, 0x3ae38e39, v160
    v_mov_b32 v6, v161
    v_rsq_f32 v162, v161
    s_waitcnt lgkmcnt(2)
    v_mfma_f32_32x32x16_bf16 v[128:143], v[28:31], a[0:3], 0
    ds_read_b128 v[24:27], v38 offset:1024
    buffer_load_dwordx4 a[40:43], v1, s[8:11], s28 offen offset:2048 sc1
    s_nop 0
    v_mfma_f32_32x32x16_bf16 v[144:159], v[28:31], a[144:147], 0
    v_mul_f32 v4, 0xc0135761, v162
    v_mul_f32 v163, v162, v162
    v_mul_f32 v163, v163, v162
    v_mul_f32 v5, 0xbdd2d3e8, v163
    v_add_f32 v176, v176, v177
    v_add_f32 v178, v178, v179
    s_waitcnt lgkmcnt(2)
    v_mfma_f32_32x32x16_bf16 v[64:79], v[32:35], a[4:7], v[64:79]
    ds_read_b128 v[28:31], v36 offset:2048
    buffer_load_dwordx4 a[44:47], v1, s[8:11], s28 offen offset:3072 sc1
    v_add_f32 v180, v180, v181
    v_mfma_f32_32x32x16_bf16 v[80:95], v[32:35], a[148:151], v[80:95]
    v_add_f32 v182, v182, v183
    v_add_f32 v176, v176, v178
    v_add_f32 v180, v180, v182
    v_add_f32 v176, v176, v180
    v_mov_b32 v177, 0x3727c5ac
    v_fmac_f32 v177, 0x3ae38e39, v176
    s_waitcnt lgkmcnt(2)
    v_mfma_f32_32x32x16_bf16 v[96:111], v[20:23], a[4:7], v[96:111]
    ds_read_b128 v[32:35], v37 offset:2048
    s_add_u32 s28, s16, 45056
    buffer_load_dwordx4 a[176:179], v1, s[8:11], s28 offen offset:0 sc1
    v_mfma_f32_32x32x16_bf16 v[112:127], v[20:23], a[148:151], v[112:127]
    v_mov_b32 v9, v177
    v_rsq_f32 v178, v177
    s_nop 0
    v_mul_f32 v7, 0xc0135761, v178
    v_mul_f32 v179, v178, v178
    s_waitcnt lgkmcnt(2)
    v_mfma_f32_32x32x16_bf16 v[128:143], v[24:27], a[4:7], v[128:143]
    ds_read_b128 v[20:23], v38 offset:2048
    buffer_load_dwordx4 a[180:183], v1, s[8:11], s28 offen offset:1024 sc1
    v_mul_f32 v179, v179, v178
    v_mfma_f32_32x32x16_bf16 v[144:159], v[24:27], a[148:151], v[144:159]
    v_mul_f32 v8, 0xbdd2d3e8, v179
    s_waitcnt lgkmcnt(2)
    v_mfma_f32_32x32x16_bf16 v[64:79], v[28:31], a[8:11], v[64:79]
    ds_read_b128 v[24:27], v36 offset:3072
    buffer_load_dwordx4 a[184:187], v1, s[8:11], s28 offen offset:2048 sc1
    v_mfma_f32_32x32x16_bf16 v[80:95], v[28:31], a[152:155], v[80:95]
    s_waitcnt lgkmcnt(2)
    v_mfma_f32_32x32x16_bf16 v[96:111], v[32:35], a[8:11], v[96:111]
    ds_read_b128 v[28:31], v37 offset:3072
    buffer_load_dwordx4 a[188:191], v1, s[8:11], s28 offen offset:3072 sc1
    v_mfma_f32_32x32x16_bf16 v[112:127], v[32:35], a[152:155], v[112:127]
    s_waitcnt lgkmcnt(2)
    v_mfma_f32_32x32x16_bf16 v[128:143], v[20:23], a[8:11], v[128:143]
    ds_read_b128 v[32:35], v38 offset:3072
    s_add_u32 s28, s16, 12288
    buffer_load_dwordx4 a[48:51], v1, s[8:11], s28 offen offset:0 sc1
    v_mfma_f32_32x32x16_bf16 v[144:159], v[20:23], a[152:155], v[144:159]
    s_waitcnt lgkmcnt(2)
    v_mfma_f32_32x32x16_bf16 v[64:79], v[24:27], a[12:15], v[64:79]
    ds_read_b128 v[20:23], v36 offset:4096
    buffer_load_dwordx4 a[52:55], v1, s[8:11], s28 offen offset:1024 sc1
    v_mfma_f32_32x32x16_bf16 v[80:95], v[24:27], a[156:159], v[80:95]
    s_waitcnt lgkmcnt(2)
    v_mfma_f32_32x32x16_bf16 v[96:111], v[28:31], a[12:15], v[96:111]
    ds_read_b128 v[24:27], v37 offset:4096
    buffer_load_dwordx4 a[56:59], v1, s[8:11], s28 offen offset:2048 sc1
    v_mfma_f32_32x32x16_bf16 v[112:127], v[28:31], a[156:159], v[112:127]
    s_waitcnt lgkmcnt(2)
    v_mfma_f32_32x32x16_bf16 v[128:143], v[32:35], a[12:15], v[128:143]
    ds_read_b128 v[28:31], v38 offset:4096
    buffer_load_dwordx4 a[60:63], v1, s[8:11], s28 offen offset:3072 sc1
    v_mfma_f32_32x32x16_bf16 v[144:159], v[32:35], a[156:159], v[144:159]
    s_waitcnt lgkmcnt(2)
    s_waitcnt vmcnt(15)
    v_mfma_f32_32x32x16_bf16 v[64:79], v[20:23], a[16:19], v[64:79]
    ds_read_b128 v[32:35], v36 offset:5120
    s_add_u32 s28, s16, 49152
    buffer_load_dwordx4 a[192:195], v1, s[8:11], s28 offen offset:0 sc1
    v_mfma_f32_32x32x16_bf16 v[80:95], v[20:23], a[160:163], v[80:95]
    s_waitcnt lgkmcnt(2)
    v_mfma_f32_32x32x16_bf16 v[96:111], v[24:27], a[16:19], v[96:111]
    ds_read_b128 v[20:23], v37 offset:5120
    buffer_load_dwordx4 a[196:199], v1, s[8:11], s28 offen offset:1024 sc1
    v_mfma_f32_32x32x16_bf16 v[112:127], v[24:27], a[160:163], v[112:127]
    s_waitcnt lgkmcnt(2)
    v_mfma_f32_32x32x16_bf16 v[128:143], v[28:31], a[16:19], v[128:143]
    ds_read_b128 v[24:27], v38 offset:5120
    buffer_load_dwordx4 a[200:203], v1, s[8:11], s28 offen offset:2048 sc1
    v_mfma_f32_32x32x16_bf16 v[144:159], v[28:31], a[160:163], v[144:159]
    s_waitcnt lgkmcnt(2)
    s_waitcnt vmcnt(17)
    v_mfma_f32_32x32x16_bf16 v[64:79], v[32:35], a[20:23], v[64:79]
    ds_read_b128 v[28:31], v36 offset:6144
    buffer_load_dwordx4 a[204:207], v1, s[8:11], s28 offen offset:3072 sc1
    v_mfma_f32_32x32x16_bf16 v[80:95], v[32:35], a[164:167], v[80:95]
    s_waitcnt lgkmcnt(2)
    v_mfma_f32_32x32x16_bf16 v[96:111], v[20:23], a[20:23], v[96:111]
    ds_read_b128 v[32:35], v37 offset:6144
    s_add_u32 s28, s16, 16384
    buffer_load_dwordx4 a[64:67], v1, s[8:11], s28 offen offset:0 sc1
    v_mfma_f32_32x32x16_bf16 v[112:127], v[20:23], a[164:167], v[112:127]
    s_waitcnt lgkmcnt(2)
    v_mfma_f32_32x32x16_bf16 v[128:143], v[24:27], a[20:23], v[128:143]
    ds_read_b128 v[20:23], v38 offset:6144
    buffer_load_dwordx4 a[68:71], v1, s[8:11], s28 offen offset:1024 sc1
    v_mfma_f32_32x32x16_bf16 v[144:159], v[24:27], a[164:167], v[144:159]
    s_waitcnt lgkmcnt(2)
    s_waitcnt vmcnt(19)
    v_mfma_f32_32x32x16_bf16 v[64:79], v[28:31], a[24:27], v[64:79]
    ds_read_b128 v[24:27], v36 offset:7168
    buffer_load_dwordx4 a[72:75], v1, s[8:11], s28 offen offset:2048 sc1
    v_mfma_f32_32x32x16_bf16 v[80:95], v[28:31], a[168:171], v[80:95]
    s_waitcnt lgkmcnt(2)
    v_mfma_f32_32x32x16_bf16 v[96:111], v[32:35], a[24:27], v[96:111]
    ds_read_b128 v[28:31], v37 offset:7168
    buffer_load_dwordx4 a[76:79], v1, s[8:11], s28 offen offset:3072 sc1
    v_mfma_f32_32x32x16_bf16 v[112:127], v[32:35], a[168:171], v[112:127]
    s_waitcnt lgkmcnt(2)
    v_mfma_f32_32x32x16_bf16 v[128:143], v[20:23], a[24:27], v[128:143]
    ds_read_b128 v[32:35], v38 offset:7168
    s_add_u32 s28, s16, 53248
    buffer_load_dwordx4 a[208:211], v1, s[8:11], s28 offen offset:0 sc1
    v_mfma_f32_32x32x16_bf16 v[144:159], v[20:23], a[168:171], v[144:159]
    s_waitcnt lgkmcnt(2)
    s_waitcnt vmcnt(21)
    v_mfma_f32_32x32x16_bf16 v[64:79], v[24:27], a[28:31], v[64:79]
    ds_read_b128 v[20:23], v36 offset:8192
    buffer_load_dwordx4 a[212:215], v1, s[8:11], s28 offen offset:1024 sc1
    v_mfma_f32_32x32x16_bf16 v[80:95], v[24:27], a[172:175], v[80:95]
    s_waitcnt lgkmcnt(2)
    v_mfma_f32_32x32x16_bf16 v[96:111], v[28:31], a[28:31], v[96:111]
    ds_read_b128 v[24:27], v37 offset:8192
    buffer_load_dwordx4 a[216:219], v1, s[8:11], s28 offen offset:2048 sc1
    v_mfma_f32_32x32x16_bf16 v[112:127], v[28:31], a[172:175], v[112:127]
    s_waitcnt lgkmcnt(2)
    v_mfma_f32_32x32x16_bf16 v[128:143], v[32:35], a[28:31], v[128:143]
    ds_read_b128 v[28:31], v38 offset:8192
    buffer_load_dwordx4 a[220:223], v1, s[8:11], s28 offen offset:3072 sc1
    v_mfma_f32_32x32x16_bf16 v[144:159], v[32:35], a[172:175], v[144:159]
    s_waitcnt lgkmcnt(2)
    s_waitcnt vmcnt(19)
    v_mfma_f32_32x32x16_bf16 v[64:79], v[20:23], a[32:35], v[64:79]
    ds_read_b128 v[32:35], v36 offset:9216
    s_add_u32 s28, s16, 20480
    buffer_load_dwordx4 a[80:83], v1, s[8:11], s28 offen offset:0 sc1
    v_mfma_f32_32x32x16_bf16 v[80:95], v[20:23], a[176:179], v[80:95]
    s_waitcnt lgkmcnt(2)
    v_mfma_f32_32x32x16_bf16 v[96:111], v[24:27], a[32:35], v[96:111]
    ds_read_b128 v[20:23], v37 offset:9216
    buffer_load_dwordx4 a[84:87], v1, s[8:11], s28 offen offset:1024 sc1
    v_mfma_f32_32x32x16_bf16 v[112:127], v[24:27], a[176:179], v[112:127]
    s_waitcnt lgkmcnt(2)
    v_mfma_f32_32x32x16_bf16 v[128:143], v[28:31], a[32:35], v[128:143]
    ds_read_b128 v[24:27], v38 offset:9216
    buffer_load_dwordx4 a[88:91], v1, s[8:11], s28 offen offset:2048 sc1
    v_mfma_f32_32x32x16_bf16 v[144:159], v[28:31], a[176:179], v[144:159]
    s_waitcnt lgkmcnt(2)
    s_waitcnt vmcnt(21)
    v_mfma_f32_32x32x16_bf16 v[64:79], v[32:35], a[36:39], v[64:79]
    ds_read_b128 v[28:31], v36 offset:10240
    buffer_load_dwordx4 a[92:95], v1, s[8:11], s28 offen offset:3072 sc1
    v_mfma_f32_32x32x16_bf16 v[80:95], v[32:35], a[180:183], v[80:95]
    s_waitcnt lgkmcnt(2)
    v_mfma_f32_32x32x16_bf16 v[96:111], v[20:23], a[36:39], v[96:111]
    ds_read_b128 v[32:35], v37 offset:10240
    s_add_u32 s28, s16, 57344
    buffer_load_dwordx4 a[224:227], v1, s[8:11], s28 offen offset:0 sc1
    v_mfma_f32_32x32x16_bf16 v[112:127], v[20:23], a[180:183], v[112:127]
    s_waitcnt lgkmcnt(2)
    v_mfma_f32_32x32x16_bf16 v[128:143], v[24:27], a[36:39], v[128:143]
    ds_read_b128 v[20:23], v38 offset:10240
    buffer_load_dwordx4 a[228:231], v1, s[8:11], s28 offen offset:1024 sc1
    v_mfma_f32_32x32x16_bf16 v[144:159], v[24:27], a[180:183], v[144:159]
    s_waitcnt lgkmcnt(2)
    s_waitcnt vmcnt(23)
    v_mfma_f32_32x32x16_bf16 v[64:79], v[28:31], a[40:43], v[64:79]
    ds_read_b128 v[24:27], v36 offset:11264
    buffer_load_dwordx4 a[232:235], v1, s[8:11], s28 offen offset:2048 sc1
    v_mfma_f32_32x32x16_bf16 v[80:95], v[28:31], a[184:187], v[80:95]
    s_waitcnt lgkmcnt(2)
    v_mfma_f32_32x32x16_bf16 v[96:111], v[32:35], a[40:43], v[96:111]
    ds_read_b128 v[28:31], v37 offset:11264
    buffer_load_dwordx4 a[236:239], v1, s[8:11], s28 offen offset:3072 sc1
    v_mfma_f32_32x32x16_bf16 v[112:127], v[32:35], a[184:187], v[112:127]
    s_waitcnt lgkmcnt(2)
    v_mfma_f32_32x32x16_bf16 v[128:143], v[20:23], a[40:43], v[128:143]
    ds_read_b128 v[32:35], v38 offset:11264
    s_add_u32 s28, s16, 24576
    buffer_load_dwordx4 a[96:99], v1, s[8:11], s28 offen offset:0 sc1
    v_mfma_f32_32x32x16_bf16 v[144:159], v[20:23], a[184:187], v[144:159]
    s_waitcnt lgkmcnt(2)
    s_waitcnt vmcnt(25)
    v_mfma_f32_32x32x16_bf16 v[64:79], v[24:27], a[44:47], v[64:79]
    ds_read_b128 v[20:23], v36 offset:12288
    buffer_load_dwordx4 a[100:103], v1, s[8:11], s28 offen offset:1024 sc1
    v_mfma_f32_32x32x16_bf16 v[80:95], v[24:27], a[188:191], v[80:95]
    s_waitcnt lgkmcnt(2)
    v_mfma_f32_32x32x16_bf16 v[96:111], v[28:31], a[44:47], v[96:111]
    ds_read_b128 v[24:27], v37 offset:12288
    buffer_load_dwordx4 a[104:107], v1, s[8:11], s28 offen offset:2048 sc1
    v_mfma_f32_32x32x16_bf16 v[112:127], v[28:31], a[188:191], v[112:127]
    s_waitcnt lgkmcnt(2)
    v_mfma_f32_32x32x16_bf16 v[128:143], v[32:35], a[44:47], v[128:143]
    ds_read_b128 v[28:31], v38 offset:12288
    buffer_load_dwordx4 a[108:111], v1, s[8:11], s28 offen offset:3072 sc1
    v_mfma_f32_32x32x16_bf16 v[144:159], v[32:35], a[188:191], v[144:159]
    s_waitcnt lgkmcnt(2)
    s_waitcnt vmcnt(23)
    v_mfma_f32_32x32x16_bf16 v[64:79], v[20:23], a[48:51], v[64:79]
    ds_read_b128 v[32:35], v36 offset:13312
    s_add_u32 s28, s16, 61440
    buffer_load_dwordx4 a[240:243], v1, s[8:11], s28 offen offset:0 sc1
    v_mfma_f32_32x32x16_bf16 v[80:95], v[20:23], a[192:195], v[80:95]
    s_waitcnt lgkmcnt(2)
    v_mfma_f32_32x32x16_bf16 v[96:111], v[24:27], a[48:51], v[96:111]
    ds_read_b128 v[20:23], v37 offset:13312
    buffer_load_dwordx4 a[244:247], v1, s[8:11], s28 offen offset:1024 sc1
    v_mfma_f32_32x32x16_bf16 v[112:127], v[24:27], a[192:195], v[112:127]
    s_waitcnt lgkmcnt(2)
    v_mfma_f32_32x32x16_bf16 v[128:143], v[28:31], a[48:51], v[128:143]
    ds_read_b128 v[24:27], v38 offset:13312
    buffer_load_dwordx4 a[248:251], v1, s[8:11], s28 offen offset:2048 sc1
    v_mfma_f32_32x32x16_bf16 v[144:159], v[28:31], a[192:195], v[144:159]
    s_waitcnt lgkmcnt(2)
    s_waitcnt vmcnt(25)
    v_mfma_f32_32x32x16_bf16 v[64:79], v[32:35], a[52:55], v[64:79]
    ds_read_b128 v[28:31], v36 offset:14336
    buffer_load_dwordx4 a[252:255], v1, s[8:11], s28 offen offset:3072 sc1
    v_mfma_f32_32x32x16_bf16 v[80:95], v[32:35], a[196:199], v[80:95]
    s_waitcnt lgkmcnt(2)
    v_mfma_f32_32x32x16_bf16 v[96:111], v[20:23], a[52:55], v[96:111]
    ds_read_b128 v[32:35], v37 offset:14336
    s_add_u32 s28, s16, 28672
    buffer_load_dwordx4 a[112:115], v1, s[8:11], s28 offen offset:0 sc1
    v_mfma_f32_32x32x16_bf16 v[112:127], v[20:23], a[196:199], v[112:127]
    s_waitcnt lgkmcnt(2)
    v_mfma_f32_32x32x16_bf16 v[128:143], v[24:27], a[52:55], v[128:143]
    ds_read_b128 v[20:23], v38 offset:14336
    buffer_load_dwordx4 a[116:119], v1, s[8:11], s28 offen offset:1024 sc1
    v_mfma_f32_32x32x16_bf16 v[144:159], v[24:27], a[196:199], v[144:159]
    s_waitcnt lgkmcnt(2)
    s_waitcnt vmcnt(27)
    v_mfma_f32_32x32x16_bf16 v[64:79], v[28:31], a[56:59], v[64:79]
    ds_read_b128 v[24:27], v36 offset:15360
    buffer_load_dwordx4 a[120:123], v1, s[8:11], s28 offen offset:2048 sc1
    v_mfma_f32_32x32x16_bf16 v[80:95], v[28:31], a[200:203], v[80:95]
    s_waitcnt lgkmcnt(2)
    v_mfma_f32_32x32x16_bf16 v[96:111], v[32:35], a[56:59], v[96:111]
    ds_read_b128 v[28:31], v37 offset:15360
    buffer_load_dwordx4 a[124:127], v1, s[8:11], s28 offen offset:3072 sc1
    v_mfma_f32_32x32x16_bf16 v[112:127], v[32:35], a[200:203], v[112:127]
    s_waitcnt lgkmcnt(2)
    v_mfma_f32_32x32x16_bf16 v[128:143], v[20:23], a[56:59], v[128:143]
    ds_read_b128 v[32:35], v38 offset:15360
    s_add_u32 s28, s16, 65536
    buffer_load_dwordx4 v[224:227], v1, s[8:11], s28 offen offset:0 sc1
    v_mfma_f32_32x32x16_bf16 v[144:159], v[20:23], a[200:203], v[144:159]
    s_waitcnt lgkmcnt(2)
    s_waitcnt vmcnt(29)
    v_mfma_f32_32x32x16_bf16 v[64:79], v[24:27], a[60:63], v[64:79]
    ds_read_b128 v[20:23], v36 offset:16384
    buffer_load_dwordx4 v[228:231], v1, s[8:11], s28 offen offset:1024 sc1
    v_mfma_f32_32x32x16_bf16 v[80:95], v[24:27], a[204:207], v[80:95]
    s_waitcnt lgkmcnt(2)
    v_mfma_f32_32x32x16_bf16 v[96:111], v[28:31], a[60:63], v[96:111]
    ds_read_b128 v[24:27], v37 offset:16384
    buffer_load_dwordx4 v[232:235], v1, s[8:11], s28 offen offset:2048 sc1
    v_mfma_f32_32x32x16_bf16 v[112:127], v[28:31], a[204:207], v[112:127]
    s_waitcnt lgkmcnt(2)
    v_mfma_f32_32x32x16_bf16 v[128:143], v[32:35], a[60:63], v[128:143]
    ds_read_b128 v[28:31], v38 offset:16384
    buffer_load_dwordx4 v[236:239], v1, s[8:11], s28 offen offset:3072 sc1
    v_mfma_f32_32x32x16_bf16 v[144:159], v[32:35], a[204:207], v[144:159]
    s_waitcnt lgkmcnt(2)
    s_waitcnt vmcnt(27)
    v_mfma_f32_32x32x16_bf16 v[64:79], v[20:23], a[64:67], v[64:79]
    ds_read_b128 v[32:35], v36 offset:17408
    s_add_u32 s28, s16, 32768
    buffer_load_dwordx4 a[128:131], v1, s[8:11], s28 offen offset:0 sc1
    v_mfma_f32_32x32x16_bf16 v[80:95], v[20:23], a[208:211], v[80:95]
    s_waitcnt lgkmcnt(2)
    v_mfma_f32_32x32x16_bf16 v[96:111], v[24:27], a[64:67], v[96:111]
    ds_read_b128 v[20:23], v37 offset:17408
    buffer_load_dwordx4 a[132:135], v1, s[8:11], s28 offen offset:1024 sc1
    v_mfma_f32_32x32x16_bf16 v[112:127], v[24:27], a[208:211], v[112:127]
    s_waitcnt lgkmcnt(2)
    v_mfma_f32_32x32x16_bf16 v[128:143], v[28:31], a[64:67], v[128:143]
    ds_read_b128 v[24:27], v38 offset:17408
    buffer_load_dwordx4 a[136:139], v1, s[8:11], s28 offen offset:2048 sc1
    v_mfma_f32_32x32x16_bf16 v[144:159], v[28:31], a[208:211], v[144:159]
    s_waitcnt lgkmcnt(2)
    s_waitcnt vmcnt(29)
    v_mfma_f32_32x32x16_bf16 v[64:79], v[32:35], a[68:71], v[64:79]
    buffer_load_dwordx4 a[140:143], v1, s[8:11], s28 offen offset:3072 sc1
    v_mfma_f32_32x32x16_bf16 v[80:95], v[32:35], a[212:215], v[80:95]
    s_waitcnt vmcnt(63)
    s_barrier
    ds_read_b128 v[28:31], v36 offset:18432
    s_waitcnt lgkmcnt(2)
    v_mfma_f32_32x32x16_bf16 v[96:111], v[20:23], a[68:71], v[96:111]
    ds_read_b128 v[32:35], v37 offset:18432
    s_add_u32 s28, s16, 69632
    buffer_load_dwordx4 v[240:243], v1, s[8:11], s28 offen offset:0 sc1
    v_mfma_f32_32x32x16_bf16 v[112:127], v[20:23], a[212:215], v[112:127]
    s_waitcnt lgkmcnt(2)
    v_mfma_f32_32x32x16_bf16 v[128:143], v[24:27], a[68:71], v[128:143]
    ds_read_b128 v[20:23], v38 offset:18432
    buffer_load_dwordx4 v[244:247], v1, s[8:11], s28 offen offset:1024 sc1
    v_mfma_f32_32x32x16_bf16 v[144:159], v[24:27], a[212:215], v[144:159]
    s_waitcnt lgkmcnt(2)
    s_waitcnt vmcnt(31)
    v_mfma_f32_32x32x16_bf16 v[64:79], v[28:31], a[72:75], v[64:79]
    ds_read_b128 v[24:27], v36 offset:19456
    buffer_load_dwordx4 v[248:251], v1, s[8:11], s28 offen offset:2048 sc1
    v_mfma_f32_32x32x16_bf16 v[80:95], v[28:31], a[216:219], v[80:95]
    s_waitcnt lgkmcnt(2)
    v_mfma_f32_32x32x16_bf16 v[96:111], v[32:35], a[72:75], v[96:111]
    ds_read_b128 v[28:31], v37 offset:19456
    buffer_load_dwordx4 v[252:255], v1, s[8:11], s28 offen offset:3072 sc1
    v_mfma_f32_32x32x16_bf16 v[112:127], v[32:35], a[216:219], v[112:127]
    s_waitcnt lgkmcnt(2)
    v_mfma_f32_32x32x16_bf16 v[128:143], v[20:23], a[72:75], v[128:143]
    ds_read_b128 v[32:35], v38 offset:19456
    v_mfma_f32_32x32x16_bf16 v[144:159], v[20:23], a[216:219], v[144:159]
    s_waitcnt lgkmcnt(2)
    s_waitcnt vmcnt(32)
    v_mfma_f32_32x32x16_bf16 v[64:79], v[24:27], a[76:79], v[64:79]
    ds_read_b128 v[20:23], v36 offset:20480
    v_mfma_f32_32x32x16_bf16 v[80:95], v[24:27], a[220:223], v[80:95]
    s_waitcnt lgkmcnt(2)
    v_mfma_f32_32x32x16_bf16 v[96:111], v[28:31], a[76:79], v[96:111]
    ds_read_b128 v[24:27], v37 offset:20480
    v_mfma_f32_32x32x16_bf16 v[112:127], v[28:31], a[220:223], v[112:127]
    s_waitcnt lgkmcnt(2)
    v_mfma_f32_32x32x16_bf16 v[128:143], v[32:35], a[76:79], v[128:143]
    ds_read_b128 v[28:31], v38 offset:20480
    v_mfma_f32_32x32x16_bf16 v[144:159], v[32:35], a[220:223], v[144:159]
    s_waitcnt lgkmcnt(2)
    s_waitcnt vmcnt(27)
    v_mfma_f32_32x32x16_bf16 v[64:79], v[20:23], a[80:83], v[64:79]
    ds_read_b128 v[32:35], v36 offset:21504
    v_mfma_f32_32x32x16_bf16 v[80:95], v[20:23], a[224:227], v[80:95]
    s_waitcnt lgkmcnt(2)
    v_mfma_f32_32x32x16_bf16 v[96:111], v[24:27], a[80:83], v[96:111]
    ds_read_b128 v[20:23], v37 offset:21504
    v_mfma_f32_32x32x16_bf16 v[112:127], v[24:27], a[224:227], v[112:127]
    s_waitcnt lgkmcnt(2)
    v_mfma_f32_32x32x16_bf16 v[128:143], v[28:31], a[80:83], v[128:143]
    ds_read_b128 v[24:27], v38 offset:21504
    v_mfma_f32_32x32x16_bf16 v[144:159], v[28:31], a[224:227], v[144:159]
    s_waitcnt lgkmcnt(2)
    s_waitcnt vmcnt(26)
    v_mfma_f32_32x32x16_bf16 v[64:79], v[32:35], a[84:87], v[64:79]
    ds_read_b128 v[28:31], v36 offset:22528
    v_mfma_f32_32x32x16_bf16 v[80:95], v[32:35], a[228:231], v[80:95]
    s_waitcnt lgkmcnt(2)
    v_mfma_f32_32x32x16_bf16 v[96:111], v[20:23], a[84:87], v[96:111]
    ds_read_b128 v[32:35], v37 offset:22528
    v_mfma_f32_32x32x16_bf16 v[112:127], v[20:23], a[228:231], v[112:127]
    s_waitcnt lgkmcnt(2)
    v_mfma_f32_32x32x16_bf16 v[128:143], v[24:27], a[84:87], v[128:143]
    ds_read_b128 v[20:23], v38 offset:22528
    v_mfma_f32_32x32x16_bf16 v[144:159], v[24:27], a[228:231], v[144:159]
    s_waitcnt lgkmcnt(2)
    s_waitcnt vmcnt(25)
    v_mfma_f32_32x32x16_bf16 v[64:79], v[28:31], a[88:91], v[64:79]
    ds_read_b128 v[24:27], v36 offset:23552
    v_mfma_f32_32x32x16_bf16 v[80:95], v[28:31], a[232:235], v[80:95]
    s_waitcnt lgkmcnt(2)
    v_mfma_f32_32x32x16_bf16 v[96:111], v[32:35], a[88:91], v[96:111]
    ds_read_b128 v[28:31], v37 offset:23552
    v_mfma_f32_32x32x16_bf16 v[112:127], v[32:35], a[232:235], v[112:127]
    s_waitcnt lgkmcnt(2)
    v_mfma_f32_32x32x16_bf16 v[128:143], v[20:23], a[88:91], v[128:143]
    ds_read_b128 v[32:35], v38 offset:23552
    v_mfma_f32_32x32x16_bf16 v[144:159], v[20:23], a[232:235], v[144:159]
    s_waitcnt lgkmcnt(2)
    s_waitcnt vmcnt(24)
    v_mfma_f32_32x32x16_bf16 v[64:79], v[24:27], a[92:95], v[64:79]
    ds_read_b128 v[20:23], v36 offset:24576
    v_mfma_f32_32x32x16_bf16 v[80:95], v[24:27], a[236:239], v[80:95]
    s_waitcnt lgkmcnt(2)
    v_mfma_f32_32x32x16_bf16 v[96:111], v[28:31], a[92:95], v[96:111]
    ds_read_b128 v[24:27], v37 offset:24576
    v_mfma_f32_32x32x16_bf16 v[112:127], v[28:31], a[236:239], v[112:127]
    s_waitcnt lgkmcnt(2)
    v_mfma_f32_32x32x16_bf16 v[128:143], v[32:35], a[92:95], v[128:143]
    ds_read_b128 v[28:31], v38 offset:24576
    v_mfma_f32_32x32x16_bf16 v[144:159], v[32:35], a[236:239], v[144:159]
    s_waitcnt lgkmcnt(2)
    s_waitcnt vmcnt(19)
    v_mfma_f32_32x32x16_bf16 v[64:79], v[20:23], a[96:99], v[64:79]
    ds_read_b128 v[32:35], v36 offset:25600
    v_mfma_f32_32x32x16_bf16 v[80:95], v[20:23], a[240:243], v[80:95]
    s_waitcnt lgkmcnt(2)
    v_mfma_f32_32x32x16_bf16 v[96:111], v[24:27], a[96:99], v[96:111]
    ds_read_b128 v[20:23], v37 offset:25600
    v_mfma_f32_32x32x16_bf16 v[112:127], v[24:27], a[240:243], v[112:127]
    s_waitcnt lgkmcnt(2)
    v_mfma_f32_32x32x16_bf16 v[128:143], v[28:31], a[96:99], v[128:143]
    ds_read_b128 v[24:27], v38 offset:25600
    v_mfma_f32_32x32x16_bf16 v[144:159], v[28:31], a[240:243], v[144:159]
    s_waitcnt lgkmcnt(2)
    s_waitcnt vmcnt(18)
    v_mfma_f32_32x32x16_bf16 v[64:79], v[32:35], a[100:103], v[64:79]
    ds_read_b128 v[28:31], v36 offset:26624
    v_mfma_f32_32x32x16_bf16 v[80:95], v[32:35], a[244:247], v[80:95]
    s_waitcnt lgkmcnt(2)
    v_mfma_f32_32x32x16_bf16 v[96:111], v[20:23], a[100:103], v[96:111]
    ds_read_b128 v[32:35], v37 offset:26624
    v_mfma_f32_32x32x16_bf16 v[112:127], v[20:23], a[244:247], v[112:127]
    s_waitcnt lgkmcnt(2)
    v_mfma_f32_32x32x16_bf16 v[128:143], v[24:27], a[100:103], v[128:143]
    ds_read_b128 v[20:23], v38 offset:26624
    v_mfma_f32_32x32x16_bf16 v[144:159], v[24:27], a[244:247], v[144:159]
    s_waitcnt lgkmcnt(2)
    s_waitcnt vmcnt(17)
    v_mfma_f32_32x32x16_bf16 v[64:79], v[28:31], a[104:107], v[64:79]
    ds_read_b128 v[24:27], v36 offset:27648
    v_mfma_f32_32x32x16_bf16 v[80:95], v[28:31], a[248:251], v[80:95]
    s_waitcnt lgkmcnt(2)
    v_mfma_f32_32x32x16_bf16 v[96:111], v[32:35], a[104:107], v[96:111]
    ds_read_b128 v[28:31], v37 offset:27648
    v_mfma_f32_32x32x16_bf16 v[112:127], v[32:35], a[248:251], v[112:127]
    s_waitcnt lgkmcnt(2)
    v_mfma_f32_32x32x16_bf16 v[128:143], v[20:23], a[104:107], v[128:143]
    ds_read_b128 v[32:35], v38 offset:27648
    v_mfma_f32_32x32x16_bf16 v[144:159], v[20:23], a[248:251], v[144:159]
    s_waitcnt lgkmcnt(2)
    s_waitcnt vmcnt(16)
    v_mfma_f32_32x32x16_bf16 v[64:79], v[24:27], a[108:111], v[64:79]
    ds_read_b128 v[20:23], v36 offset:28672
    v_mfma_f32_32x32x16_bf16 v[80:95], v[24:27], a[252:255], v[80:95]
    s_waitcnt lgkmcnt(2)
    v_mfma_f32_32x32x16_bf16 v[96:111], v[28:31], a[108:111], v[96:111]
    ds_read_b128 v[24:27], v37 offset:28672
    v_mfma_f32_32x32x16_bf16 v[112:127], v[28:31], a[252:255], v[112:127]
    s_waitcnt lgkmcnt(2)
    v_mfma_f32_32x32x16_bf16 v[128:143], v[32:35], a[108:111], v[128:143]
    ds_read_b128 v[28:31], v38 offset:28672
    v_mfma_f32_32x32x16_bf16 v[144:159], v[32:35], a[252:255], v[144:159]
    s_waitcnt lgkmcnt(2)
    s_waitcnt vmcnt(11)
    v_mfma_f32_32x32x16_bf16 v[64:79], v[20:23], a[112:115], v[64:79]
    ds_read_b128 v[32:35], v36 offset:29696
    v_mfma_f32_32x32x16_bf16 v[80:95], v[20:23], v[224:227], v[80:95]
    s_waitcnt lgkmcnt(2)
    v_mfma_f32_32x32x16_bf16 v[96:111], v[24:27], a[112:115], v[96:111]
    ds_read_b128 v[20:23], v37 offset:29696
    v_mfma_f32_32x32x16_bf16 v[112:127], v[24:27], v[224:227], v[112:127]
    s_waitcnt lgkmcnt(2)
    v_mfma_f32_32x32x16_bf16 v[128:143], v[28:31], a[112:115], v[128:143]
    ds_read_b128 v[24:27], v38 offset:29696
    v_mfma_f32_32x32x16_bf16 v[144:159], v[28:31], v[224:227], v[144:159]
    s_waitcnt lgkmcnt(2)
    s_waitcnt vmcnt(10)
    v_mfma_f32_32x32x16_bf16 v[64:79], v[32:35], a[116:119], v[64:79]
    ds_read_b128 v[28:31], v36 offset:30720
    v_mfma_f32_32x32x16_bf16 v[80:95], v[32:35], v[228:231], v[80:95]
    s_waitcnt lgkmcnt(2)
    v_mfma_f32_32x32x16_bf16 v[96:111], v[20:23], a[116:119], v[96:111]
    ds_read_b128 v[32:35], v37 offset:30720
    v_mfma_f32_32x32x16_bf16 v[112:127], v[20:23], v[228:231], v[112:127]
    s_waitcnt lgkmcnt(2)
    v_mfma_f32_32x32x16_bf16 v[128:143], v[24:27], a[116:119], v[128:143]
    ds_read_b128 v[20:23], v38 offset:30720
    v_mfma_f32_32x32x16_bf16 v[144:159], v[24:27], v[228:231], v[144:159]
    s_waitcnt lgkmcnt(2)
    s_waitcnt vmcnt(9)
    v_mfma_f32_32x32x16_bf16 v[64:79], v[28:31], a[120:123], v[64:79]
    ds_read_b128 v[24:27], v36 offset:31744
    v_mfma_f32_32x32x16_bf16 v[80:95], v[28:31], v[232:235], v[80:95]
    s_waitcnt lgkmcnt(2)
    v_mfma_f32_32x32x16_bf16 v[96:111], v[32:35], a[120:123], v[96:111]
    ds_read_b128 v[28:31], v37 offset:31744
    v_mfma_f32_32x32x16_bf16 v[112:127], v[32:35], v[232:235], v[112:127]
    s_waitcnt lgkmcnt(2)
    v_mfma_f32_32x32x16_bf16 v[128:143], v[20:23], a[120:123], v[128:143]
    ds_read_b128 v[32:35], v38 offset:31744
    v_mfma_f32_32x32x16_bf16 v[144:159], v[20:23], v[232:235], v[144:159]
    s_waitcnt lgkmcnt(2)
    s_waitcnt vmcnt(8)
    v_mfma_f32_32x32x16_bf16 v[64:79], v[24:27], a[124:127], v[64:79]
    ds_read_b128 v[20:23], v36 offset:32768
    v_mfma_f32_32x32x16_bf16 v[80:95], v[24:27], v[236:239], v[80:95]
    s_waitcnt lgkmcnt(2)
    v_mfma_f32_32x32x16_bf16 v[96:111], v[28:31], a[124:127], v[96:111]
    ds_read_b128 v[24:27], v37 offset:32768
    v_mfma_f32_32x32x16_bf16 v[112:127], v[28:31], v[236:239], v[112:127]
    s_waitcnt lgkmcnt(2)
    v_mfma_f32_32x32x16_bf16 v[128:143], v[32:35], a[124:127], v[128:143]
    ds_read_b128 v[28:31], v38 offset:32768
    v_mfma_f32_32x32x16_bf16 v[144:159], v[32:35], v[236:239], v[144:159]
    s_waitcnt lgkmcnt(2)
    s_waitcnt vmcnt(3)
    v_mfma_f32_32x32x16_bf16 v[64:79], v[20:23], a[128:131], v[64:79]
    ds_read_b128 v[32:35], v36 offset:33792
    v_mfma_f32_32x32x16_bf16 v[80:95], v[20:23], v[240:243], v[80:95]
    s_waitcnt lgkmcnt(2)
    v_mfma_f32_32x32x16_bf16 v[96:111], v[24:27], a[128:131], v[96:111]
    ds_read_b128 v[20:23], v37 offset:33792
    v_mfma_f32_32x32x16_bf16 v[112:127], v[24:27], v[240:243], v[112:127]
    s_waitcnt lgkmcnt(2)
    v_mfma_f32_32x32x16_bf16 v[128:143], v[28:31], a[128:131], v[128:143]
    ds_read_b128 v[24:27], v38 offset:33792
    v_mfma_f32_32x32x16_bf16 v[144:159], v[28:31], v[240:243], v[144:159]
    s_waitcnt lgkmcnt(2)
    s_waitcnt vmcnt(2)
    v_mfma_f32_32x32x16_bf16 v[64:79], v[32:35], a[132:135], v[64:79]
    ds_read_b128 v[28:31], v36 offset:34816
    v_mfma_f32_32x32x16_bf16 v[80:95], v[32:35], v[244:247], v[80:95]
    s_waitcnt lgkmcnt(2)
    v_mfma_f32_32x32x16_bf16 v[96:111], v[20:23], a[132:135], v[96:111]
    ds_read_b128 v[32:35], v37 offset:34816
    v_mfma_f32_32x32x16_bf16 v[112:127], v[20:23], v[244:247], v[112:127]
    s_waitcnt lgkmcnt(2)
    v_mfma_f32_32x32x16_bf16 v[128:143], v[24:27], a[132:135], v[128:143]
    ds_read_b128 v[20:23], v38 offset:34816
    v_mfma_f32_32x32x16_bf16 v[144:159], v[24:27], v[244:247], v[144:159]
    s_waitcnt lgkmcnt(2)
    s_waitcnt vmcnt(1)
    v_mfma_f32_32x32x16_bf16 v[64:79], v[28:31], a[136:139], v[64:79]
    ds_read_b128 v[24:27], v36 offset:35840
    v_mfma_f32_32x32x16_bf16 v[80:95], v[28:31], v[248:251], v[80:95]
    s_waitcnt lgkmcnt(2)
    v_mfma_f32_32x32x16_bf16 v[96:111], v[32:35], a[136:139], v[96:111]
    ds_read_b128 v[28:31], v37 offset:35840
    v_mfma_f32_32x32x16_bf16 v[112:127], v[32:35], v[248:251], v[112:127]
    s_waitcnt lgkmcnt(2)
    v_mfma_f32_32x32x16_bf16 v[128:143], v[20:23], a[136:139], v[128:143]
    ds_read_b128 v[32:35], v38 offset:35840
    v_mfma_f32_32x32x16_bf16 v[144:159], v[20:23], v[248:251], v[144:159]
    s_waitcnt lgkmcnt(2)
    s_waitcnt vmcnt(0)
    v_mfma_f32_32x32x16_bf16 v[64:79], v[24:27], a[140:143], v[64:79]
    v_mfma_f32_32x32x16_bf16 v[80:95], v[24:27], v[252:255], v[80:95]
    s_waitcnt lgkmcnt(0)
    s_barrier
    ds_read_b128 v[20:23], v39 offset:0
    v_mfma_f32_32x32x16_bf16 v[96:111], v[28:31], a[140:143], v[96:111]
    ds_read_b128 v[24:27], v39 offset:1024
    s_add_u32 m0, s24, 0
    s_add_u32 s27, s23, 147456
    buffer_load_dwordx4 v1, s[8:11], s27 offen offset:0  lds
    v_mfma_f32_32x32x16_bf16 v[112:127], v[28:31], v[252:255], v[112:127]
    v_mfma_f32_32x32x16_bf16 v[128:143], v[32:35], a[140:143], v[128:143]
    ds_read_b128 v[28:31], v39 offset:2048
    buffer_load_dwordx4 v1, s[8:11], s27 offen offset:1024  lds
    v_mul_f32 v10, v64, v64
    v_mfma_f32_32x32x16_bf16 v[144:159], v[32:35], v[252:255], v[144:159]
    v_mul_f32 v11, v65, v65
    v_mul_f32 v12, v66, v66
    v_mul_f32 v13, v67, v67
    v_fma_f32 v10, v10, v5, v4
    v_fma_f32 v11, v11, v5, v4
    v_fma_f32 v12, v12, v5, v4
    s_waitcnt lgkmcnt(2)
    v_mfma_f32_32x32x16_bf16 v[160:175], v[20:23], a[0:3], 0
    ds_read_b128 v[32:35], v39 offset:3072
    buffer_load_dwordx4 v1, s[8:11], s27 offen offset:2048  lds
    v_fma_f32 v13, v13, v5, v4
    v_mfma_f32_32x32x16_bf16 v[176:191], v[20:23], a[144:147], 0
    v_mul_f32 v10, v64, v10
    v_mul_f32 v11, v65, v11
    v_mul_f32 v12, v66, v12
    v_mul_f32 v13, v67, v13
    v_exp_f32 v10, v10
    s_waitcnt lgkmcnt(2)
    v_mfma_f32_32x32x16_bf16 v[160:175], v[24:27], a[4:7], v[160:175]
    ds_read_b128 v[20:23], v39 offset:4096
    buffer_load_dwordx4 v1, s[8:11], s27 offen offset:3072  lds
    v_mfma_f32_32x32x16_bf16 v[176:191], v[24:27], a[148:151], v[176:191]
    v_exp_f32 v11, v11
    v_exp_f32 v12, v12
    v_exp_f32 v13, v13
    s_waitcnt lgkmcnt(2)
    v_mfma_f32_32x32x16_bf16 v[160:175], v[28:31], a[8:11], v[160:175]
    ds_read_b128 v[24:27], v39 offset:5120
    s_add_u32 m0, s24, 4096
    s_add_u32 s27, s23, 151552
    buffer_load_dwordx4 v1, s[8:11], s27 offen offset:0  lds
    v_mfma_f32_32x32x16_bf16 v[176:191], v[28:31], a[152:155], v[176:191]
    v_mul_f32 v72, v64, v72
    v_mul_f32 v73, v65, v73
    v_mul_f32 v74, v66, v74
    v_mul_f32 v75, v67, v75
    v_fma_f32 v10, v10, v6, v6
    v_fma_f32 v11, v11, v6, v6
    s_waitcnt lgkmcnt(2)
    v_mfma_f32_32x32x16_bf16 v[160:175], v[32:35], a[12:15], v[160:175]
    ds_read_b128 v[28:31], v39 offset:6144
    buffer_load_dwordx4 v1, s[8:11], s27 offen offset:1024  lds
    v_fma_f32 v12, v12, v6, v6
    v_mfma_f32_32x32x16_bf16 v[176:191], v[32:35], a[156:159], v[176:191]
    v_fma_f32 v13, v13, v6, v6
    v_rcp_f32 v10, v10
    v_rcp_f32 v11, v11
    s_waitcnt lgkmcnt(2)
    v_mfma_f32_32x32x16_bf16 v[160:175], v[20:23], a[16:19], v[160:175]
    ds_read_b128 v[32:35], v39 offset:7168
    buffer_load_dwordx4 v1, s[8:11], s27 offen offset:2048  lds
    v_mfma_f32_32x32x16_bf16 v[176:191], v[20:23], a[160:163], v[176:191]
    v_rcp_f32 v12, v12
    v_rcp_f32 v13, v13
    s_nop 0
    v_mul_f32 v72, v72, v10
    s_waitcnt lgkmcnt(2)
    v_mfma_f32_32x32x16_bf16 v[160:175], v[24:27], a[20:23], v[160:175]
    ds_read_b128 v[20:23], v39 offset:8192
    buffer_load_dwordx4 v1, s[8:11], s27 offen offset:3072  lds
    v_mul_f32 v73, v73, v11
    v_mfma_f32_32x32x16_bf16 v[176:191], v[24:27], a[164:167], v[176:191]
    v_mul_f32 v74, v74, v12
    v_mul_f32 v75, v75, v13
    v_cvt_pk_bf16_f32 v64, v72, v73
    v_cvt_pk_bf16_f32 v65, v74, v75
    v_mul_f32 v14, v68, v68
    v_mul_f32 v15, v69, v69
    s_waitcnt lgkmcnt(2)
    v_mfma_f32_32x32x16_bf16 v[160:175], v[28:31], a[24:27], v[160:175]
    ds_read_b128 v[24:27], v39 offset:9216
    s_add_u32 m0, s24, 8192
    s_add_u32 s27, s23, 155648
    buffer_load_dwordx4 v1, s[8:11], s27 offen offset:0  lds
    v_mfma_f32_32x32x16_bf16 v[176:191], v[28:31], a[168:171], v[176:191]
    v_mul_f32 v16, v70, v70
    v_mul_f32 v17, v71, v71
    v_fma_f32 v14, v14, v5, v4
    v_fma_f32 v15, v15, v5, v4
    v_fma_f32 v16, v16, v5, v4
    v_fma_f32 v17, v17, v5, v4
    s_waitcnt lgkmcnt(2)
    v_mfma_f32_32x32x16_bf16 v[160:175], v[32:35], a[28:31], v[160:175]
    ds_read_b128 v[28:31], v39 offset:10240
    s_add_u32 m0, s24, 36864
    s_add_u32 s27, s23, 184320
    buffer_load_dwordx4 v1, s[8:11], s27 offen offset:0  lds
    v_mfma_f32_32x32x16_bf16 v[176:191], v[32:35], a[172:175], v[176:191]
    v_mul_f32 v14, v68, v14
    v_mul_f32 v15, v69, v15
    v_mul_f32 v16, v70, v16
    v_mul_f32 v17, v71, v17
    v_exp_f32 v14, v14
    s_waitcnt lgkmcnt(2)
    v_mfma_f32_32x32x16_bf16 v[160:175], v[20:23], a[32:35], v[160:175]
    ds_read_b128 v[32:35], v39 offset:11264
    buffer_load_dwordx4 v1, s[8:11], s27 offen offset:1024  lds
    v_mfma_f32_32x32x16_bf16 v[176:191], v[20:23], a[176:179], v[176:191]
    v_exp_f32 v15, v15
    v_exp_f32 v16, v16
    v_exp_f32 v17, v17
    s_waitcnt lgkmcnt(2)
    v_mfma_f32_32x32x16_bf16 v[160:175], v[24:27], a[36:39], v[160:175]
    ds_read_b128 v[20:23], v39 offset:12288
    buffer_load_dwordx4 v1, s[8:11], s27 offen offset:2048  lds
    v_mul_f32 v76, v68, v76
    v_mfma_f32_32x32x16_bf16 v[176:191], v[24:27], a[180:183], v[176:191]
    v_mul_f32 v77, v69, v77
    v_mul_f32 v78, v70, v78
    v_mul_f32 v79, v71, v79
    v_fma_f32 v14, v14, v6, v6
    v_fma_f32 v15, v15, v6, v6
    v_fma_f32 v16, v16, v6, v6
    s_waitcnt lgkmcnt(2)
    v_mfma_f32_32x32x16_bf16 v[160:175], v[28:31], a[40:43], v[160:175]
    ds_read_b128 v[24:27], v39 offset:13312
    buffer_load_dwordx4 v1, s[8:11], s27 offen offset:3072  lds
    v_fma_f32 v17, v17, v6, v6
    v_mfma_f32_32x32x16_bf16 v[176:191], v[28:31], a[184:187], v[176:191]
    v_rcp_f32 v14, v14
    v_rcp_f32 v15, v15
    v_rcp_f32 v16, v16
    s_waitcnt lgkmcnt(2)
    v_mfma_f32_32x32x16_bf16 v[160:175], v[32:35], a[44:47], v[160:175]
    ds_read_b128 v[28:31], v39 offset:14336
    s_add_u32 m0, s24, 40960
    s_add_u32 s27, s23, 188416
    buffer_load_dwordx4 v1, s[8:11], s27 offen offset:0  lds
    v_mfma_f32_32x32x16_bf16 v[176:191], v[32:35], a[188:191], v[176:191]
    v_rcp_f32 v17, v17
    s_nop 0
    v_mul_f32 v76, v76, v14
    v_mul_f32 v77, v77, v15
    v_mul_f32 v78, v78, v16
    s_waitcnt lgkmcnt(2)
    v_mfma_f32_32x32x16_bf16 v[160:175], v[20:23], a[48:51], v[160:175]
    ds_read_b128 v[32:35], v39 offset:15360
    buffer_load_dwordx4 v1, s[8:11], s27 offen offset:1024  lds
    v_mul_f32 v79, v79, v17
    v_mfma_f32_32x32x16_bf16 v[176:191], v[20:23], a[192:195], v[176:191]
    v_cvt_pk_bf16_f32 v66, v76, v77
    v_cvt_pk_bf16_f32 v67, v78, v79
    s_add_u32 s29, s20, 0
    s_waitcnt lgkmcnt(2)
    v_mfma_f32_32x32x16_bf16 v[160:175], v[24:27], a[52:55], v[160:175]
    ds_read_b128 v[20:23], v39 offset:16384
    buffer_load_dwordx4 v1, s[8:11], s27 offen offset:2048  lds
    v_mfma_f32_32x32x16_bf16 v[176:191], v[24:27], a[196:199], v[176:191]
    buffer_store_dwordx4 v[64:67], v2, s[8:11], s29 offen sc1
    v_mul_f32 v10, v80, v80
    v_mul_f32 v11, v81, v81
    s_waitcnt lgkmcnt(2)
    v_mfma_f32_32x32x16_bf16 v[160:175], v[28:31], a[56:59], v[160:175]
    ds_read_b128 v[24:27], v39 offset:17408
    buffer_load_dwordx4 v1, s[8:11], s27 offen offset:3072  lds
    v_mul_f32 v12, v82, v82
    v_mfma_f32_32x32x16_bf16 v[176:191], v[28:31], a[200:203], v[176:191]
    v_mul_f32 v13, v83, v83
    v_fma_f32 v10, v10, v8, v7
    v_fma_f32 v11, v11, v8, v7
    v_fma_f32 v12, v12, v8, v7
    v_fma_f32 v13, v13, v8, v7
    v_mul_f32 v10, v80, v10
    s_waitcnt lgkmcnt(2)
    v_mfma_f32_32x32x16_bf16 v[160:175], v[32:35], a[60:63], v[160:175]
    ds_read_b128 v[28:31], v39 offset:18432
    s_add_u32 m0, s24, 45056
    s_add_u32 s27, s23, 192512
    buffer_load_dwordx4 v1, s[8:11], s27 offen offset:0  lds
    v_mfma_f32_32x32x16_bf16 v[176:191], v[32:35], a[204:207], v[176:191]
    v_mul_f32 v11, v81, v11
    v_mul_f32 v12, v82, v12
    v_mul_f32 v13, v83, v13
    v_exp_f32 v10, v10
    s_waitcnt lgkmcnt(2)
    v_mfma_f32_32x32x16_bf16 v[160:175], v[20:23], a[64:67], v[160:175]
    ds_read_b128 v[32:35], v39 offset:19456
    s_add_u32 m0, s24, 73728
    s_add_u32 s27, s23, 221184
    buffer_load_dwordx4 v1, s[8:11], s27 offen offset:0  lds
    v_mfma_f32_32x32x16_bf16 v[176:191], v[20:23], a[208:211], v[176:191]
    v_exp_f32 v11, v11
    v_exp_f32 v12, v12
    v_exp_f32 v13, v13
    s_waitcnt lgkmcnt(2)
    v_mfma_f32_32x32x16_bf16 v[160:175], v[24:27], a[68:71], v[160:175]
    ds_read_b128 v[20:23], v39 offset:20480
    buffer_load_dwordx4 v1, s[8:11], s27 offen offset:1024  lds
    v_mul_f32 v88, v80, v88
    v_mfma_f32_32x32x16_bf16 v[176:191], v[24:27], a[212:215], v[176:191]
    v_mul_f32 v89, v81, v89
    v_mul_f32 v90, v82, v90
    v_mul_f32 v91, v83, v91
    v_fma_f32 v10, v10, v9, v9
    v_fma_f32 v11, v11, v9, v9
    v_fma_f32 v12, v12, v9, v9
    s_waitcnt lgkmcnt(2)
    v_mfma_f32_32x32x16_bf16 v[160:175], v[28:31], a[72:75], v[160:175]
    ds_read_b128 v[24:27], v39 offset:21504
    buffer_load_dwordx4 v1, s[8:11], s27 offen offset:2048  lds
    v_fma_f32 v13, v13, v9, v9
    v_mfma_f32_32x32x16_bf16 v[176:191], v[28:31], a[216:219], v[176:191]
    v_rcp_f32 v10, v10
    v_rcp_f32 v11, v11
    v_rcp_f32 v12, v12
    s_waitcnt lgkmcnt(2)
    v_mfma_f32_32x32x16_bf16 v[160:175], v[32:35], a[76:79], v[160:175]
    ds_read_b128 v[28:31], v39 offset:22528
    buffer_load_dwordx4 v1, s[8:11], s27 offen offset:3072  lds
    v_mfma_f32_32x32x16_bf16 v[176:191], v[32:35], a[220:223], v[176:191]
    v_rcp_f32 v13, v13
    s_nop 0
    v_mul_f32 v88, v88, v10
    v_mul_f32 v89, v89, v11
    v_mul_f32 v90, v90, v12
    s_waitcnt lgkmcnt(2)
    v_mfma_f32_32x32x16_bf16 v[160:175], v[20:23], a[80:83], v[160:175]
    ds_read_b128 v[32:35], v39 offset:23552
    s_add_u32 m0, s24, 77824
    s_add_u32 s27, s23, 225280
    buffer_load_dwordx4 v1, s[8:11], s27 offen offset:0  lds
    v_mfma_f32_32x32x16_bf16 v[176:191], v[20:23], a[224:227], v[176:191]
    v_mul_f32 v91, v91, v13
    v_cvt_pk_bf16_f32 v80, v88, v89
    v_cvt_pk_bf16_f32 v81, v90, v91
    v_mul_f32 v14, v84, v84
    v_mul_f32 v15, v85, v85
    v_mul_f32 v16, v86, v86
    s_waitcnt lgkmcnt(2)
    v_mfma_f32_32x32x16_bf16 v[160:175], v[24:27], a[84:87], v[160:175]
    ds_read_b128 v[20:23], v39 offset:24576
    buffer_load_dwordx4 v1, s[8:11], s27 offen offset:1024  lds
    v_mul_f32 v17, v87, v87
    v_mfma_f32_32x32x16_bf16 v[176:191], v[24:27], a[228:231], v[176:191]
    v_fma_f32 v14, v14, v8, v7
    v_fma_f32 v15, v15, v8, v7
    v_fma_f32 v16, v16, v8, v7
    v_fma_f32 v17, v17, v8, v7
    v_mul_f32 v14, v84, v14
    v_mul_f32 v15, v85, v15
    s_waitcnt lgkmcnt(2)
    v_mfma_f32_32x32x16_bf16 v[160:175], v[28:31], a[88:91], v[160:175]
    ds_read_b128 v[24:27], v39 offset:25600
    buffer_load_dwordx4 v1, s[8:11], s27 offen offset:2048  lds
    v_mul_f32 v16, v86, v16
    v_mfma_f32_32x32x16_bf16 v[176:191], v[28:31], a[232:235], v[176:191]
    v_mul_f32 v17, v87, v17
    v_exp_f32 v14, v14
    v_exp_f32 v15, v15
    s_waitcnt lgkmcnt(2)
    v_mfma_f32_32x32x16_bf16 v[160:175], v[32:35], a[92:95], v[160:175]
    ds_read_b128 v[28:31], v39 offset:26624
    buffer_load_dwordx4 v1, s[8:11], s27 offen offset:3072  lds
    v_mfma_f32_32x32x16_bf16 v[176:191], v[32:35], a[236:239], v[176:191]
    v_exp_f32 v16, v16
    v_exp_f32 v17, v17
    v_mul_f32 v92, v84, v92
    v_mul_f32 v93, v85, v93
    s_waitcnt lgkmcnt(2)
    v_mfma_f32_32x32x16_bf16 v[160:175], v[20:23], a[96:99], v[160:175]
    ds_read_b128 v[32:35], v39 offset:27648
    s_add_u32 m0, s24, 81920
    s_add_u32 s27, s23, 229376
    buffer_load_dwordx4 v1, s[8:11], s27 offen offset:0  lds
    v_mfma_f32_32x32x16_bf16 v[176:191], v[20:23], a[240:243], v[176:191]
    v_mul_f32 v94, v86, v94
    v_mul_f32 v95, v87, v95
    v_fma_f32 v14, v14, v9, v9
    v_fma_f32 v15, v15, v9, v9
    v_fma_f32 v16, v16, v9, v9
    v_fma_f32 v17, v17, v9, v9
    s_waitcnt lgkmcnt(2)
    v_mfma_f32_32x32x16_bf16 v[160:175], v[24:27], a[100:103], v[160:175]
    ds_read_b128 v[20:23], v39 offset:28672
    v_rcp_f32 v14, v14
    v_rcp_f32 v15, v15
    v_mfma_f32_32x32x16_bf16 v[176:191], v[24:27], a[244:247], v[176:191]
    v_rcp_f32 v16, v16
    v_rcp_f32 v17, v17
    s_nop 0
    v_mul_f32 v92, v92, v14
    s_waitcnt lgkmcnt(2)
    v_mfma_f32_32x32x16_bf16 v[160:175], v[28:31], a[104:107], v[160:175]
    ds_read_b128 v[24:27], v39 offset:29696
    v_mul_f32 v93, v93, v15
    v_mul_f32 v94, v94, v16
    v_mul_f32 v95, v95, v17
    v_cvt_pk_bf16_f32 v82, v92, v93
    v_cvt_pk_bf16_f32 v83, v94, v95
    v_mfma_f32_32x32x16_bf16 v[176:191], v[28:31], a[248:251], v[176:191]
    s_add_u32 s29, s20, 294912
    buffer_store_dwordx4 v[80:83], v2, s[8:11], s29 offen sc1
    v_mul_f32 v10, v96, v96
    s_waitcnt lgkmcnt(2)
    v_mfma_f32_32x32x16_bf16 v[160:175], v[32:35], a[108:111], v[160:175]
    ds_read_b128 v[28:31], v39 offset:30720
    v_mul_f32 v11, v97, v97
    v_mul_f32 v12, v98, v98
    v_mul_f32 v13, v99, v99
    v_fma_f32 v10, v10, v5, v4
    v_fma_f32 v11, v11, v5, v4
    v_mfma_f32_32x32x16_bf16 v[176:191], v[32:35], a[252:255], v[176:191]
    v_fma_f32 v12, v12, v5, v4
    v_fma_f32 v13, v13, v5, v4
    v_mul_f32 v10, v96, v10
    v_mul_f32 v11, v97, v11
    v_mul_f32 v12, v98, v12
    v_mul_f32 v13, v99, v13
    s_waitcnt lgkmcnt(2)
    v_mfma_f32_32x32x16_bf16 v[160:175], v[20:23], a[112:115], v[160:175]
    ds_read_b128 v[32:35], v39 offset:31744
    v_exp_f32 v10, v10
    v_exp_f32 v11, v11
    v_mfma_f32_32x32x16_bf16 v[176:191], v[20:23], v[224:227], v[176:191]
    v_exp_f32 v12, v12
    v_exp_f32 v13, v13
    v_mul_f32 v104, v96, v104
    v_mul_f32 v105, v97, v105
    s_waitcnt lgkmcnt(2)
    v_mfma_f32_32x32x16_bf16 v[160:175], v[24:27], a[116:119], v[160:175]
    ds_read_b128 v[20:23], v39 offset:32768
    v_mul_f32 v106, v98, v106
    v_mul_f32 v107, v99, v107
    v_fma_f32 v10, v10, v6, v6
    v_fma_f32 v11, v11, v6, v6
    v_fma_f32 v12, v12, v6, v6
    v_mfma_f32_32x32x16_bf16 v[176:191], v[24:27], v[228:231], v[176:191]
    v_fma_f32 v13, v13, v6, v6
    v_rcp_f32 v10, v10
    v_rcp_f32 v11, v11
    s_waitcnt lgkmcnt(2)
    v_mfma_f32_32x32x16_bf16 v[160:175], v[28:31], a[120:123], v[160:175]
    ds_read_b128 v[24:27], v39 offset:33792
    v_rcp_f32 v12, v12
    v_rcp_f32 v13, v13
    s_nop 0
    v_mfma_f32_32x32x16_bf16 v[176:191], v[28:31], v[232:235], v[176:191]
    v_mul_f32 v104, v104, v10
    v_mul_f32 v105, v105, v11
    v_mul_f32 v106, v106, v12
    v_mul_f32 v107, v107, v13
    v_cvt_pk_bf16_f32 v96, v104, v105
    v_cvt_pk_bf16_f32 v97, v106, v107
    s_waitcnt lgkmcnt(2)
    v_mfma_f32_32x32x16_bf16 v[160:175], v[32:35], a[124:127], v[160:175]
    ds_read_b128 v[28:31], v39 offset:34816
    v_mul_f32 v14, v100, v100
    v_mul_f32 v15, v101, v101
    v_mul_f32 v16, v102, v102
    v_mul_f32 v17, v103, v103
    v_fma_f32 v14, v14, v5, v4
    v_mfma_f32_32x32x16_bf16 v[176:191], v[32:35], v[236:239], v[176:191]
    v_fma_f32 v15, v15, v5, v4
    v_fma_f32 v16, v16, v5, v4
    v_fma_f32 v17, v17, v5, v4
    v_mul_f32 v14, v100, v14
    v_mul_f32 v15, v101, v15
    v_mul_f32 v16, v102, v16
    s_waitcnt lgkmcnt(2)
    v_mfma_f32_32x32x16_bf16 v[160:175], v[20:23], a[128:131], v[160:175]
    ds_read_b128 v[32:35], v39 offset:35840
    v_mul_f32 v17, v103, v17
    v_exp_f32 v14, v14
    v_exp_f32 v15, v15
    v_mfma_f32_32x32x16_bf16 v[176:191], v[20:23], v[240:243], v[176:191]
    v_exp_f32 v16, v16
    v_exp_f32 v17, v17
    v_mul_f32 v108, v100, v108
    v_mul_f32 v109, v101, v109
    s_waitcnt lgkmcnt(2)
    v_mfma_f32_32x32x16_bf16 v[160:175], v[24:27], a[132:135], v[160:175]
    v_mul_f32 v110, v102, v110
    v_mul_f32 v111, v103, v111
    v_fma_f32 v14, v14, v6, v6
    v_fma_f32 v15, v15, v6, v6
    v_fma_f32 v16, v16, v6, v6
    v_fma_f32 v17, v17, v6, v6
    v_mfma_f32_32x32x16_bf16 v[176:191], v[24:27], v[244:247], v[176:191]
    s_waitcnt lgkmcnt(0)
    s_waitcnt vmcnt(20)
    s_barrier
    ds_read_b128 v[20:23], v36 offset:0
    v_rcp_f32 v14, v14
    v_mfma_f32_32x32x16_bf16 v[160:175], v[28:31], a[136:139], v[160:175]
    ds_read_b128 v[24:27], v36 offset:1024
    s_add_u32 m0, s24, 110592
    s_add_u32 s27, s23, 258048
    buffer_load_dwordx4 v1, s[8:11], s27 offen offset:0  lds
    v_mfma_f32_32x32x16_bf16 v[176:191], v[28:31], v[248:251], v[176:191]
    v_rcp_f32 v15, v15
    v_rcp_f32 v16, v16
    v_rcp_f32 v17, v17
    v_mfma_f32_32x32x16_bf16 v[160:175], v[32:35], a[140:143], v[160:175]
    ds_read_b128 v[28:31], v36 offset:2048
    buffer_load_dwordx4 v1, s[8:11], s27 offen offset:1024  lds
    s_nop 0
    v_mfma_f32_32x32x16_bf16 v[176:191], v[32:35], v[252:255], v[176:191]
    v_mul_f32 v108, v108, v14
    v_mul_f32 v109, v109, v15
    v_mul_f32 v110, v110, v16
    v_mul_f32 v111, v111, v17
    v_cvt_pk_bf16_f32 v98, v108, v109
    v_cvt_pk_bf16_f32 v99, v110, v111
    s_waitcnt lgkmcnt(2)
    v_mfma_f32_32x32x16_bf16 v[64:79], v[20:23], a[0:3], 0
    ds_read_b128 v[32:35], v36 offset:3072
    buffer_load_dwordx4 v1, s[8:11], s27 offen offset:2048  lds
    s_add_u32 s29, s20, 512
    v_mfma_f32_32x32x16_bf16 v[80:95], v[20:23], a[144:147], 0
    buffer_store_dwordx4 v[96:99], v2, s[8:11], s29 offen sc1
    v_mul_f32 v10, v112, v112
    v_mul_f32 v11, v113, v113
    s_waitcnt lgkmcnt(2)
    v_mfma_f32_32x32x16_bf16 v[64:79], v[24:27], a[4:7], v[64:79]
    ds_read_b128 v[20:23], v36 offset:4096
    buffer_load_dwordx4 v1, s[8:11], s27 offen offset:3072  lds
    v_mul_f32 v12, v114, v114
    v_mfma_f32_32x32x16_bf16 v[80:95], v[24:27], a[148:151], v[80:95]
    v_mul_f32 v13, v115, v115
    v_fma_f32 v10, v10, v8, v7
    v_fma_f32 v11, v11, v8, v7
    v_fma_f32 v12, v12, v8, v7
    v_fma_f32 v13, v13, v8, v7
    v_mul_f32 v10, v112, v10
    s_waitcnt lgkmcnt(2)
    v_mfma_f32_32x32x16_bf16 v[64:79], v[28:31], a[8:11], v[64:79]
    ds_read_b128 v[24:27], v36 offset:5120
    s_add_u32 m0, s24, 114688
    s_add_u32 s27, s23, 262144
    buffer_load_dwordx4 v1, s[8:11], s27 offen offset:0  lds
    v_mfma_f32_32x32x16_bf16 v[80:95], v[28:31], a[152:155], v[80:95]
    v_mul_f32 v11, v113, v11
    v_mul_f32 v12, v114, v12
    v_mul_f32 v13, v115, v13
    v_exp_f32 v10, v10
    s_waitcnt lgkmcnt(2)
    v_mfma_f32_32x32x16_bf16 v[64:79], v[32:35], a[12:15], v[64:79]
    ds_read_b128 v[28:31], v36 offset:6144
    buffer_load_dwordx4 v1, s[8:11], s27 offen offset:1024  lds
    v_mfma_f32_32x32x16_bf16 v[80:95], v[32:35], a[156:159], v[80:95]
    v_exp_f32 v11, v11
    v_exp_f32 v12, v12
    v_exp_f32 v13, v13
    s_waitcnt lgkmcnt(2)
    v_mfma_f32_32x32x16_bf16 v[64:79], v[20:23], a[16:19], v[64:79]
    ds_read_b128 v[32:35], v36 offset:7168
    buffer_load_dwordx4 v1, s[8:11], s27 offen offset:2048  lds
    v_mul_f32 v120, v112, v120
    v_mfma_f32_32x32x16_bf16 v[80:95], v[20:23], a[160:163], v[80:95]
    v_mul_f32 v121, v113, v121
    v_mul_f32 v122, v114, v122
    v_mul_f32 v123, v115, v123
    v_fma_f32 v10, v10, v9, v9
    v_fma_f32 v11, v11, v9, v9
    v_fma_f32 v12, v12, v9, v9
    s_waitcnt lgkmcnt(2)
    v_mfma_f32_32x32x16_bf16 v[64:79], v[24:27], a[20:23], v[64:79]
    ds_read_b128 v[20:23], v36 offset:8192
    buffer_load_dwordx4 v1, s[8:11], s27 offen offset:3072  lds
    v_fma_f32 v13, v13, v9, v9
    v_mfma_f32_32x32x16_bf16 v[80:95], v[24:27], a[164:167], v[80:95]
    v_rcp_f32 v10, v10
    v_rcp_f32 v11, v11
    v_rcp_f32 v12, v12
    s_waitcnt lgkmcnt(2)
    v_mfma_f32_32x32x16_bf16 v[64:79], v[28:31], a[24:27], v[64:79]
    ds_read_b128 v[24:27], v36 offset:9216
    s_add_u32 m0, s24, 118784
    s_add_u32 s27, s23, 266240
    buffer_load_dwordx4 v1, s[8:11], s27 offen offset:0  lds
    v_mfma_f32_32x32x16_bf16 v[80:95], v[28:31], a[168:171], v[80:95]
    v_rcp_f32 v13, v13
    s_nop 0
    v_mul_f32 v120, v120, v10
    v_mul_f32 v121, v121, v11
    v_mul_f32 v122, v122, v12
    s_waitcnt lgkmcnt(2)
    v_mfma_f32_32x32x16_bf16 v[64:79], v[32:35], a[28:31], v[64:79]
    ds_read_b128 v[28:31], v36 offset:10240
    v_mul_f32 v123, v123, v13
    v_cvt_pk_bf16_f32 v112, v120, v121
    v_cvt_pk_bf16_f32 v113, v122, v123
    v_mul_f32 v14, v116, v116
    v_mul_f32 v15, v117, v117
    v_mfma_f32_32x32x16_bf16 v[80:95], v[32:35], a[172:175], v[80:95]
    v_mul_f32 v16, v118, v118
    v_mul_f32 v17, v119, v119
    v_fma_f32 v14, v14, v8, v7
    v_fma_f32 v15, v15, v8, v7
    v_fma_f32 v16, v16, v8, v7
    v_fma_f32 v17, v17, v8, v7
    s_waitcnt lgkmcnt(2)
    v_mfma_f32_32x32x16_bf16 v[64:79], v[20:23], a[32:35], v[64:79]
    ds_read_b128 v[32:35], v36 offset:11264
    v_mul_f32 v14, v116, v14
    v_mul_f32 v15, v117, v15
    v_mul_f32 v16, v118, v16
    v_mul_f32 v17, v119, v17
    v_mfma_f32_32x32x16_bf16 v[80:95], v[20:23], a[176:179], v[80:95]
    v_exp_f32 v14, v14
    v_exp_f32 v15, v15
    v_exp_f32 v16, v16
    s_waitcnt lgkmcnt(2)
    v_mfma_f32_32x32x16_bf16 v[64:79], v[24:27], a[36:39], v[64:79]
    ds_read_b128 v[20:23], v36 offset:12288
    v_exp_f32 v17, v17
    v_mul_f32 v124, v116, v124
    v_mul_f32 v125, v117, v125
    v_mul_f32 v126, v118, v126
    v_mfma_f32_32x32x16_bf16 v[80:95], v[24:27], a[180:183], v[80:95]
    v_mul_f32 v127, v119, v127
    v_fma_f32 v14, v14, v9, v9
    v_fma_f32 v15, v15, v9, v9
    v_fma_f32 v16, v16, v9, v9
    v_fma_f32 v17, v17, v9, v9
    s_waitcnt lgkmcnt(2)
    v_mfma_f32_32x32x16_bf16 v[64:79], v[28:31], a[40:43], v[64:79]
    ds_read_b128 v[24:27], v36 offset:13312
    v_rcp_f32 v14, v14
    v_rcp_f32 v15, v15
    v_mfma_f32_32x32x16_bf16 v[80:95], v[28:31], a[184:187], v[80:95]
    v_rcp_f32 v16, v16
    v_rcp_f32 v17, v17
    s_nop 0
    v_mul_f32 v124, v124, v14
    s_waitcnt lgkmcnt(2)
    v_mfma_f32_32x32x16_bf16 v[64:79], v[32:35], a[44:47], v[64:79]
    ds_read_b128 v[28:31], v36 offset:14336
    v_mul_f32 v125, v125, v15
    v_mul_f32 v126, v126, v16
    v_mul_f32 v127, v127, v17
    v_cvt_pk_bf16_f32 v114, v124, v125
    v_cvt_pk_bf16_f32 v115, v126, v127
    v_mfma_f32_32x32x16_bf16 v[80:95], v[32:35], a[188:191], v[80:95]
    s_add_u32 s29, s20, 295424
    buffer_store_dwordx4 v[112:115], v2, s[8:11], s29 offen sc1
    v_mul_f32 v10, v128, v128
    s_waitcnt lgkmcnt(2)
    v_mfma_f32_32x32x16_bf16 v[64:79], v[20:23], a[48:51], v[64:79]
    ds_read_b128 v[32:35], v36 offset:15360
    v_mul_f32 v11, v129, v129
    v_mul_f32 v12, v130, v130
    v_mul_f32 v13, v131, v131
    v_fma_f32 v10, v10, v5, v4
    v_fma_f32 v11, v11, v5, v4
    v_mfma_f32_32x32x16_bf16 v[80:95], v[20:23], a[192:195], v[80:95]
    v_fma_f32 v12, v12, v5, v4
    v_fma_f32 v13, v13, v5, v4
    v_mul_f32 v10, v128, v10
    v_mul_f32 v11, v129, v11
    v_mul_f32 v12, v130, v12
    v_mul_f32 v13, v131, v13
    s_waitcnt lgkmcnt(2)
    v_mfma_f32_32x32x16_bf16 v[64:79], v[24:27], a[52:55], v[64:79]
    ds_read_b128 v[20:23], v36 offset:16384
    v_exp_f32 v10, v10
    v_exp_f32 v11, v11
    v_mfma_f32_32x32x16_bf16 v[80:95], v[24:27], a[196:199], v[80:95]
    v_exp_f32 v12, v12
    v_exp_f32 v13, v13
    v_mul_f32 v136, v128, v136
    v_mul_f32 v137, v129, v137
    s_waitcnt lgkmcnt(2)
    v_mfma_f32_32x32x16_bf16 v[64:79], v[28:31], a[56:59], v[64:79]
    ds_read_b128 v[24:27], v36 offset:17408
    v_mul_f32 v138, v130, v138
    v_mul_f32 v139, v131, v139
    v_fma_f32 v10, v10, v6, v6
    v_fma_f32 v11, v11, v6, v6
    v_fma_f32 v12, v12, v6, v6
    v_mfma_f32_32x32x16_bf16 v[80:95], v[28:31], a[200:203], v[80:95]
    v_fma_f32 v13, v13, v6, v6
    v_rcp_f32 v10, v10
    v_rcp_f32 v11, v11
    s_waitcnt lgkmcnt(2)
    v_mfma_f32_32x32x16_bf16 v[64:79], v[32:35], a[60:63], v[64:79]
    ds_read_b128 v[28:31], v36 offset:18432
    v_rcp_f32 v12, v12
    v_rcp_f32 v13, v13
    s_nop 0
    v_mfma_f32_32x32x16_bf16 v[80:95], v[32:35], a[204:207], v[80:95]
    v_mul_f32 v136, v136, v10
    v_mul_f32 v137, v137, v11
    v_mul_f32 v138, v138, v12
    v_mul_f32 v139, v139, v13
    v_cvt_pk_bf16_f32 v128, v136, v137
    v_cvt_pk_bf16_f32 v129, v138, v139
    s_waitcnt lgkmcnt(2)
    v_mfma_f32_32x32x16_bf16 v[64:79], v[20:23], a[64:67], v[64:79]
    ds_read_b128 v[32:35], v36 offset:19456
    v_mul_f32 v14, v132, v132
    v_mul_f32 v15, v133, v133
    v_mul_f32 v16, v134, v134
    v_mul_f32 v17, v135, v135
    v_fma_f32 v14, v14, v5, v4
    v_mfma_f32_32x32x16_bf16 v[80:95], v[20:23], a[208:211], v[80:95]
    v_fma_f32 v15, v15, v5, v4
    v_fma_f32 v16, v16, v5, v4
    v_fma_f32 v17, v17, v5, v4
    v_mul_f32 v14, v132, v14
    v_mul_f32 v15, v133, v15
    v_mul_f32 v16, v134, v16
    s_waitcnt lgkmcnt(2)
    v_mfma_f32_32x32x16_bf16 v[64:79], v[24:27], a[68:71], v[64:79]
    ds_read_b128 v[20:23], v36 offset:20480
    v_mul_f32 v17, v135, v17
    v_exp_f32 v14, v14
    v_exp_f32 v15, v15
    v_mfma_f32_32x32x16_bf16 v[80:95], v[24:27], a[212:215], v[80:95]
    v_exp_f32 v16, v16
    v_exp_f32 v17, v17
    v_mul_f32 v140, v132, v140
    v_mul_f32 v141, v133, v141
    s_waitcnt lgkmcnt(2)
    v_mfma_f32_32x32x16_bf16 v[64:79], v[28:31], a[72:75], v[64:79]
    ds_read_b128 v[24:27], v36 offset:21504
    v_mul_f32 v142, v134, v142
    v_mul_f32 v143, v135, v143
    v_fma_f32 v14, v14, v6, v6
    v_fma_f32 v15, v15, v6, v6
    v_fma_f32 v16, v16, v6, v6
    v_mfma_f32_32x32x16_bf16 v[80:95], v[28:31], a[216:219], v[80:95]
    v_fma_f32 v17, v17, v6, v6
    v_rcp_f32 v14, v14
    v_rcp_f32 v15, v15
    s_waitcnt lgkmcnt(2)
    v_mfma_f32_32x32x16_bf16 v[64:79], v[32:35], a[76:79], v[64:79]
    ds_read_b128 v[28:31], v36 offset:22528
    v_rcp_f32 v16, v16
    v_rcp_f32 v17, v17
    s_nop 0
    v_mfma_f32_32x32x16_bf16 v[80:95], v[32:35], a[220:223], v[80:95]
    v_mul_f32 v140, v140, v14
    v_mul_f32 v141, v141, v15
    v_mul_f32 v142, v142, v16
    v_mul_f32 v143, v143, v17
    v_cvt_pk_bf16_f32 v130, v140, v141
    v_cvt_pk_bf16_f32 v131, v142, v143
    s_waitcnt lgkmcnt(2)
    v_mfma_f32_32x32x16_bf16 v[64:79], v[20:23], a[80:83], v[64:79]
    ds_read_b128 v[32:35], v36 offset:23552
    s_add_u32 s29, s20, 1024
    buffer_store_dwordx4 v[128:131], v2, s[8:11], s29 offen sc1
    v_mfma_f32_32x32x16_bf16 v[80:95], v[20:23], a[224:227], v[80:95]
    v_mul_f32 v10, v144, v144
    v_mul_f32 v11, v145, v145
    v_mul_f32 v12, v146, v146
    v_mul_f32 v13, v147, v147
    v_fma_f32 v10, v10, v8, v7
    v_fma_f32 v11, v11, v8, v7
    s_waitcnt lgkmcnt(2)
    v_mfma_f32_32x32x16_bf16 v[64:79], v[24:27], a[84:87], v[64:79]
    ds_read_b128 v[20:23], v36 offset:24576
    v_fma_f32 v12, v12, v8, v7
    v_fma_f32 v13, v13, v8, v7
    v_mul_f32 v10, v144, v10
    v_mul_f32 v11, v145, v11
    v_mul_f32 v12, v146, v12
    v_mfma_f32_32x32x16_bf16 v[80:95], v[24:27], a[228:231], v[80:95]
    v_mul_f32 v13, v147, v13
    v_exp_f32 v10, v10
    v_exp_f32 v11, v11
    s_waitcnt lgkmcnt(2)
    v_mfma_f32_32x32x16_bf16 v[64:79], v[28:31], a[88:91], v[64:79]
    ds_read_b128 v[24:27], v36 offset:25600
    v_exp_f32 v12, v12
    v_exp_f32 v13, v13
    v_mul_f32 v152, v144, v152
    v_mfma_f32_32x32x16_bf16 v[80:95], v[28:31], a[232:235], v[80:95]
    v_mul_f32 v153, v145, v153
    v_mul_f32 v154, v146, v154
    v_mul_f32 v155, v147, v155
    v_fma_f32 v10, v10, v9, v9
    v_fma_f32 v11, v11, v9, v9
    v_fma_f32 v12, v12, v9, v9
    s_waitcnt lgkmcnt(2)
    v_mfma_f32_32x32x16_bf16 v[64:79], v[32:35], a[92:95], v[64:79]
    ds_read_b128 v[28:31], v36 offset:26624
    v_fma_f32 v13, v13, v9, v9
    v_rcp_f32 v10, v10
    v_rcp_f32 v11, v11
    v_mfma_f32_32x32x16_bf16 v[80:95], v[32:35], a[236:239], v[80:95]
    v_rcp_f32 v12, v12
    v_rcp_f32 v13, v13
    s_nop 0
    v_mul_f32 v152, v152, v10
    s_waitcnt lgkmcnt(2)
    v_mfma_f32_32x32x16_bf16 v[64:79], v[20:23], a[96:99], v[64:79]
    ds_read_b128 v[32:35], v36 offset:27648
    v_mul_f32 v153, v153, v11
    v_mul_f32 v154, v154, v12
    v_mul_f32 v155, v155, v13
    v_cvt_pk_bf16_f32 v144, v152, v153
    v_cvt_pk_bf16_f32 v145, v154, v155
    v_mfma_f32_32x32x16_bf16 v[80:95], v[20:23], a[240:243], v[80:95]
    v_mul_f32 v14, v148, v148
    v_mul_f32 v15, v149, v149
    v_mul_f32 v16, v150, v150
    v_mul_f32 v17, v151, v151
    v_fma_f32 v14, v14, v8, v7
    v_fma_f32 v15, v15, v8, v7
    s_waitcnt lgkmcnt(2)
    v_mfma_f32_32x32x16_bf16 v[64:79], v[24:27], a[100:103], v[64:79]
    ds_read_b128 v[20:23], v36 offset:28672
    v_fma_f32 v16, v16, v8, v7
    v_fma_f32 v17, v17, v8, v7
    v_mul_f32 v14, v148, v14
    v_mul_f32 v15, v149, v15
    v_mul_f32 v16, v150, v16
    v_mfma_f32_32x32x16_bf16 v[80:95], v[24:27], a[244:247], v[80:95]
    v_mul_f32 v17, v151, v17
    v_exp_f32 v14, v14
    v_exp_f32 v15, v15
    s_waitcnt lgkmcnt(2)
    v_mfma_f32_32x32x16_bf16 v[64:79], v[28:31], a[104:107], v[64:79]
    ds_read_b128 v[24:27], v36 offset:29696
    v_exp_f32 v16, v16
    v_exp_f32 v17, v17
    v_mul_f32 v156, v148, v156
    v_mfma_f32_32x32x16_bf16 v[80:95], v[28:31], a[248:251], v[80:95]
    v_mul_f32 v157, v149, v157
    v_mul_f32 v158, v150, v158
    v_mul_f32 v159, v151, v159
    v_fma_f32 v14, v14, v9, v9
    v_fma_f32 v15, v15, v9, v9
    v_fma_f32 v16, v16, v9, v9
    s_waitcnt lgkmcnt(2)
    v_mfma_f32_32x32x16_bf16 v[64:79], v[32:35], a[108:111], v[64:79]
    ds_read_b128 v[28:31], v36 offset:30720
    v_fma_f32 v17, v17, v9, v9
    v_rcp_f32 v14, v14
    v_rcp_f32 v15, v15
    v_mfma_f32_32x32x16_bf16 v[80:95], v[32:35], a[252:255], v[80:95]
    v_rcp_f32 v16, v16
    v_rcp_f32 v17, v17
    s_nop 0
    v_mul_f32 v156, v156, v14
    s_waitcnt lgkmcnt(2)
    v_mfma_f32_32x32x16_bf16 v[64:79], v[20:23], a[112:115], v[64:79]
    ds_read_b128 v[32:35], v36 offset:31744
    v_mul_f32 v157, v157, v15
    v_mul_f32 v158, v158, v16
    v_mul_f32 v159, v159, v17
    v_cvt_pk_bf16_f32 v146, v156, v157
    v_cvt_pk_bf16_f32 v147, v158, v159
    v_mfma_f32_32x32x16_bf16 v[80:95], v[20:23], v[224:227], v[80:95]
    s_add_u32 s29, s20, 295936
    buffer_store_dwordx4 v[144:147], v2, s[8:11], s29 offen sc1
    v_mul_f32 v10, v160, v160
    s_waitcnt lgkmcnt(2)
    v_mfma_f32_32x32x16_bf16 v[64:79], v[24:27], a[116:119], v[64:79]
    ds_read_b128 v[20:23], v36 offset:32768
    v_mul_f32 v11, v161, v161
    v_mul_f32 v12, v162, v162
    v_mul_f32 v13, v163, v163
    v_fma_f32 v10, v10, v5, v4
    v_fma_f32 v11, v11, v5, v4
    v_mfma_f32_32x32x16_bf16 v[80:95], v[24:27], v[228:231], v[80:95]
    v_fma_f32 v12, v12, v5, v4
    v_fma_f32 v13, v13, v5, v4
    v_mul_f32 v10, v160, v10
    v_mul_f32 v11, v161, v11
    v_mul_f32 v12, v162, v12
    v_mul_f32 v13, v163, v13
    s_waitcnt lgkmcnt(2)
    v_mfma_f32_32x32x16_bf16 v[64:79], v[28:31], a[120:123], v[64:79]
    ds_read_b128 v[24:27], v36 offset:33792
    v_exp_f32 v10, v10
    v_exp_f32 v11, v11
    v_mfma_f32_32x32x16_bf16 v[80:95], v[28:31], v[232:235], v[80:95]
    v_exp_f32 v12, v12
    v_exp_f32 v13, v13
    v_mul_f32 v168, v160, v168
    v_mul_f32 v169, v161, v169
    s_waitcnt lgkmcnt(2)
    v_mfma_f32_32x32x16_bf16 v[64:79], v[32:35], a[124:127], v[64:79]
    ds_read_b128 v[28:31], v36 offset:34816
    v_mul_f32 v170, v162, v170
    v_mul_f32 v171, v163, v171
    v_fma_f32 v10, v10, v6, v6
    v_fma_f32 v11, v11, v6, v6
    v_fma_f32 v12, v12, v6, v6
    v_mfma_f32_32x32x16_bf16 v[80:95], v[32:35], v[236:239], v[80:95]
    v_fma_f32 v13, v13, v6, v6
    v_rcp_f32 v10, v10
    v_rcp_f32 v11, v11
    s_waitcnt lgkmcnt(2)
    v_mfma_f32_32x32x16_bf16 v[64:79], v[20:23], a[128:131], v[64:79]
    ds_read_b128 v[32:35], v36 offset:35840
    v_rcp_f32 v12, v12
    v_rcp_f32 v13, v13
    s_nop 0
    v_mfma_f32_32x32x16_bf16 v[80:95], v[20:23], v[240:243], v[80:95]
    v_mul_f32 v168, v168, v10
    v_mul_f32 v169, v169, v11
    v_mul_f32 v170, v170, v12
    v_mul_f32 v171, v171, v13
    v_cvt_pk_bf16_f32 v160, v168, v169
    v_cvt_pk_bf16_f32 v161, v170, v171
    s_waitcnt lgkmcnt(2)
    v_mfma_f32_32x32x16_bf16 v[64:79], v[24:27], a[132:135], v[64:79]
    v_mul_f32 v14, v164, v164
    v_mul_f32 v15, v165, v165
    v_mul_f32 v16, v166, v166
    v_mul_f32 v17, v167, v167
    v_fma_f32 v14, v14, v5, v4
    v_fma_f32 v15, v15, v5, v4
    v_mfma_f32_32x32x16_bf16 v[80:95], v[24:27], v[244:247], v[80:95]
    s_waitcnt lgkmcnt(0)
    s_waitcnt vmcnt(23)
    s_barrier
    ds_read_b128 v[20:23], v37 offset:0
    v_fma_f32 v16, v16, v5, v4
    v_fma_f32 v17, v17, v5, v4
    v_mfma_f32_32x32x16_bf16 v[64:79], v[28:31], a[136:139], v[64:79]
    ds_read_b128 v[24:27], v37 offset:1024
    s_add_u32 m0, s24, 0
    s_add_u32 s27, s23, 294912
    buffer_load_dwordx4 v1, s[8:11], s27 offen offset:0  lds
    v_mfma_f32_32x32x16_bf16 v[80:95], v[28:31], v[248:251], v[80:95]
    v_mul_f32 v14, v164, v14
    v_mul_f32 v15, v165, v15
    v_mul_f32 v16, v166, v16
    v_mul_f32 v17, v167, v17
    v_exp_f32 v14, v14
    v_mfma_f32_32x32x16_bf16 v[64:79], v[32:35], a[140:143], v[64:79]
    ds_read_b128 v[28:31], v37 offset:2048
    buffer_load_dwordx4 v1, s[8:11], s27 offen offset:1024  lds
    v_mfma_f32_32x32x16_bf16 v[80:95], v[32:35], v[252:255], v[80:95]
    v_exp_f32 v15, v15
    v_exp_f32 v16, v16
    v_exp_f32 v17, v17
    s_waitcnt lgkmcnt(2)
    v_mfma_f32_32x32x16_bf16 v[96:111], v[20:23], a[0:3], 0
    ds_read_b128 v[32:35], v37 offset:3072
    buffer_load_dwordx4 v1, s[8:11], s27 offen offset:2048  lds
    v_mul_f32 v172, v164, v172
    v_mfma_f32_32x32x16_bf16 v[112:127], v[20:23], a[144:147], 0
    v_mul_f32 v173, v165, v173
    v_mul_f32 v174, v166, v174
    v_mul_f32 v175, v167, v175
    v_fma_f32 v14, v14, v6, v6
    v_fma_f32 v15, v15, v6, v6
    v_fma_f32 v16, v16, v6, v6
    s_waitcnt lgkmcnt(2)
    v_mfma_f32_32x32x16_bf16 v[96:111], v[24:27], a[4:7], v[96:111]
    ds_read_b128 v[20:23], v37 offset:4096
    buffer_load_dwordx4 v1, s[8:11], s27 offen offset:3072  lds
    v_fma_f32 v17, v17, v6, v6
    v_mfma_f32_32x32x16_bf16 v[112:127], v[24:27], a[148:151], v[112:127]
    v_rcp_f32 v14, v14
    v_rcp_f32 v15, v15
    v_rcp_f32 v16, v16
    s_waitcnt lgkmcnt(2)
    v_mfma_f32_32x32x16_bf16 v[96:111], v[28:31], a[8:11], v[96:111]
    ds_read_b128 v[24:27], v37 offset:5120
    s_add_u32 m0, s24, 4096
    s_add_u32 s27, s23, 299008
    buffer_load_dwordx4 v1, s[8:11], s27 offen offset:0  lds
    v_mfma_f32_32x32x16_bf16 v[112:127], v[28:31], a[152:155], v[112:127]
    v_rcp_f32 v17, v17
    s_nop 0
    v_mul_f32 v172, v172, v14
    v_mul_f32 v173, v173, v15
    v_mul_f32 v174, v174, v16
    s_waitcnt lgkmcnt(2)
    v_mfma_f32_32x32x16_bf16 v[96:111], v[32:35], a[12:15], v[96:111]
    ds_read_b128 v[28:31], v37 offset:6144
    buffer_load_dwordx4 v1, s[8:11], s27 offen offset:1024  lds
    v_mul_f32 v175, v175, v17
    v_mfma_f32_32x32x16_bf16 v[112:127], v[32:35], a[156:159], v[112:127]
    v_cvt_pk_bf16_f32 v162, v172, v173
    v_cvt_pk_bf16_f32 v163, v174, v175
    s_add_u32 s29, s20, 1536
    s_waitcnt lgkmcnt(2)
    v_mfma_f32_32x32x16_bf16 v[96:111], v[20:23], a[16:19], v[96:111]
    ds_read_b128 v[32:35], v37 offset:7168
    buffer_load_dwordx4 v1, s[8:11], s27 offen offset:2048  lds
    v_mfma_f32_32x32x16_bf16 v[112:127], v[20:23], a[160:163], v[112:127]
    buffer_store_dwordx4 v[160:163], v2, s[8:11], s29 offen sc1
    v_mul_f32 v10, v176, v176
    v_mul_f32 v11, v177, v177
    s_waitcnt lgkmcnt(2)
    v_mfma_f32_32x32x16_bf16 v[96:111], v[24:27], a[20:23], v[96:111]
    ds_read_b128 v[20:23], v37 offset:8192
    buffer_load_dwordx4 v1, s[8:11], s27 offen offset:3072  lds
    v_mul_f32 v12, v178, v178
    v_mfma_f32_32x32x16_bf16 v[112:127], v[24:27], a[164:167], v[112:127]
    v_mul_f32 v13, v179, v179
    v_fma_f32 v10, v10, v8, v7
    v_fma_f32 v11, v11, v8, v7
    v_fma_f32 v12, v12, v8, v7
    v_fma_f32 v13, v13, v8, v7
    v_mul_f32 v10, v176, v10
    s_waitcnt lgkmcnt(2)
    v_mfma_f32_32x32x16_bf16 v[96:111], v[28:31], a[24:27], v[96:111]
    ds_read_b128 v[24:27], v37 offset:9216
    s_add_u32 m0, s24, 8192
    s_add_u32 s27, s23, 303104
    buffer_load_dwordx4 v1, s[8:11], s27 offen offset:0  lds
    v_mfma_f32_32x32x16_bf16 v[112:127], v[28:31], a[168:171], v[112:127]
    v_mul_f32 v11, v177, v11
    v_mul_f32 v12, v178, v12
    v_mul_f32 v13, v179, v13
    v_exp_f32 v10, v10
    s_waitcnt lgkmcnt(2)
    v_mfma_f32_32x32x16_bf16 v[96:111], v[32:35], a[28:31], v[96:111]
    ds_read_b128 v[28:31], v37 offset:10240
    v_exp_f32 v11, v11
    v_exp_f32 v12, v12
    v_mfma_f32_32x32x16_bf16 v[112:127], v[32:35], a[172:175], v[112:127]
    v_exp_f32 v13, v13
    v_mul_f32 v184, v176, v184
    v_mul_f32 v185, v177, v185
    v_mul_f32 v186, v178, v186
    v_mul_f32 v187, v179, v187
    s_waitcnt lgkmcnt(2)
    v_mfma_f32_32x32x16_bf16 v[96:111], v[20:23], a[32:35], v[96:111]
    ds_read_b128 v[32:35], v37 offset:11264
    v_fma_f32 v10, v10, v9, v9
    v_fma_f32 v11, v11, v9, v9
    v_fma_f32 v12, v12, v9, v9
    v_fma_f32 v13, v13, v9, v9
    v_mfma_f32_32x32x16_bf16 v[112:127], v[20:23], a[176:179], v[112:127]
    v_rcp_f32 v10, v10
    v_rcp_f32 v11, v11
    v_rcp_f32 v12, v12
    s_waitcnt lgkmcnt(2)
    v_mfma_f32_32x32x16_bf16 v[96:111], v[24:27], a[36:39], v[96:111]
    ds_read_b128 v[20:23], v37 offset:12288
    v_rcp_f32 v13, v13
    s_nop 0
    v_mul_f32 v184, v184, v10
    v_mul_f32 v185, v185, v11
    v_mfma_f32_32x32x16_bf16 v[112:127], v[24:27], a[180:183], v[112:127]
    v_mul_f32 v186, v186, v12
    v_mul_f32 v187, v187, v13
    v_cvt_pk_bf16_f32 v176, v184, v185
    v_cvt_pk_bf16_f32 v177, v186, v187
    v_mul_f32 v14, v180, v180
    v_mul_f32 v15, v181, v181
    s_waitcnt lgkmcnt(2)
    v_mfma_f32_32x32x16_bf16 v[96:111], v[28:31], a[40:43], v[96:111]
    ds_read_b128 v[24:27], v37 offset:13312
    v_mul_f32 v16, v182, v182
    v_mul_f32 v17, v183, v183
    v_fma_f32 v14, v14, v8, v7
    v_fma_f32 v15, v15, v8, v7
    v_fma_f32 v16, v16, v8, v7
    v_mfma_f32_32x32x16_bf16 v[112:127], v[28:31], a[184:187], v[112:127]
    v_fma_f32 v17, v17, v8, v7
    v_mul_f32 v14, v180, v14
    v_mul_f32 v15, v181, v15
    v_mul_f32 v16, v182, v16
    v_mul_f32 v17, v183, v17
    s_waitcnt lgkmcnt(2)
    v_mfma_f32_32x32x16_bf16 v[96:111], v[32:35], a[44:47], v[96:111]
    ds_read_b128 v[28:31], v37 offset:14336
    v_exp_f32 v14, v14
    v_exp_f32 v15, v15
    v_mfma_f32_32x32x16_bf16 v[112:127], v[32:35], a[188:191], v[112:127]
    v_exp_f32 v16, v16
    v_exp_f32 v17, v17
    v_mul_f32 v188, v180, v188
    v_mul_f32 v189, v181, v189
    s_waitcnt lgkmcnt(2)
    v_mfma_f32_32x32x16_bf16 v[96:111], v[20:23], a[48:51], v[96:111]
    ds_read_b128 v[32:35], v37 offset:15360
    v_mul_f32 v190, v182, v190
    v_mul_f32 v191, v183, v191
    v_fma_f32 v14, v14, v9, v9
    v_fma_f32 v15, v15, v9, v9
    v_fma_f32 v16, v16, v9, v9
    v_mfma_f32_32x32x16_bf16 v[112:127], v[20:23], a[192:195], v[112:127]
    v_fma_f32 v17, v17, v9, v9
    v_rcp_f32 v14, v14
    v_rcp_f32 v15, v15
    s_waitcnt lgkmcnt(2)
    v_mfma_f32_32x32x16_bf16 v[96:111], v[24:27], a[52:55], v[96:111]
    ds_read_b128 v[20:23], v37 offset:16384
    v_rcp_f32 v16, v16
    v_rcp_f32 v17, v17
    s_nop 0
    v_mfma_f32_32x32x16_bf16 v[112:127], v[24:27], a[196:199], v[112:127]
    v_mul_f32 v188, v188, v14
    v_mul_f32 v189, v189, v15
    v_mul_f32 v190, v190, v16
    v_mul_f32 v191, v191, v17
    v_cvt_pk_bf16_f32 v178, v188, v189
    v_cvt_pk_bf16_f32 v179, v190, v191
    s_waitcnt lgkmcnt(2)
    v_mfma_f32_32x32x16_bf16 v[96:111], v[28:31], a[56:59], v[96:111]
    ds_read_b128 v[24:27], v37 offset:17408
    s_add_u32 s29, s20, 296448
    buffer_store_dwordx4 v[176:179], v2, s[8:11], s29 offen sc1
    v_mfma_f32_32x32x16_bf16 v[112:127], v[28:31], a[200:203], v[112:127]
    v_mul_f32 v10, v64, v64
    v_mul_f32 v11, v65, v65
    v_mul_f32 v12, v66, v66
    v_mul_f32 v13, v67, v67
    v_fma_f32 v10, v10, v5, v4
    v_fma_f32 v11, v11, v5, v4
    s_waitcnt lgkmcnt(2)
    v_mfma_f32_32x32x16_bf16 v[96:111], v[32:35], a[60:63], v[96:111]
    ds_read_b128 v[28:31], v37 offset:18432
    v_fma_f32 v12, v12, v5, v4
    v_fma_f32 v13, v13, v5, v4
    v_mul_f32 v10, v64, v10
    v_mul_f32 v11, v65, v11
    v_mul_f32 v12, v66, v12
    v_mfma_f32_32x32x16_bf16 v[112:127], v[32:35], a[204:207], v[112:127]
    v_mul_f32 v13, v67, v13
    v_exp_f32 v10, v10
    v_exp_f32 v11, v11
    s_waitcnt lgkmcnt(2)
    v_mfma_f32_32x32x16_bf16 v[96:111], v[20:23], a[64:67], v[96:111]
    ds_read_b128 v[32:35], v37 offset:19456
    v_exp_f32 v12, v12
    v_exp_f32 v13, v13
    v_mul_f32 v72, v64, v72
    v_mfma_f32_32x32x16_bf16 v[112:127], v[20:23], a[208:211], v[112:127]
    v_mul_f32 v73, v65, v73
    v_mul_f32 v74, v66, v74
    v_mul_f32 v75, v67, v75
    v_fma_f32 v10, v10, v6, v6
    v_fma_f32 v11, v11, v6, v6
    v_fma_f32 v12, v12, v6, v6
    s_waitcnt lgkmcnt(2)
    v_mfma_f32_32x32x16_bf16 v[96:111], v[24:27], a[68:71], v[96:111]
    ds_read_b128 v[20:23], v37 offset:20480
    v_fma_f32 v13, v13, v6, v6
    v_rcp_f32 v10, v10
    v_rcp_f32 v11, v11
    v_mfma_f32_32x32x16_bf16 v[112:127], v[24:27], a[212:215], v[112:127]
    v_rcp_f32 v12, v12
    v_rcp_f32 v13, v13
    s_nop 0
    v_mul_f32 v72, v72, v10
    s_waitcnt lgkmcnt(2)
    v_mfma_f32_32x32x16_bf16 v[96:111], v[28:31], a[72:75], v[96:111]
    ds_read_b128 v[24:27], v37 offset:21504
    v_mul_f32 v73, v73, v11
    v_mul_f32 v74, v74, v12
    v_mul_f32 v75, v75, v13
    v_cvt_pk_bf16_f32 v64, v72, v73
    v_cvt_pk_bf16_f32 v65, v74, v75
    v_mfma_f32_32x32x16_bf16 v[112:127], v[28:31], a[216:219], v[112:127]
    v_mul_f32 v14, v68, v68
    v_mul_f32 v15, v69, v69
    v_mul_f32 v16, v70, v70
    v_mul_f32 v17, v71, v71
    v_fma_f32 v14, v14, v5, v4
    v_fma_f32 v15, v15, v5, v4
    s_waitcnt lgkmcnt(2)
    v_mfma_f32_32x32x16_bf16 v[96:111], v[32:35], a[76:79], v[96:111]
    ds_read_b128 v[28:31], v37 offset:22528
    v_fma_f32 v16, v16, v5, v4
    v_fma_f32 v17, v17, v5, v4
    v_mul_f32 v14, v68, v14
    v_mul_f32 v15, v69, v15
    v_mul_f32 v16, v70, v16
    v_mfma_f32_32x32x16_bf16 v[112:127], v[32:35], a[220:223], v[112:127]
    v_mul_f32 v17, v71, v17
    v_exp_f32 v14, v14
    v_exp_f32 v15, v15
    s_waitcnt lgkmcnt(2)
    v_mfma_f32_32x32x16_bf16 v[96:111], v[20:23], a[80:83], v[96:111]
    ds_read_b128 v[32:35], v37 offset:23552
    v_exp_f32 v16, v16
    v_exp_f32 v17, v17
    v_mul_f32 v76, v68, v76
    v_mfma_f32_32x32x16_bf16 v[112:127], v[20:23], a[224:227], v[112:127]
    v_mul_f32 v77, v69, v77
    v_mul_f32 v78, v70, v78
    v_mul_f32 v79, v71, v79
    v_fma_f32 v14, v14, v6, v6
    v_fma_f32 v15, v15, v6, v6
    v_fma_f32 v16, v16, v6, v6
    s_waitcnt lgkmcnt(2)
    v_mfma_f32_32x32x16_bf16 v[96:111], v[24:27], a[84:87], v[96:111]
    ds_read_b128 v[20:23], v37 offset:24576
    v_fma_f32 v17, v17, v6, v6
    v_rcp_f32 v14, v14
    v_rcp_f32 v15, v15
    v_mfma_f32_32x32x16_bf16 v[112:127], v[24:27], a[228:231], v[112:127]
    v_rcp_f32 v16, v16
    v_rcp_f32 v17, v17
    s_nop 0
    v_mul_f32 v76, v76, v14
    s_waitcnt lgkmcnt(2)
    v_mfma_f32_32x32x16_bf16 v[96:111], v[28:31], a[88:91], v[96:111]
    ds_read_b128 v[24:27], v37 offset:25600
    v_mul_f32 v77, v77, v15
    v_mul_f32 v78, v78, v16
    v_mul_f32 v79, v79, v17
    v_cvt_pk_bf16_f32 v66, v76, v77
    v_cvt_pk_bf16_f32 v67, v78, v79
    v_mfma_f32_32x32x16_bf16 v[112:127], v[28:31], a[232:235], v[112:127]
    s_add_u32 s29, s20, 2048
    buffer_store_dwordx4 v[64:67], v2, s[8:11], s29 offen sc1
    v_mul_f32 v10, v80, v80
    s_waitcnt lgkmcnt(2)
    v_mfma_f32_32x32x16_bf16 v[96:111], v[32:35], a[92:95], v[96:111]
    ds_read_b128 v[28:31], v37 offset:26624
    v_mul_f32 v11, v81, v81
    v_mul_f32 v12, v82, v82
    v_mul_f32 v13, v83, v83
    v_fma_f32 v10, v10, v8, v7
    v_fma_f32 v11, v11, v8, v7
    v_mfma_f32_32x32x16_bf16 v[112:127], v[32:35], a[236:239], v[112:127]
    v_fma_f32 v12, v12, v8, v7
    v_fma_f32 v13, v13, v8, v7
    v_mul_f32 v10, v80, v10
    v_mul_f32 v11, v81, v11
    v_mul_f32 v12, v82, v12
    v_mul_f32 v13, v83, v13
    s_waitcnt lgkmcnt(2)
    v_mfma_f32_32x32x16_bf16 v[96:111], v[20:23], a[96:99], v[96:111]
    ds_read_b128 v[32:35], v37 offset:27648
    v_exp_f32 v10, v10
    v_exp_f32 v11, v11
    v_mfma_f32_32x32x16_bf16 v[112:127], v[20:23], a[240:243], v[112:127]
    v_exp_f32 v12, v12
    v_exp_f32 v13, v13
    v_mul_f32 v88, v80, v88
    v_mul_f32 v89, v81, v89
    s_waitcnt lgkmcnt(2)
    v_mfma_f32_32x32x16_bf16 v[96:111], v[24:27], a[100:103], v[96:111]
    ds_read_b128 v[20:23], v37 offset:28672
    v_mul_f32 v90, v82, v90
    v_mul_f32 v91, v83, v91
    v_fma_f32 v10, v10, v9, v9
    v_fma_f32 v11, v11, v9, v9
    v_fma_f32 v12, v12, v9, v9
    v_mfma_f32_32x32x16_bf16 v[112:127], v[24:27], a[244:247], v[112:127]
    v_fma_f32 v13, v13, v9, v9
    v_rcp_f32 v10, v10
    v_rcp_f32 v11, v11
    s_waitcnt lgkmcnt(2)
    v_mfma_f32_32x32x16_bf16 v[96:111], v[28:31], a[104:107], v[96:111]
    ds_read_b128 v[24:27], v37 offset:29696
    v_rcp_f32 v12, v12
    v_rcp_f32 v13, v13
    s_nop 0
    v_mfma_f32_32x32x16_bf16 v[112:127], v[28:31], a[248:251], v[112:127]
    v_mul_f32 v88, v88, v10
    v_mul_f32 v89, v89, v11
    v_mul_f32 v90, v90, v12
    v_mul_f32 v91, v91, v13
    v_cvt_pk_bf16_f32 v80, v88, v89
    v_cvt_pk_bf16_f32 v81, v90, v91
    s_waitcnt lgkmcnt(2)
    v_mfma_f32_32x32x16_bf16 v[96:111], v[32:35], a[108:111], v[96:111]
    ds_read_b128 v[28:31], v37 offset:30720
    v_mul_f32 v14, v84, v84
    v_mul_f32 v15, v85, v85
    v_mul_f32 v16, v86, v86
    v_mul_f32 v17, v87, v87
    v_fma_f32 v14, v14, v8, v7
    v_mfma_f32_32x32x16_bf16 v[112:127], v[32:35], a[252:255], v[112:127]
    v_fma_f32 v15, v15, v8, v7
    v_fma_f32 v16, v16, v8, v7
    v_fma_f32 v17, v17, v8, v7
    v_mul_f32 v14, v84, v14
    v_mul_f32 v15, v85, v15
    v_mul_f32 v16, v86, v16
    s_waitcnt lgkmcnt(2)
    v_mfma_f32_32x32x16_bf16 v[96:111], v[20:23], a[112:115], v[96:111]
    ds_read_b128 v[32:35], v37 offset:31744
    v_mul_f32 v17, v87, v17
    v_exp_f32 v14, v14
    v_exp_f32 v15, v15
    v_mfma_f32_32x32x16_bf16 v[112:127], v[20:23], v[224:227], v[112:127]
    v_exp_f32 v16, v16
    v_exp_f32 v17, v17
    v_mul_f32 v92, v84, v92
    v_mul_f32 v93, v85, v93
    s_waitcnt lgkmcnt(2)
    v_mfma_f32_32x32x16_bf16 v[96:111], v[24:27], a[116:119], v[96:111]
    ds_read_b128 v[20:23], v37 offset:32768
    v_mul_f32 v94, v86, v94
    v_mul_f32 v95, v87, v95
    v_fma_f32 v14, v14, v9, v9
    v_fma_f32 v15, v15, v9, v9
    v_fma_f32 v16, v16, v9, v9
    v_mfma_f32_32x32x16_bf16 v[112:127], v[24:27], v[228:231], v[112:127]
    v_fma_f32 v17, v17, v9, v9
    v_rcp_f32 v14, v14
    v_rcp_f32 v15, v15
    s_waitcnt lgkmcnt(2)
    v_mfma_f32_32x32x16_bf16 v[96:111], v[28:31], a[120:123], v[96:111]
    ds_read_b128 v[24:27], v37 offset:33792
    v_rcp_f32 v16, v16
    v_rcp_f32 v17, v17
    s_nop 0
    v_mfma_f32_32x32x16_bf16 v[112:127], v[28:31], v[232:235], v[112:127]
    v_mul_f32 v92, v92, v14
    v_mul_f32 v93, v93, v15
    v_mul_f32 v94, v94, v16
    v_mul_f32 v95, v95, v17
    v_cvt_pk_bf16_f32 v82, v92, v93
    v_cvt_pk_bf16_f32 v83, v94, v95
    s_waitcnt lgkmcnt(2)
    v_mfma_f32_32x32x16_bf16 v[96:111], v[32:35], a[124:127], v[96:111]
    ds_read_b128 v[28:31], v37 offset:34816
    s_add_u32 s29, s20, 296960
    buffer_store_dwordx4 v[80:83], v2, s[8:11], s29 offen sc1
    v_mfma_f32_32x32x16_bf16 v[112:127], v[32:35], v[236:239], v[112:127]
    s_waitcnt lgkmcnt(2)
    v_mfma_f32_32x32x16_bf16 v[96:111], v[20:23], a[128:131], v[96:111]
    ds_read_b128 v[32:35], v37 offset:35840
    v_mfma_f32_32x32x16_bf16 v[112:127], v[20:23], v[240:243], v[112:127]
    s_waitcnt lgkmcnt(2)
    v_mfma_f32_32x32x16_bf16 v[96:111], v[24:27], a[132:135], v[96:111]
    v_mfma_f32_32x32x16_bf16 v[112:127], v[24:27], v[244:247], v[112:127]
    s_waitcnt lgkmcnt(0)
    s_waitcnt vmcnt(27)
    s_barrier
    ds_read_b128 v[20:23], v38 offset:0
    v_mfma_f32_32x32x16_bf16 v[96:111], v[28:31], a[136:139], v[96:111]
    ds_read_b128 v[24:27], v38 offset:1024
    s_add_u32 m0, s24, 36864
    s_add_u32 s27, s36, 0
    buffer_load_dwordx4 v1, s[8:11], s27 offen offset:0  lds
    v_mfma_f32_32x32x16_bf16 v[112:127], v[28:31], v[248:251], v[112:127]
    v_mfma_f32_32x32x16_bf16 v[96:111], v[32:35], a[140:143], v[96:111]
    ds_read_b128 v[28:31], v38 offset:2048
    buffer_load_dwordx4 v1, s[8:11], s27 offen offset:1024  lds
    v_mfma_f32_32x32x16_bf16 v[112:127], v[32:35], v[252:255], v[112:127]
    s_waitcnt lgkmcnt(2)
    v_mfma_f32_32x32x16_bf16 v[128:143], v[20:23], a[0:3], 0
    ds_read_b128 v[32:35], v38 offset:3072
    buffer_load_dwordx4 v1, s[8:11], s27 offen offset:2048  lds
    v_mfma_f32_32x32x16_bf16 v[144:159], v[20:23], a[144:147], 0
    s_waitcnt lgkmcnt(2)
    v_mfma_f32_32x32x16_bf16 v[128:143], v[24:27], a[4:7], v[128:143]
    ds_read_b128 v[20:23], v38 offset:4096
    buffer_load_dwordx4 v1, s[8:11], s27 offen offset:3072  lds
    v_mul_f32 v10, v96, v96
    v_mfma_f32_32x32x16_bf16 v[144:159], v[24:27], a[148:151], v[144:159]
    v_mul_f32 v11, v97, v97
    v_mul_f32 v12, v98, v98
    v_mul_f32 v13, v99, v99
    v_fma_f32 v10, v10, v5, v4
    v_fma_f32 v11, v11, v5, v4
    v_fma_f32 v12, v12, v5, v4
    s_waitcnt lgkmcnt(2)
    v_mfma_f32_32x32x16_bf16 v[128:143], v[28:31], a[8:11], v[128:143]
    ds_read_b128 v[24:27], v38 offset:5120
    s_add_u32 m0, s24, 40960
    s_add_u32 s27, s36, 4096
    buffer_load_dwordx4 v1, s[8:11], s27 offen offset:0  lds
    v_mfma_f32_32x32x16_bf16 v[144:159], v[28:31], a[152:155], v[144:159]
    v_fma_f32 v13, v13, v5, v4
    v_mul_f32 v10, v96, v10
    v_mul_f32 v11, v97, v11
    v_mul_f32 v12, v98, v12
    v_mul_f32 v13, v99, v13
    s_waitcnt lgkmcnt(2)
    v_mfma_f32_32x32x16_bf16 v[128:143], v[32:35], a[12:15], v[128:143]
    ds_read_b128 v[28:31], v38 offset:6144
    buffer_load_dwordx4 v1, s[8:11], s27 offen offset:1024  lds
    v_mfma_f32_32x32x16_bf16 v[144:159], v[32:35], a[156:159], v[144:159]
    v_exp_f32 v10, v10
    v_exp_f32 v11, v11
    v_exp_f32 v12, v12
    s_waitcnt lgkmcnt(2)
    v_mfma_f32_32x32x16_bf16 v[128:143], v[20:23], a[16:19], v[128:143]
    ds_read_b128 v[32:35], v38 offset:7168
    buffer_load_dwordx4 v1, s[8:11], s27 offen offset:2048  lds
    v_mfma_f32_32x32x16_bf16 v[144:159], v[20:23], a[160:163], v[144:159]
    v_exp_f32 v13, v13
    v_mul_f32 v104, v96, v104
    v_mul_f32 v105, v97, v105
    v_mul_f32 v106, v98, v106
    v_mul_f32 v107, v99, v107
    s_waitcnt lgkmcnt(2)
    v_mfma_f32_32x32x16_bf16 v[128:143], v[24:27], a[20:23], v[128:143]
    ds_read_b128 v[20:23], v38 offset:8192
    buffer_load_dwordx4 v1, s[8:11], s27 offen offset:3072  lds
    v_fma_f32 v10, v10, v6, v6
    v_mfma_f32_32x32x16_bf16 v[144:159], v[24:27], a[164:167], v[144:159]
    v_fma_f32 v11, v11, v6, v6
    v_fma_f32 v12, v12, v6, v6
    v_fma_f32 v13, v13, v6, v6
    v_rcp_f32 v10, v10
    s_waitcnt lgkmcnt(2)
    v_mfma_f32_32x32x16_bf16 v[128:143], v[28:31], a[24:27], v[128:143]
    ds_read_b128 v[24:27], v38 offset:9216
    s_add_u32 m0, s24, 45056
    s_add_u32 s27, s36, 8192
    buffer_load_dwordx4 v1, s[8:11], s27 offen offset:0  lds
    v_mfma_f32_32x32x16_bf16 v[144:159], v[28:31], a[168:171], v[144:159]
    v_rcp_f32 v11, v11
    v_rcp_f32 v12, v12
    v_rcp_f32 v13, v13
    s_waitcnt lgkmcnt(2)
    v_mfma_f32_32x32x16_bf16 v[128:143], v[32:35], a[28:31], v[128:143]
    ds_read_b128 v[28:31], v38 offset:10240
    s_nop 0
    v_mul_f32 v104, v104, v10
    v_mul_f32 v105, v105, v11
    v_mul_f32 v106, v106, v12
    v_mul_f32 v107, v107, v13
    v_mfma_f32_32x32x16_bf16 v[144:159], v[32:35], a[172:175], v[144:159]
    v_cvt_pk_bf16_f32 v96, v104, v105
    v_cvt_pk_bf16_f32 v97, v106, v107
    v_mul_f32 v14, v100, v100
    v_mul_f32 v15, v101, v101
    v_mul_f32 v16, v102, v102
    v_mul_f32 v17, v103, v103
    s_waitcnt lgkmcnt(2)
    v_mfma_f32_32x32x16_bf16 v[128:143], v[20:23], a[32:35], v[128:143]
    ds_read_b128 v[32:35], v38 offset:11264
    v_fma_f32 v14, v14, v5, v4
    v_fma_f32 v15, v15, v5, v4
    v_fma_f32 v16, v16, v5, v4
    v_fma_f32 v17, v17, v5, v4
    v_mul_f32 v14, v100, v14
    v_mfma_f32_32x32x16_bf16 v[144:159], v[20:23], a[176:179], v[144:159]
    v_mul_f32 v15, v101, v15
    v_mul_f32 v16, v102, v16
    v_mul_f32 v17, v103, v17
    v_exp_f32 v14, v14
    s_waitcnt lgkmcnt(2)
    v_mfma_f32_32x32x16_bf16 v[128:143], v[24:27], a[36:39], v[128:143]
    ds_read_b128 v[20:23], v38 offset:12288
    v_exp_f32 v15, v15
    v_exp_f32 v16, v16
    v_mfma_f32_32x32x16_bf16 v[144:159], v[24:27], a[180:183], v[144:159]
    v_exp_f32 v17, v17
    v_mul_f32 v108, v100, v108
    v_mul_f32 v109, v101, v109
    v_mul_f32 v110, v102, v110
    v_mul_f32 v111, v103, v111
    s_waitcnt lgkmcnt(2)
    v_mfma_f32_32x32x16_bf16 v[128:143], v[28:31], a[40:43], v[128:143]
    ds_read_b128 v[24:27], v38 offset:13312
    v_fma_f32 v14, v14, v6, v6
    v_fma_f32 v15, v15, v6, v6
    v_fma_f32 v16, v16, v6, v6
    v_fma_f32 v17, v17, v6, v6
    v_mfma_f32_32x32x16_bf16 v[144:159], v[28:31], a[184:187], v[144:159]
    v_rcp_f32 v14, v14
    v_rcp_f32 v15, v15
    v_rcp_f32 v16, v16
    s_waitcnt lgkmcnt(2)
    v_mfma_f32_32x32x16_bf16 v[128:143], v[32:35], a[44:47], v[128:143]
    ds_read_b128 v[28:31], v38 offset:14336
    v_rcp_f32 v17, v17
    s_nop 0
    v_mul_f32 v108, v108, v14
    v_mul_f32 v109, v109, v15
    v_mfma_f32_32x32x16_bf16 v[144:159], v[32:35], a[188:191], v[144:159]
    v_mul_f32 v110, v110, v16
    v_mul_f32 v111, v111, v17
    v_cvt_pk_bf16_f32 v98, v108, v109
    v_cvt_pk_bf16_f32 v99, v110, v111
    s_add_u32 s29, s20, 2560
    s_waitcnt lgkmcnt(2)
    v_mfma_f32_32x32x16_bf16 v[128:143], v[20:23], a[48:51], v[128:143]
    ds_read_b128 v[32:35], v38 offset:15360
    buffer_store_dwordx4 v[96:99], v2, s[8:11], s29 offen sc1
    v_mul_f32 v10, v112, v112
    v_mfma_f32_32x32x16_bf16 v[144:159], v[20:23], a[192:195], v[144:159]
    v_mul_f32 v11, v113, v113
    v_mul_f32 v12, v114, v114
    v_mul_f32 v13, v115, v115
    v_fma_f32 v10, v10, v8, v7
    v_fma_f32 v11, v11, v8, v7
    v_fma_f32 v12, v12, v8, v7
    s_waitcnt lgkmcnt(2)
    v_mfma_f32_32x32x16_bf16 v[128:143], v[24:27], a[52:55], v[128:143]
    ds_read_b128 v[20:23], v38 offset:16384
    v_fma_f32 v13, v13, v8, v7
    v_mul_f32 v10, v112, v10
    v_mul_f32 v11, v113, v11
    v_mul_f32 v12, v114, v12
    v_mul_f32 v13, v115, v13
    v_mfma_f32_32x32x16_bf16 v[144:159], v[24:27], a[196:199], v[144:159]
    v_exp_f32 v10, v10
    v_exp_f32 v11, v11
    v_exp_f32 v12, v12
    s_waitcnt lgkmcnt(2)
    v_mfma_f32_32x32x16_bf16 v[128:143], v[28:31], a[56:59], v[128:143]
    ds_read_b128 v[24:27], v38 offset:17408
    v_exp_f32 v13, v13
    v_mul_f32 v120, v112, v120
    v_mul_f32 v121, v113, v121
    v_mul_f32 v122, v114, v122
    v_mfma_f32_32x32x16_bf16 v[144:159], v[28:31], a[200:203], v[144:159]
    v_mul_f32 v123, v115, v123
    v_fma_f32 v10, v10, v9, v9
    v_fma_f32 v11, v11, v9, v9
    v_fma_f32 v12, v12, v9, v9
    v_fma_f32 v13, v13, v9, v9
    s_waitcnt lgkmcnt(2)
    v_mfma_f32_32x32x16_bf16 v[128:143], v[32:35], a[60:63], v[128:143]
    ds_read_b128 v[28:31], v38 offset:18432
    v_rcp_f32 v10, v10
    v_rcp_f32 v11, v11
    v_mfma_f32_32x32x16_bf16 v[144:159], v[32:35], a[204:207], v[144:159]
    v_rcp_f32 v12, v12
    v_rcp_f32 v13, v13
    s_nop 0
    v_mul_f32 v120, v120, v10
    s_waitcnt lgkmcnt(2)
    v_mfma_f32_32x32x16_bf16 v[128:143], v[20:23], a[64:67], v[128:143]
    ds_read_b128 v[32:35], v38 offset:19456
    v_mul_f32 v121, v121, v11
    v_mul_f32 v122, v122, v12
    v_mul_f32 v123, v123, v13
    v_cvt_pk_bf16_f32 v112, v120, v121
    v_cvt_pk_bf16_f32 v113, v122, v123
    v_mfma_f32_32x32x16_bf16 v[144:159], v[20:23], a[208:211], v[144:159]
    v_mul_f32 v14, v116, v116
    v_mul_f32 v15, v117, v117
    v_mul_f32 v16, v118, v118
    v_mul_f32 v17, v119, v119
    v_fma_f32 v14, v14, v8, v7
    v_fma_f32 v15, v15, v8, v7
    s_waitcnt lgkmcnt(2)
    v_mfma_f32_32x32x16_bf16 v[128:143], v[24:27], a[68:71], v[128:143]
    ds_read_b128 v[20:23], v38 offset:20480
    v_fma_f32 v16, v16, v8, v7
    v_fma_f32 v17, v17, v8, v7
    v_mul_f32 v14, v116, v14
    v_mul_f32 v15, v117, v15
    v_mul_f32 v16, v118, v16
    v_mfma_f32_32x32x16_bf16 v[144:159], v[24:27], a[212:215], v[144:159]
    v_mul_f32 v17, v119, v17
    v_exp_f32 v14, v14
    v_exp_f32 v15, v15
    s_waitcnt lgkmcnt(2)
    v_mfma_f32_32x32x16_bf16 v[128:143], v[28:31], a[72:75], v[128:143]
    ds_read_b128 v[24:27], v38 offset:21504
    v_exp_f32 v16, v16
    v_exp_f32 v17, v17
    v_mul_f32 v124, v116, v124
    v_mfma_f32_32x32x16_bf16 v[144:159], v[28:31], a[216:219], v[144:159]
    v_mul_f32 v125, v117, v125
    v_mul_f32 v126, v118, v126
    v_mul_f32 v127, v119, v127
    v_fma_f32 v14, v14, v9, v9
    v_fma_f32 v15, v15, v9, v9
    v_fma_f32 v16, v16, v9, v9
    s_waitcnt lgkmcnt(2)
    v_mfma_f32_32x32x16_bf16 v[128:143], v[32:35], a[76:79], v[128:143]
    ds_read_b128 v[28:31], v38 offset:22528
    v_fma_f32 v17, v17, v9, v9
    v_rcp_f32 v14, v14
    v_rcp_f32 v15, v15
    v_mfma_f32_32x32x16_bf16 v[144:159], v[32:35], a[220:223], v[144:159]
    v_rcp_f32 v16, v16
    v_rcp_f32 v17, v17
    s_nop 0
    v_mul_f32 v124, v124, v14
    s_waitcnt lgkmcnt(2)
    v_mfma_f32_32x32x16_bf16 v[128:143], v[20:23], a[80:83], v[128:143]
    ds_read_b128 v[32:35], v38 offset:23552
    v_mul_f32 v125, v125, v15
    v_mul_f32 v126, v126, v16
    v_mul_f32 v127, v127, v17
    v_cvt_pk_bf16_f32 v114, v124, v125
    v_cvt_pk_bf16_f32 v115, v126, v127
    v_mfma_f32_32x32x16_bf16 v[144:159], v[20:23], a[224:227], v[144:159]
    s_add_u32 s29, s20, 297472
    buffer_store_dwordx4 v[112:115], v2, s[8:11], s29 offen sc1
    s_waitcnt lgkmcnt(2)
    v_mfma_f32_32x32x16_bf16 v[128:143], v[24:27], a[84:87], v[128:143]
    ds_read_b128 v[20:23], v38 offset:24576
    v_mfma_f32_32x32x16_bf16 v[144:159], v[24:27], a[228:231], v[144:159]
    s_waitcnt lgkmcnt(2)
    v_mfma_f32_32x32x16_bf16 v[128:143], v[28:31], a[88:91], v[128:143]
    ds_read_b128 v[24:27], v38 offset:25600
    v_mfma_f32_32x32x16_bf16 v[144:159], v[28:31], a[232:235], v[144:159]
    s_waitcnt lgkmcnt(2)
    v_mfma_f32_32x32x16_bf16 v[128:143], v[32:35], a[92:95], v[128:143]
    ds_read_b128 v[28:31], v38 offset:26624
    v_mfma_f32_32x32x16_bf16 v[144:159], v[32:35], a[236:239], v[144:159]
    s_waitcnt lgkmcnt(2)
    v_mfma_f32_32x32x16_bf16 v[128:143], v[20:23], a[96:99], v[128:143]
    ds_read_b128 v[32:35], v38 offset:27648
    v_mfma_f32_32x32x16_bf16 v[144:159], v[20:23], a[240:243], v[144:159]
    s_waitcnt lgkmcnt(2)
    v_mfma_f32_32x32x16_bf16 v[128:143], v[24:27], a[100:103], v[128:143]
    ds_read_b128 v[20:23], v38 offset:28672
    v_mfma_f32_32x32x16_bf16 v[144:159], v[24:27], a[244:247], v[144:159]
    s_waitcnt lgkmcnt(2)
    v_mfma_f32_32x32x16_bf16 v[128:143], v[28:31], a[104:107], v[128:143]
    ds_read_b128 v[24:27], v38 offset:29696
    v_mfma_f32_32x32x16_bf16 v[144:159], v[28:31], a[248:251], v[144:159]
    s_waitcnt lgkmcnt(2)
    v_mfma_f32_32x32x16_bf16 v[128:143], v[32:35], a[108:111], v[128:143]
    ds_read_b128 v[28:31], v38 offset:30720
    v_mfma_f32_32x32x16_bf16 v[144:159], v[32:35], a[252:255], v[144:159]
    s_waitcnt lgkmcnt(2)
    v_mfma_f32_32x32x16_bf16 v[128:143], v[20:23], a[112:115], v[128:143]
    ds_read_b128 v[32:35], v38 offset:31744
    v_mfma_f32_32x32x16_bf16 v[144:159], v[20:23], v[224:227], v[144:159]
    s_waitcnt lgkmcnt(2)
    v_mfma_f32_32x32x16_bf16 v[128:143], v[24:27], a[116:119], v[128:143]
    ds_read_b128 v[20:23], v38 offset:32768
    v_mfma_f32_32x32x16_bf16 v[144:159], v[24:27], v[228:231], v[144:159]
    s_waitcnt lgkmcnt(2)
    v_mfma_f32_32x32x16_bf16 v[128:143], v[28:31], a[120:123], v[128:143]
    ds_read_b128 v[24:27], v38 offset:33792
    v_mfma_f32_32x32x16_bf16 v[144:159], v[28:31], v[232:235], v[144:159]
    s_waitcnt lgkmcnt(2)
    v_mfma_f32_32x32x16_bf16 v[128:143], v[32:35], a[124:127], v[128:143]
    ds_read_b128 v[28:31], v38 offset:34816
    v_mfma_f32_32x32x16_bf16 v[144:159], v[32:35], v[236:239], v[144:159]
    s_waitcnt lgkmcnt(2)
    v_mfma_f32_32x32x16_bf16 v[128:143], v[20:23], a[128:131], v[128:143]
    ds_read_b128 v[32:35], v38 offset:35840
    v_mfma_f32_32x32x16_bf16 v[144:159], v[20:23], v[240:243], v[144:159]
    s_waitcnt lgkmcnt(2)
    v_mfma_f32_32x32x16_bf16 v[128:143], v[24:27], a[132:135], v[128:143]
    v_mfma_f32_32x32x16_bf16 v[144:159], v[24:27], v[244:247], v[144:159]
    s_waitcnt lgkmcnt(0)
    s_waitcnt vmcnt(27)
    s_barrier
    ds_read_b128 v[20:23], v39 offset:0
    v_mfma_f32_32x32x16_bf16 v[128:143], v[28:31], a[136:139], v[128:143]
    ds_read_b128 v[24:27], v39 offset:1024
    s_add_u32 m0, s24, 73728
    s_add_u32 s27, s36, 36864
    buffer_load_dwordx4 v1, s[8:11], s27 offen offset:0  lds
    v_mfma_f32_32x32x16_bf16 v[144:159], v[28:31], v[248:251], v[144:159]
    v_mfma_f32_32x32x16_bf16 v[128:143], v[32:35], a[140:143], v[128:143]
    ds_read_b128 v[28:31], v39 offset:2048
    buffer_load_dwordx4 v1, s[8:11], s27 offen offset:1024  lds
    v_mfma_f32_32x32x16_bf16 v[144:159], v[32:35], v[252:255], v[144:159]
    s_waitcnt lgkmcnt(2)
    v_mfma_f32_32x32x16_bf16 v[64:79], v[20:23], a[0:3], 0
    ds_read_b128 v[32:35], v39 offset:3072
    buffer_load_dwordx4 v1, s[8:11], s27 offen offset:2048  lds
    v_mfma_f32_32x32x16_bf16 v[80:95], v[20:23], a[144:147], 0
    s_waitcnt lgkmcnt(2)
    v_mfma_f32_32x32x16_bf16 v[64:79], v[24:27], a[4:7], v[64:79]
    ds_read_b128 v[20:23], v39 offset:4096
    buffer_load_dwordx4 v1, s[8:11], s27 offen offset:3072  lds
    v_mul_f32 v10, v128, v128
    v_mfma_f32_32x32x16_bf16 v[80:95], v[24:27], a[148:151], v[80:95]
    v_mul_f32 v11, v129, v129
    v_mul_f32 v12, v130, v130
    v_mul_f32 v13, v131, v131
    v_fma_f32 v10, v10, v5, v4
    v_fma_f32 v11, v11, v5, v4
    v_fma_f32 v12, v12, v5, v4
    s_waitcnt lgkmcnt(2)
    v_mfma_f32_32x32x16_bf16 v[64:79], v[28:31], a[8:11], v[64:79]
    ds_read_b128 v[24:27], v39 offset:5120
    s_add_u32 m0, s24, 77824
    s_add_u32 s27, s36, 40960
    buffer_load_dwordx4 v1, s[8:11], s27 offen offset:0  lds
    v_mfma_f32_32x32x16_bf16 v[80:95], v[28:31], a[152:155], v[80:95]
    v_fma_f32 v13, v13, v5, v4
    v_mul_f32 v10, v128, v10
    v_mul_f32 v11, v129, v11
    v_mul_f32 v12, v130, v12
    v_mul_f32 v13, v131, v13
    s_waitcnt lgkmcnt(2)
    v_mfma_f32_32x32x16_bf16 v[64:79], v[32:35], a[12:15], v[64:79]
    ds_read_b128 v[28:31], v39 offset:6144
    buffer_load_dwordx4 v1, s[8:11], s27 offen offset:1024  lds
    v_mfma_f32_32x32x16_bf16 v[80:95], v[32:35], a[156:159], v[80:95]
    v_exp_f32 v10, v10
    v_exp_f32 v11, v11
    v_exp_f32 v12, v12
    s_waitcnt lgkmcnt(2)
    v_mfma_f32_32x32x16_bf16 v[64:79], v[20:23], a[16:19], v[64:79]
    ds_read_b128 v[32:35], v39 offset:7168
    buffer_load_dwordx4 v1, s[8:11], s27 offen offset:2048  lds
    v_mfma_f32_32x32x16_bf16 v[80:95], v[20:23], a[160:163], v[80:95]
    v_exp_f32 v13, v13
    v_mul_f32 v136, v128, v136
    v_mul_f32 v137, v129, v137
    v_mul_f32 v138, v130, v138
    v_mul_f32 v139, v131, v139
    s_waitcnt lgkmcnt(2)
    v_mfma_f32_32x32x16_bf16 v[64:79], v[24:27], a[20:23], v[64:79]
    ds_read_b128 v[20:23], v39 offset:8192
    buffer_load_dwordx4 v1, s[8:11], s27 offen offset:3072  lds
    v_fma_f32 v10, v10, v6, v6
    v_mfma_f32_32x32x16_bf16 v[80:95], v[24:27], a[164:167], v[80:95]
    v_fma_f32 v11, v11, v6, v6
    v_fma_f32 v12, v12, v6, v6
    v_fma_f32 v13, v13, v6, v6
    v_rcp_f32 v10, v10
    s_waitcnt lgkmcnt(2)
    v_mfma_f32_32x32x16_bf16 v[64:79], v[28:31], a[24:27], v[64:79]
    ds_read_b128 v[24:27], v39 offset:9216
    s_add_u32 m0, s24, 81920
    s_add_u32 s27, s36, 45056
    buffer_load_dwordx4 v1, s[8:11], s27 offen offset:0  lds
    v_mfma_f32_32x32x16_bf16 v[80:95], v[28:31], a[168:171], v[80:95]
    v_rcp_f32 v11, v11
    v_rcp_f32 v12, v12
    v_rcp_f32 v13, v13
    s_waitcnt lgkmcnt(2)
    v_mfma_f32_32x32x16_bf16 v[64:79], v[32:35], a[28:31], v[64:79]
    ds_read_b128 v[28:31], v39 offset:10240
    s_nop 0
    v_mul_f32 v136, v136, v10
    v_mul_f32 v137, v137, v11
    v_mul_f32 v138, v138, v12
    v_mul_f32 v139, v139, v13
    v_mfma_f32_32x32x16_bf16 v[80:95], v[32:35], a[172:175], v[80:95]
    v_cvt_pk_bf16_f32 v128, v136, v137
    v_cvt_pk_bf16_f32 v129, v138, v139
    v_mul_f32 v14, v132, v132
    v_mul_f32 v15, v133, v133
    v_mul_f32 v16, v134, v134
    v_mul_f32 v17, v135, v135
    s_waitcnt lgkmcnt(2)
    v_mfma_f32_32x32x16_bf16 v[64:79], v[20:23], a[32:35], v[64:79]
    ds_read_b128 v[32:35], v39 offset:11264
    v_fma_f32 v14, v14, v5, v4
    v_fma_f32 v15, v15, v5, v4
    v_fma_f32 v16, v16, v5, v4
    v_fma_f32 v17, v17, v5, v4
    v_mul_f32 v14, v132, v14
    v_mfma_f32_32x32x16_bf16 v[80:95], v[20:23], a[176:179], v[80:95]
    v_mul_f32 v15, v133, v15
    v_mul_f32 v16, v134, v16
    v_mul_f32 v17, v135, v17
    v_exp_f32 v14, v14
    s_waitcnt lgkmcnt(2)
    v_mfma_f32_32x32x16_bf16 v[64:79], v[24:27], a[36:39], v[64:79]
    ds_read_b128 v[20:23], v39 offset:12288
    v_exp_f32 v15, v15
    v_exp_f32 v16, v16
    v_mfma_f32_32x32x16_bf16 v[80:95], v[24:27], a[180:183], v[80:95]
    v_exp_f32 v17, v17
    v_mul_f32 v140, v132, v140
    v_mul_f32 v141, v133, v141
    v_mul_f32 v142, v134, v142
    v_mul_f32 v143, v135, v143
    s_waitcnt lgkmcnt(2)
    v_mfma_f32_32x32x16_bf16 v[64:79], v[28:31], a[40:43], v[64:79]
    ds_read_b128 v[24:27], v39 offset:13312
    v_fma_f32 v14, v14, v6, v6
    v_fma_f32 v15, v15, v6, v6
    v_fma_f32 v16, v16, v6, v6
    v_fma_f32 v17, v17, v6, v6
    v_mfma_f32_32x32x16_bf16 v[80:95], v[28:31], a[184:187], v[80:95]
    v_rcp_f32 v14, v14
    v_rcp_f32 v15, v15
    v_rcp_f32 v16, v16
    s_waitcnt lgkmcnt(2)
    v_mfma_f32_32x32x16_bf16 v[64:79], v[32:35], a[44:47], v[64:79]
    ds_read_b128 v[28:31], v39 offset:14336
    v_rcp_f32 v17, v17
    s_nop 0
    v_mul_f32 v140, v140, v14
    v_mul_f32 v141, v141, v15
    v_mfma_f32_32x32x16_bf16 v[80:95], v[32:35], a[188:191], v[80:95]
    v_mul_f32 v142, v142, v16
    v_mul_f32 v143, v143, v17
    v_cvt_pk_bf16_f32 v130, v140, v141
    v_cvt_pk_bf16_f32 v131, v142, v143
    s_add_u32 s29, s20, 3072
    s_waitcnt lgkmcnt(2)
    v_mfma_f32_32x32x16_bf16 v[64:79], v[20:23], a[48:51], v[64:79]
    ds_read_b128 v[32:35], v39 offset:15360
    buffer_store_dwordx4 v[128:131], v2, s[8:11], s29 offen sc1
    v_mul_f32 v10, v144, v144
    v_mfma_f32_32x32x16_bf16 v[80:95], v[20:23], a[192:195], v[80:95]
    v_mul_f32 v11, v145, v145
    v_mul_f32 v12, v146, v146
    v_mul_f32 v13, v147, v147
    v_fma_f32 v10, v10, v8, v7
    v_fma_f32 v11, v11, v8, v7
    v_fma_f32 v12, v12, v8, v7
    s_waitcnt lgkmcnt(2)
    v_mfma_f32_32x32x16_bf16 v[64:79], v[24:27], a[52:55], v[64:79]
    ds_read_b128 v[20:23], v39 offset:16384
    v_fma_f32 v13, v13, v8, v7
    v_mul_f32 v10, v144, v10
    v_mul_f32 v11, v145, v11
    v_mul_f32 v12, v146, v12
    v_mul_f32 v13, v147, v13
    v_mfma_f32_32x32x16_bf16 v[80:95], v[24:27], a[196:199], v[80:95]
    v_exp_f32 v10, v10
    v_exp_f32 v11, v11
    v_exp_f32 v12, v12
    s_waitcnt lgkmcnt(2)
    v_mfma_f32_32x32x16_bf16 v[64:79], v[28:31], a[56:59], v[64:79]
    ds_read_b128 v[24:27], v39 offset:17408
    v_exp_f32 v13, v13
    v_mul_f32 v152, v144, v152
    v_mul_f32 v153, v145, v153
    v_mul_f32 v154, v146, v154
    v_mfma_f32_32x32x16_bf16 v[80:95], v[28:31], a[200:203], v[80:95]
    v_mul_f32 v155, v147, v155
    v_fma_f32 v10, v10, v9, v9
    v_fma_f32 v11, v11, v9, v9
    v_fma_f32 v12, v12, v9, v9
    v_fma_f32 v13, v13, v9, v9
    s_waitcnt lgkmcnt(2)
    v_mfma_f32_32x32x16_bf16 v[64:79], v[32:35], a[60:63], v[64:79]
    ds_read_b128 v[28:31], v39 offset:18432
    v_rcp_f32 v10, v10
    v_rcp_f32 v11, v11
    v_mfma_f32_32x32x16_bf16 v[80:95], v[32:35], a[204:207], v[80:95]
    v_rcp_f32 v12, v12
    v_rcp_f32 v13, v13
    s_nop 0
    v_mul_f32 v152, v152, v10
    s_waitcnt lgkmcnt(2)
    v_mfma_f32_32x32x16_bf16 v[64:79], v[20:23], a[64:67], v[64:79]
    ds_read_b128 v[32:35], v39 offset:19456
    v_mul_f32 v153, v153, v11
    v_mul_f32 v154, v154, v12
    v_mul_f32 v155, v155, v13
    v_cvt_pk_bf16_f32 v144, v152, v153
    v_cvt_pk_bf16_f32 v145, v154, v155
    v_mfma_f32_32x32x16_bf16 v[80:95], v[20:23], a[208:211], v[80:95]
    v_mul_f32 v14, v148, v148
    v_mul_f32 v15, v149, v149
    v_mul_f32 v16, v150, v150
    v_mul_f32 v17, v151, v151
    v_fma_f32 v14, v14, v8, v7
    v_fma_f32 v15, v15, v8, v7
    s_waitcnt lgkmcnt(2)
    v_mfma_f32_32x32x16_bf16 v[64:79], v[24:27], a[68:71], v[64:79]
    ds_read_b128 v[20:23], v39 offset:20480
    v_fma_f32 v16, v16, v8, v7
    v_fma_f32 v17, v17, v8, v7
    v_mul_f32 v14, v148, v14
    v_mul_f32 v15, v149, v15
    v_mul_f32 v16, v150, v16
    v_mfma_f32_32x32x16_bf16 v[80:95], v[24:27], a[212:215], v[80:95]
    v_mul_f32 v17, v151, v17
    v_exp_f32 v14, v14
    v_exp_f32 v15, v15
    s_waitcnt lgkmcnt(2)
    v_mfma_f32_32x32x16_bf16 v[64:79], v[28:31], a[72:75], v[64:79]
    ds_read_b128 v[24:27], v39 offset:21504
    v_exp_f32 v16, v16
    v_exp_f32 v17, v17
    v_mul_f32 v156, v148, v156
    v_mfma_f32_32x32x16_bf16 v[80:95], v[28:31], a[216:219], v[80:95]
    v_mul_f32 v157, v149, v157
    v_mul_f32 v158, v150, v158
    v_mul_f32 v159, v151, v159
    v_fma_f32 v14, v14, v9, v9
    v_fma_f32 v15, v15, v9, v9
    v_fma_f32 v16, v16, v9, v9
    s_waitcnt lgkmcnt(2)
    v_mfma_f32_32x32x16_bf16 v[64:79], v[32:35], a[76:79], v[64:79]
    ds_read_b128 v[28:31], v39 offset:22528
    v_fma_f32 v17, v17, v9, v9
    v_rcp_f32 v14, v14
    v_rcp_f32 v15, v15
    v_mfma_f32_32x32x16_bf16 v[80:95], v[32:35], a[220:223], v[80:95]
    v_rcp_f32 v16, v16
    v_rcp_f32 v17, v17
    s_nop 0
    v_mul_f32 v156, v156, v14
    s_waitcnt lgkmcnt(2)
    v_mfma_f32_32x32x16_bf16 v[64:79], v[20:23], a[80:83], v[64:79]
    ds_read_b128 v[32:35], v39 offset:23552
    v_mul_f32 v157, v157, v15
    v_mul_f32 v158, v158, v16
    v_mul_f32 v159, v159, v17
    v_cvt_pk_bf16_f32 v146, v156, v157
    v_cvt_pk_bf16_f32 v147, v158, v159
    v_mfma_f32_32x32x16_bf16 v[80:95], v[20:23], a[224:227], v[80:95]
    s_add_u32 s29, s20, 297984
    buffer_store_dwordx4 v[144:147], v2, s[8:11], s29 offen sc1
    s_waitcnt lgkmcnt(2)
    v_mfma_f32_32x32x16_bf16 v[64:79], v[24:27], a[84:87], v[64:79]
    ds_read_b128 v[20:23], v39 offset:24576
    v_mfma_f32_32x32x16_bf16 v[80:95], v[24:27], a[228:231], v[80:95]
    s_waitcnt lgkmcnt(2)
    v_mfma_f32_32x32x16_bf16 v[64:79], v[28:31], a[88:91], v[64:79]
    ds_read_b128 v[24:27], v39 offset:25600
    v_mfma_f32_32x32x16_bf16 v[80:95], v[28:31], a[232:235], v[80:95]
    s_waitcnt lgkmcnt(2)
    v_mfma_f32_32x32x16_bf16 v[64:79], v[32:35], a[92:95], v[64:79]
    ds_read_b128 v[28:31], v39 offset:26624
    v_mfma_f32_32x32x16_bf16 v[80:95], v[32:35], a[236:239], v[80:95]
    s_waitcnt lgkmcnt(2)
    v_mfma_f32_32x32x16_bf16 v[64:79], v[20:23], a[96:99], v[64:79]
    ds_read_b128 v[32:35], v39 offset:27648
    v_mfma_f32_32x32x16_bf16 v[80:95], v[20:23], a[240:243], v[80:95]
    s_waitcnt lgkmcnt(2)
    v_mfma_f32_32x32x16_bf16 v[64:79], v[24:27], a[100:103], v[64:79]
    ds_read_b128 v[20:23], v39 offset:28672
    v_mfma_f32_32x32x16_bf16 v[80:95], v[24:27], a[244:247], v[80:95]
    s_waitcnt lgkmcnt(2)
    v_mfma_f32_32x32x16_bf16 v[64:79], v[28:31], a[104:107], v[64:79]
    ds_read_b128 v[24:27], v39 offset:29696
    v_mfma_f32_32x32x16_bf16 v[80:95], v[28:31], a[248:251], v[80:95]
    s_waitcnt lgkmcnt(2)
    v_mfma_f32_32x32x16_bf16 v[64:79], v[32:35], a[108:111], v[64:79]
    ds_read_b128 v[28:31], v39 offset:30720
    v_mfma_f32_32x32x16_bf16 v[80:95], v[32:35], a[252:255], v[80:95]
    s_waitcnt lgkmcnt(2)
    v_mfma_f32_32x32x16_bf16 v[64:79], v[20:23], a[112:115], v[64:79]
    ds_read_b128 v[32:35], v39 offset:31744
    v_mfma_f32_32x32x16_bf16 v[80:95], v[20:23], v[224:227], v[80:95]
    s_waitcnt lgkmcnt(2)
    v_mfma_f32_32x32x16_bf16 v[64:79], v[24:27], a[116:119], v[64:79]
    ds_read_b128 v[20:23], v39 offset:32768
    v_mfma_f32_32x32x16_bf16 v[80:95], v[24:27], v[228:231], v[80:95]
    s_waitcnt lgkmcnt(2)
    v_mfma_f32_32x32x16_bf16 v[64:79], v[28:31], a[120:123], v[64:79]
    ds_read_b128 v[24:27], v39 offset:33792
    v_mfma_f32_32x32x16_bf16 v[80:95], v[28:31], v[232:235], v[80:95]
    s_waitcnt lgkmcnt(2)
    v_mfma_f32_32x32x16_bf16 v[64:79], v[32:35], a[124:127], v[64:79]
    ds_read_b128 v[28:31], v39 offset:34816
    v_mfma_f32_32x32x16_bf16 v[80:95], v[32:35], v[236:239], v[80:95]
    s_waitcnt lgkmcnt(2)
    v_mfma_f32_32x32x16_bf16 v[64:79], v[20:23], a[128:131], v[64:79]
    ds_read_b128 v[32:35], v39 offset:35840
    v_mfma_f32_32x32x16_bf16 v[80:95], v[20:23], v[240:243], v[80:95]
    s_waitcnt lgkmcnt(2)
    v_mfma_f32_32x32x16_bf16 v[64:79], v[24:27], a[132:135], v[64:79]
    v_mfma_f32_32x32x16_bf16 v[80:95], v[24:27], v[244:247], v[80:95]
    s_waitcnt lgkmcnt(0)
    s_waitcnt vmcnt(25)
    s_waitcnt vmcnt(0)
    s_barrier
    s_cmp_lg_u32 s12, 0
    s_cbranch_scc1 L_e13
    v_mov_b32 v40, 0
    v_mov_b32 v41, 1
    s_mov_b64 exec, 1
    buffer_store_dword v41, v40, s[8:11], s30 offen sc1
    s_mov_b64 exec, -1
L_e13:
    ds_read_b128 v[20:23], v36 offset:0
    v_mfma_f32_32x32x16_bf16 v[64:79], v[28:31], a[136:139], v[64:79]
    ds_read_b128 v[24:27], v36 offset:1024
    s_add_u32 m0, s24, 110592
    s_add_u32 s27, s36, 73728
    buffer_load_dwordx4 v1, s[8:11], s27 offen offset:0  lds
    v_mfma_f32_32x32x16_bf16 v[80:95], v[28:31], v[248:251], v[80:95]
    v_mfma_f32_32x32x16_bf16 v[64:79], v[32:35], a[140:143], v[64:79]
    ds_read_b128 v[28:31], v36 offset:2048
    buffer_load_dwordx4 v1, s[8:11], s27 offen offset:1024  lds
    v_mfma_f32_32x32x16_bf16 v[80:95], v[32:35], v[252:255], v[80:95]
    s_waitcnt lgkmcnt(2)
    v_mfma_f32_32x32x16_bf16 v[96:111], v[20:23], a[0:3], 0
    ds_read_b128 v[32:35], v36 offset:3072
    buffer_load_dwordx4 v1, s[8:11], s27 offen offset:2048  lds
    v_mfma_f32_32x32x16_bf16 v[112:127], v[20:23], a[144:147], 0
    s_waitcnt lgkmcnt(2)
    v_mfma_f32_32x32x16_bf16 v[96:111], v[24:27], a[4:7], v[96:111]
    ds_read_b128 v[20:23], v36 offset:4096
    buffer_load_dwordx4 v1, s[8:11], s27 offen offset:3072  lds
    v_mul_f32 v10, v64, v64
    v_mfma_f32_32x32x16_bf16 v[112:127], v[24:27], a[148:151], v[112:127]
    v_mul_f32 v11, v65, v65
    v_mul_f32 v12, v66, v66
    v_mul_f32 v13, v67, v67
    v_fma_f32 v10, v10, v5, v4
    v_fma_f32 v11, v11, v5, v4
    v_fma_f32 v12, v12, v5, v4
    s_waitcnt lgkmcnt(2)
    v_mfma_f32_32x32x16_bf16 v[96:111], v[28:31], a[8:11], v[96:111]
    ds_read_b128 v[24:27], v36 offset:5120
    s_add_u32 m0, s24, 114688
    s_add_u32 s27, s36, 77824
    buffer_load_dwordx4 v1, s[8:11], s27 offen offset:0  lds
    v_mfma_f32_32x32x16_bf16 v[112:127], v[28:31], a[152:155], v[112:127]
    v_fma_f32 v13, v13, v5, v4
    v_mul_f32 v10, v64, v10
    v_mul_f32 v11, v65, v11
    v_mul_f32 v12, v66, v12
    v_mul_f32 v13, v67, v13
    s_waitcnt lgkmcnt(2)
    v_mfma_f32_32x32x16_bf16 v[96:111], v[32:35], a[12:15], v[96:111]
    ds_read_b128 v[28:31], v36 offset:6144
    buffer_load_dwordx4 v1, s[8:11], s27 offen offset:1024  lds
    v_mfma_f32_32x32x16_bf16 v[112:127], v[32:35], a[156:159], v[112:127]
    v_exp_f32 v10, v10
    v_exp_f32 v11, v11
    v_exp_f32 v12, v12
    s_waitcnt lgkmcnt(2)
    v_mfma_f32_32x32x16_bf16 v[96:111], v[20:23], a[16:19], v[96:111]
    ds_read_b128 v[32:35], v36 offset:7168
    buffer_load_dwordx4 v1, s[8:11], s27 offen offset:2048  lds
    v_mfma_f32_32x32x16_bf16 v[112:127], v[20:23], a[160:163], v[112:127]
    v_exp_f32 v13, v13
    v_mul_f32 v72, v64, v72
    v_mul_f32 v73, v65, v73
    v_mul_f32 v74, v66, v74
    v_mul_f32 v75, v67, v75
    s_waitcnt lgkmcnt(2)
    v_mfma_f32_32x32x16_bf16 v[96:111], v[24:27], a[20:23], v[96:111]
    ds_read_b128 v[20:23], v36 offset:8192
    buffer_load_dwordx4 v1, s[8:11], s27 offen offset:3072  lds
    v_fma_f32 v10, v10, v6, v6
    v_mfma_f32_32x32x16_bf16 v[112:127], v[24:27], a[164:167], v[112:127]
    v_fma_f32 v11, v11, v6, v6
    v_fma_f32 v12, v12, v6, v6
    v_fma_f32 v13, v13, v6, v6
    v_rcp_f32 v10, v10
    s_waitcnt lgkmcnt(2)
    v_mfma_f32_32x32x16_bf16 v[96:111], v[28:31], a[24:27], v[96:111]
    ds_read_b128 v[24:27], v36 offset:9216
    s_add_u32 m0, s24, 118784
    s_add_u32 s27, s36, 81920
    buffer_load_dwordx4 v1, s[8:11], s27 offen offset:0  lds
    v_mfma_f32_32x32x16_bf16 v[112:127], v[28:31], a[168:171], v[112:127]
    v_rcp_f32 v11, v11
    v_rcp_f32 v12, v12
    v_rcp_f32 v13, v13
    s_waitcnt lgkmcnt(2)
    v_mfma_f32_32x32x16_bf16 v[96:111], v[32:35], a[28:31], v[96:111]
    ds_read_b128 v[28:31], v36 offset:10240
    s_nop 0
    v_mul_f32 v72, v72, v10
    v_mul_f32 v73, v73, v11
    v_mul_f32 v74, v74, v12
    v_mul_f32 v75, v75, v13
    v_mfma_f32_32x32x16_bf16 v[112:127], v[32:35], a[172:175], v[112:127]
    v_cvt_pk_bf16_f32 v64, v72, v73
    v_cvt_pk_bf16_f32 v65, v74, v75
    v_mul_f32 v14, v68, v68
    v_mul_f32 v15, v69, v69
    v_mul_f32 v16, v70, v70
    v_mul_f32 v17, v71, v71
    s_waitcnt lgkmcnt(2)
    v_mfma_f32_32x32x16_bf16 v[96:111], v[20:23], a[32:35], v[96:111]
    ds_read_b128 v[32:35], v36 offset:11264
    v_fma_f32 v14, v14, v5, v4
    v_fma_f32 v15, v15, v5, v4
    v_fma_f32 v16, v16, v5, v4
    v_fma_f32 v17, v17, v5, v4
    v_mul_f32 v14, v68, v14
    v_mfma_f32_32x32x16_bf16 v[112:127], v[20:23], a[176:179], v[112:127]
    v_mul_f32 v15, v69, v15
    v_mul_f32 v16, v70, v16
    v_mul_f32 v17, v71, v17
    v_exp_f32 v14, v14
    s_waitcnt lgkmcnt(2)
    v_mfma_f32_32x32x16_bf16 v[96:111], v[24:27], a[36:39], v[96:111]
    ds_read_b128 v[20:23], v36 offset:12288
    v_exp_f32 v15, v15
    v_exp_f32 v16, v16
    v_mfma_f32_32x32x16_bf16 v[112:127], v[24:27], a[180:183], v[112:127]
    v_exp_f32 v17, v17
    v_mul_f32 v76, v68, v76
    v_mul_f32 v77, v69, v77
    v_mul_f32 v78, v70, v78
    v_mul_f32 v79, v71, v79
    s_waitcnt lgkmcnt(2)
    buffer_load_dword v18, v19, s[8:11], 0 offen sc1
    v_mfma_f32_32x32x16_bf16 v[96:111], v[28:31], a[40:43], v[96:111]
    ds_read_b128 v[24:27], v36 offset:13312
    v_fma_f32 v14, v14, v6, v6
    v_fma_f32 v15, v15, v6, v6
    v_fma_f32 v16, v16, v6, v6
    v_fma_f32 v17, v17, v6, v6
    v_mfma_f32_32x32x16_bf16 v[112:127], v[28:31], a[184:187], v[112:127]
    v_rcp_f32 v14, v14
    v_rcp_f32 v15, v15
    v_rcp_f32 v16, v16
    s_waitcnt lgkmcnt(2)
    v_mfma_f32_32x32x16_bf16 v[96:111], v[32:35], a[44:47], v[96:111]
    ds_read_b128 v[28:31], v36 offset:14336
    v_rcp_f32 v17, v17
    s_nop 0
    v_mul_f32 v76, v76, v14
    v_mul_f32 v77, v77, v15
    v_mfma_f32_32x32x16_bf16 v[112:127], v[32:35], a[188:191], v[112:127]
    v_mul_f32 v78, v78, v16
    v_mul_f32 v79, v79, v17
    v_cvt_pk_bf16_f32 v66, v76, v77
    v_cvt_pk_bf16_f32 v67, v78, v79
    s_add_u32 s29, s20, 3584
    s_waitcnt lgkmcnt(2)
    v_mfma_f32_32x32x16_bf16 v[96:111], v[20:23], a[48:51], v[96:111]
    ds_read_b128 v[32:35], v36 offset:15360
    buffer_store_dwordx4 v[64:67], v2, s[8:11], s29 offen sc1
    v_mul_f32 v10, v80, v80
    v_mfma_f32_32x32x16_bf16 v[112:127], v[20:23], a[192:195], v[112:127]
    v_mul_f32 v11, v81, v81
    v_mul_f32 v12, v82, v82
    v_mul_f32 v13, v83, v83
    v_fma_f32 v10, v10, v8, v7
    v_fma_f32 v11, v11, v8, v7
    v_fma_f32 v12, v12, v8, v7
    s_waitcnt lgkmcnt(2)
    v_mfma_f32_32x32x16_bf16 v[96:111], v[24:27], a[52:55], v[96:111]
    ds_read_b128 v[20:23], v36 offset:16384
    v_fma_f32 v13, v13, v8, v7
    v_mul_f32 v10, v80, v10
    v_mul_f32 v11, v81, v11
    v_mul_f32 v12, v82, v12
    v_mul_f32 v13, v83, v13
    v_mfma_f32_32x32x16_bf16 v[112:127], v[24:27], a[196:199], v[112:127]
    v_exp_f32 v10, v10
    v_exp_f32 v11, v11
    v_exp_f32 v12, v12
    s_waitcnt lgkmcnt(2)
    v_mfma_f32_32x32x16_bf16 v[96:111], v[28:31], a[56:59], v[96:111]
    ds_read_b128 v[24:27], v36 offset:17408
    v_exp_f32 v13, v13
    v_mul_f32 v88, v80, v88
    v_mul_f32 v89, v81, v89
    v_mul_f32 v90, v82, v90
    v_mfma_f32_32x32x16_bf16 v[112:127], v[28:31], a[200:203], v[112:127]
    v_mul_f32 v91, v83, v91
    v_fma_f32 v10, v10, v9, v9
    v_fma_f32 v11, v11, v9, v9
    v_fma_f32 v12, v12, v9, v9
    v_fma_f32 v13, v13, v9, v9
    s_waitcnt lgkmcnt(2)
    v_mfma_f32_32x32x16_bf16 v[96:111], v[32:35], a[60:63], v[96:111]
    ds_read_b128 v[28:31], v36 offset:18432
    v_rcp_f32 v10, v10
    v_rcp_f32 v11, v11
    v_mfma_f32_32x32x16_bf16 v[112:127], v[32:35], a[204:207], v[112:127]
    v_rcp_f32 v12, v12
    v_rcp_f32 v13, v13
    s_nop 0
    v_mul_f32 v88, v88, v10
    s_waitcnt lgkmcnt(2)
    v_mfma_f32_32x32x16_bf16 v[96:111], v[20:23], a[64:67], v[96:111]
    ds_read_b128 v[32:35], v36 offset:19456
    v_mul_f32 v89, v89, v11
    v_mul_f32 v90, v90, v12
    v_mul_f32 v91, v91, v13
    v_cvt_pk_bf16_f32 v80, v88, v89
    v_cvt_pk_bf16_f32 v81, v90, v91
    v_mfma_f32_32x32x16_bf16 v[112:127], v[20:23], a[208:211], v[112:127]
    v_mul_f32 v14, v84, v84
    v_mul_f32 v15, v85, v85
    v_mul_f32 v16, v86, v86
    v_mul_f32 v17, v87, v87
    v_fma_f32 v14, v14, v8, v7
    v_fma_f32 v15, v15, v8, v7
    s_waitcnt lgkmcnt(2)
    v_mfma_f32_32x32x16_bf16 v[96:111], v[24:27], a[68:71], v[96:111]
    ds_read_b128 v[20:23], v36 offset:20480
    v_fma_f32 v16, v16, v8, v7
    v_fma_f32 v17, v17, v8, v7
    v_mul_f32 v14, v84, v14
    v_mul_f32 v15, v85, v15
    v_mul_f32 v16, v86, v16
    v_mfma_f32_32x32x16_bf16 v[112:127], v[24:27], a[212:215], v[112:127]
    v_mul_f32 v17, v87, v17
    v_exp_f32 v14, v14
    v_exp_f32 v15, v15
    s_waitcnt lgkmcnt(2)
    s_waitcnt vmcnt(1)
    v_cmp_ne_u32 vcc, 1, v18
    s_nop 4
    s_cbranch_vccz L_eok14
    s_mov_b32 s88, 0
L_ep14:
    buffer_load_dword v18, v19, s[8:11], 0 offen sc1
    s_add_u32 s88, s88, 1
    s_waitcnt vmcnt(0)
    v_cmp_ne_u32 vcc, 1, v18
    s_nop 4
    s_cbranch_vccz L_eok14
    s_cmp_lt_u32 s88, 1048576
    s_cbranch_scc1 L_ep14
L_eok14:
    v_mfma_f32_32x32x16_bf16 v[96:111], v[28:31], a[72:75], v[96:111]
    ds_read_b128 v[24:27], v36 offset:21504
    s_add_u32 s28, s37, 0
    buffer_load_dwordx4 v[192:195], v1, s[8:11], s28 offen sc1
    v_mfma_f32_32x32x16_bf16 v[112:127], v[28:31], a[216:219], v[112:127]
    v_exp_f32 v16, v16
    v_exp_f32 v17, v17
    v_mul_f32 v92, v84, v92
    v_mul_f32 v93, v85, v93
    s_waitcnt lgkmcnt(2)
    v_mfma_f32_32x32x16_bf16 v[96:111], v[32:35], a[76:79], v[96:111]
    ds_read_b128 v[28:31], v36 offset:22528
    s_add_u32 s28, s37, 1024
    buffer_load_dwordx4 v[196:199], v1, s[8:11], s28 offen sc1
    v_mfma_f32_32x32x16_bf16 v[112:127], v[32:35], a[220:223], v[112:127]
    v_mul_f32 v94, v86, v94
    v_mul_f32 v95, v87, v95
    v_fma_f32 v14, v14, v9, v9
    v_fma_f32 v15, v15, v9, v9
    v_fma_f32 v16, v16, v9, v9
    v_fma_f32 v17, v17, v9, v9
    s_waitcnt lgkmcnt(2)
    v_mfma_f32_32x32x16_bf16 v[96:111], v[20:23], a[80:83], v[96:111]
    ds_read_b128 v[32:35], v36 offset:23552
    s_add_u32 s28, s37, 2048
    buffer_load_dwordx4 v[200:203], v1, s[8:11], s28 offen sc1
    v_mfma_f32_32x32x16_bf16 v[112:127], v[20:23], a[224:227], v[112:127]
    v_rcp_f32 v14, v14
    v_rcp_f32 v15, v15
    v_rcp_f32 v16, v16
    s_waitcnt lgkmcnt(2)
    v_mfma_f32_32x32x16_bf16 v[96:111], v[24:27], a[84:87], v[96:111]
    ds_read_b128 v[20:23], v36 offset:24576
    s_add_u32 s28, s37, 5120
    buffer_load_dwordx4 v[204:207], v1, s[8:11], s28 offen sc1
    v_mfma_f32_32x32x16_bf16 v[112:127], v[24:27], a[228:231], v[112:127]
    v_rcp_f32 v17, v17
    s_nop 0
    v_mul_f32 v92, v92, v14
    v_mul_f32 v93, v93, v15
    v_mul_f32 v94, v94, v16
    s_waitcnt lgkmcnt(2)
    v_mfma_f32_32x32x16_bf16 v[96:111], v[28:31], a[88:91], v[96:111]
    ds_read_b128 v[24:27], v36 offset:25600
    s_add_u32 s28, s37, 147456
    buffer_load_dwordx4 v[208:211], v1, s[8:11], s28 offen sc1
    v_mfma_f32_32x32x16_bf16 v[112:127], v[28:31], a[232:235], v[112:127]
    v_mul_f32 v95, v95, v17
    v_cvt_pk_bf16_f32 v82, v92, v93
    v_cvt_pk_bf16_f32 v83, v94, v95
    s_add_u32 s29, s20, 298496
    s_waitcnt lgkmcnt(2)
    v_mfma_f32_32x32x16_bf16 v[96:111], v[32:35], a[92:95], v[96:111]
    ds_read_b128 v[28:31], v36 offset:26624
    s_add_u32 s28, s37, 148480
    buffer_load_dwordx4 v[212:215], v1, s[8:11], s28 offen sc1
    v_mfma_f32_32x32x16_bf16 v[112:127], v[32:35], a[236:239], v[112:127]
    buffer_store_dwordx4 v[80:83], v2, s[8:11], s29 offen sc1
    s_waitcnt lgkmcnt(2)
    v_mfma_f32_32x32x16_bf16 v[96:111], v[20:23], a[96:99], v[96:111]
    ds_read_b128 v[32:35], v36 offset:27648
    s_add_u32 s28, s37, 149504
    buffer_load_dwordx4 v[216:219], v1, s[8:11], s28 offen sc1
    v_mfma_f32_32x32x16_bf16 v[112:127], v[20:23], a[240:243], v[112:127]
    s_waitcnt lgkmcnt(2)
    v_mfma_f32_32x32x16_bf16 v[96:111], v[24:27], a[100:103], v[96:111]
    ds_read_b128 v[20:23], v36 offset:28672
    s_add_u32 s28, s37, 152576
    buffer_load_dwordx4 v[220:223], v1, s[8:11], s28 offen sc1
    v_mfma_f32_32x32x16_bf16 v[112:127], v[24:27], a[244:247], v[112:127]
    s_waitcnt lgkmcnt(2)
    v_mfma_f32_32x32x16_bf16 v[96:111], v[28:31], a[104:107], v[96:111]
    ds_read_b128 v[24:27], v36 offset:29696
    s_add_u32 s28, s37, 6144
    buffer_load_dwordx4 v[160:163], v1, s[8:11], s28 offen sc1
    v_mfma_f32_32x32x16_bf16 v[112:127], v[28:31], a[248:251], v[112:127]
    s_waitcnt lgkmcnt(2)
    v_mfma_f32_32x32x16_bf16 v[96:111], v[32:35], a[108:111], v[96:111]
    ds_read_b128 v[28:31], v36 offset:30720
    s_add_u32 s28, s37, 7168
    buffer_load_dwordx4 v[164:167], v1, s[8:11], s28 offen sc1
    v_mfma_f32_32x32x16_bf16 v[112:127], v[32:35], a[252:255], v[112:127]
    s_waitcnt lgkmcnt(2)
    v_mfma_f32_32x32x16_bf16 v[96:111], v[20:23], a[112:115], v[96:111]
    ds_read_b128 v[32:35], v36 offset:31744
    s_add_u32 s28, s37, 9216
    buffer_load_dwordx4 v[168:171], v1, s[8:11], s28 offen sc1
    v_mfma_f32_32x32x16_bf16 v[112:127], v[20:23], v[224:227], v[112:127]
    s_waitcnt lgkmcnt(2)
    v_mfma_f32_32x32x16_bf16 v[96:111], v[24:27], a[116:119], v[96:111]
    ds_read_b128 v[20:23], v36 offset:32768
    s_add_u32 s28, s37, 10240
    buffer_load_dwordx4 v[172:175], v1, s[8:11], s28 offen sc1
    v_mfma_f32_32x32x16_bf16 v[112:127], v[24:27], v[228:231], v[112:127]
    s_waitcnt lgkmcnt(2)
    v_mfma_f32_32x32x16_bf16 v[96:111], v[28:31], a[120:123], v[96:111]
    ds_read_b128 v[24:27], v36 offset:33792
    s_add_u32 s28, s37, 153600
    buffer_load_dwordx4 v[176:179], v1, s[8:11], s28 offen sc1
    v_mfma_f32_32x32x16_bf16 v[112:127], v[28:31], v[232:235], v[112:127]
    s_waitcnt lgkmcnt(2)
    v_mfma_f32_32x32x16_bf16 v[96:111], v[32:35], a[124:127], v[96:111]
    ds_read_b128 v[28:31], v36 offset:34816
    s_add_u32 s28, s37, 154624
    buffer_load_dwordx4 v[180:183], v1, s[8:11], s28 offen sc1
    v_mfma_f32_32x32x16_bf16 v[112:127], v[32:35], v[236:239], v[112:127]
    s_waitcnt lgkmcnt(2)
    v_mfma_f32_32x32x16_bf16 v[96:111], v[20:23], a[128:131], v[96:111]
    ds_read_b128 v[32:35], v36 offset:35840
    s_add_u32 s28, s37, 156672
    buffer_load_dwordx4 v[184:187], v1, s[8:11], s28 offen sc1
    v_mfma_f32_32x32x16_bf16 v[112:127], v[20:23], v[240:243], v[112:127]
    s_waitcnt lgkmcnt(2)
    v_mfma_f32_32x32x16_bf16 v[96:111], v[24:27], a[132:135], v[96:111]
    s_add_u32 s28, s37, 157696
    buffer_load_dwordx4 v[188:191], v1, s[8:11], s28 offen sc1
    v_mfma_f32_32x32x16_bf16 v[112:127], v[24:27], v[244:247], v[112:127]
    s_waitcnt lgkmcnt(1)
    v_mfma_f32_32x32x16_bf16 v[96:111], v[28:31], a[136:139], v[96:111]
    v_mfma_f32_32x32x16_bf16 v[112:127], v[28:31], v[248:251], v[112:127]
    s_waitcnt lgkmcnt(0)
    v_mfma_f32_32x32x16_bf16 v[96:111], v[32:35], a[140:143], v[96:111]
    v_mfma_f32_32x32x16_bf16 v[112:127], v[32:35], v[252:255], v[112:127]
    v_mov_b32 v3, v42
    s_barrier
    s_nop 7
    s_nop 3
    v_pk_mul_f32 v[10:11], v[96:97], v[96:97]
    v_pk_mul_f32 v[12:13], v[98:99], v[98:99]
    v_pk_mul_f32 v[14:15], v[100:101], v[100:101]
    v_pk_mul_f32 v[16:17], v[102:103], v[102:103]
    v_pk_fma_f32 v[10:11], v[10:11], v[4:5], v[4:5] op_sel:[0,1,0] op_sel_hi:[1,1,0]
    v_pk_fma_f32 v[12:13], v[12:13], v[4:5], v[4:5] op_sel:[0,1,0] op_sel_hi:[1,1,0]
    v_pk_fma_f32 v[14:15], v[14:15], v[4:5], v[4:5] op_sel:[0,1,0] op_sel_hi:[1,1,0]
    v_pk_fma_f32 v[16:17], v[16:17], v[4:5], v[4:5] op_sel:[0,1,0] op_sel_hi:[1,1,0]
    v_pk_mul_f32 v[10:11], v[96:97], v[10:11]
    v_pk_mul_f32 v[12:13], v[98:99], v[12:13]
    v_pk_mul_f32 v[14:15], v[100:101], v[14:15]
    v_pk_mul_f32 v[16:17], v[102:103], v[16:17]
    v_exp_f32 v10, v10
    v_exp_f32 v11, v11
    v_exp_f32 v12, v12
    v_exp_f32 v13, v13
    v_exp_f32 v14, v14
    v_exp_f32 v15, v15
    v_exp_f32 v16, v16
    v_exp_f32 v17, v17
    v_pk_mul_f32 v[104:105], v[96:97], v[104:105]
    v_pk_mul_f32 v[106:107], v[98:99], v[106:107]
    v_pk_mul_f32 v[108:109], v[100:101], v[108:109]
    v_pk_mul_f32 v[110:111], v[102:103], v[110:111]
    v_pk_fma_f32 v[10:11], v[10:11], v[6:7], v[6:7] op_sel:[0,0,0] op_sel_hi:[1,0,0]
    v_pk_fma_f32 v[12:13], v[12:13], v[6:7], v[6:7] op_sel:[0,0,0] op_sel_hi:[1,0,0]
    v_pk_fma_f32 v[14:15], v[14:15], v[6:7], v[6:7] op_sel:[0,0,0] op_sel_hi:[1,0,0]
    v_pk_fma_f32 v[16:17], v[16:17], v[6:7], v[6:7] op_sel:[0,0,0] op_sel_hi:[1,0,0]
    v_rcp_f32 v10, v10
    v_rcp_f32 v11, v11
    v_rcp_f32 v12, v12
    v_rcp_f32 v13, v13
    v_rcp_f32 v14, v14
    v_rcp_f32 v15, v15
    v_rcp_f32 v16, v16
    v_rcp_f32 v17, v17
    s_nop 0
    v_pk_mul_f32 v[104:105], v[104:105], v[10:11]
    v_pk_mul_f32 v[106:107], v[106:107], v[12:13]
    v_pk_mul_f32 v[108:109], v[108:109], v[14:15]
    v_pk_mul_f32 v[110:111], v[110:111], v[16:17]
    v_cvt_pk_bf16_f32 v96, v104, v105
    v_cvt_pk_bf16_f32 v97, v106, v107
    v_cvt_pk_bf16_f32 v98, v108, v109
    v_cvt_pk_bf16_f32 v99, v110, v111
    s_add_u32 s29, s20, 4096
    buffer_store_dwordx4 v[96:99], v2, s[8:11], s29 offen sc1
    v_pk_mul_f32 v[10:11], v[112:113], v[112:113]
    v_pk_mul_f32 v[12:13], v[114:115], v[114:115]
    v_pk_mul_f32 v[14:15], v[116:117], v[116:117]
    v_pk_mul_f32 v[16:17], v[118:119], v[118:119]
    v_pk_fma_f32 v[10:11], v[10:11], v[8:9], v[6:7] op_sel:[0,0,1] op_sel_hi:[1,0,1]
    v_pk_fma_f32 v[12:13], v[12:13], v[8:9], v[6:7] op_sel:[0,0,1] op_sel_hi:[1,0,1]
    v_pk_fma_f32 v[14:15], v[14:15], v[8:9], v[6:7] op_sel:[0,0,1] op_sel_hi:[1,0,1]
    v_pk_fma_f32 v[16:17], v[16:17], v[8:9], v[6:7] op_sel:[0,0,1] op_sel_hi:[1,0,1]
    v_pk_mul_f32 v[10:11], v[112:113], v[10:11]
    v_pk_mul_f32 v[12:13], v[114:115], v[12:13]
    v_pk_mul_f32 v[14:15], v[116:117], v[14:15]
    v_pk_mul_f32 v[16:17], v[118:119], v[16:17]
    v_exp_f32 v10, v10
    v_exp_f32 v11, v11
    v_exp_f32 v12, v12
    v_exp_f32 v13, v13
    v_exp_f32 v14, v14
    v_exp_f32 v15, v15
    v_exp_f32 v16, v16
    v_exp_f32 v17, v17
    v_pk_mul_f32 v[120:121], v[112:113], v[120:121]
    v_pk_mul_f32 v[122:123], v[114:115], v[122:123]
    v_pk_mul_f32 v[124:125], v[116:117], v[124:125]
    v_pk_mul_f32 v[126:127], v[118:119], v[126:127]
    v_pk_fma_f32 v[10:11], v[10:11], v[8:9], v[8:9] op_sel:[0,1,1] op_sel_hi:[1,1,1]
    v_pk_fma_f32 v[12:13], v[12:13], v[8:9], v[8:9] op_sel:[0,1,1] op_sel_hi:[1,1,1]
    v_pk_fma_f32 v[14:15], v[14:15], v[8:9], v[8:9] op_sel:[0,1,1] op_sel_hi:[1,1,1]
    v_pk_fma_f32 v[16:17], v[16:17], v[8:9], v[8:9] op_sel:[0,1,1] op_sel_hi:[1,1,1]
    v_rcp_f32 v10, v10
    v_rcp_f32 v11, v11
    v_rcp_f32 v12, v12
    v_rcp_f32 v13, v13
    v_rcp_f32 v14, v14
    v_rcp_f32 v15, v15
    v_rcp_f32 v16, v16
    v_rcp_f32 v17, v17
    s_nop 0
    v_pk_mul_f32 v[120:121], v[120:121], v[10:11]
    v_pk_mul_f32 v[122:123], v[122:123], v[12:13]
    v_pk_mul_f32 v[124:125], v[124:125], v[14:15]
    v_pk_mul_f32 v[126:127], v[126:127], v[16:17]
    v_cvt_pk_bf16_f32 v112, v120, v121
    v_cvt_pk_bf16_f32 v113, v122, v123
    v_cvt_pk_bf16_f32 v114, v124, v125
    v_cvt_pk_bf16_f32 v115, v126, v127
    s_add_u32 s29, s20, 299008
    buffer_store_dwordx4 v[112:115], v2, s[8:11], s29 offen sc1
    v_add_u32 v52, 0, v1
    v_add_u32 v53, 36864, v1
    v_add_u32 v54, 73728, v1
    v_add_u32 v55, 110592, v1
    s_lshl_b32 s20, s33, 2
    s_add_u32 s20, s20, s34
    s_lshl_b32 s21, s20, 4
    s_add_u32 s21, s21, s35
    s_lshl_b32 s21, s21, 2
    s_add_u32 s21, s21, s12
    s_mul_i32 s21, s21, 3072
    s_add_u32 s21, s21, 0x3000000
    s_lshl_b32 s22, s35, 1
    v_lshlrev_b32 v56, 3, v0
    s_barrier
    ds_read_b128 v[20:23], v53 offset:0
    ds_read_b128 v[24:27], v53 offset:1024
    ds_read_b128 v[28:31], v53 offset:2048
    ds_read_b128 v[32:35], v53 offset:3072
    ds_read_b128 v[36:39], v53 offset:4096
    ds_read_b128 v[40:43], v53 offset:5120
    ds_read_b128 v[44:47], v53 offset:6144
    s_waitcnt lgkmcnt(6)
    s_waitcnt vmcnt(10)
    v_mfma_f32_16x16x32_bf16 v[64:67], v[20:23], v[192:195], 0
    ds_read_b128 v[48:51], v53 offset:7168
    s_add_u32 s28, s37, 11264
    buffer_load_dwordx4 a[32:35], v1, s[8:11], s28 offen sc1
    v_mfma_f32_16x16x32_bf16 v[68:71], v[20:23], v[208:211], 0
    s_waitcnt lgkmcnt(6)
    v_mfma_f32_16x16x32_bf16 v[72:75], v[24:27], v[192:195], 0
    ds_read_b128 v[20:23], v53 offset:8192
    v_mfma_f32_16x16x32_bf16 v[76:79], v[24:27], v[208:211], 0
    s_waitcnt lgkmcnt(6)
    v_mfma_f32_16x16x32_bf16 v[80:83], v[28:31], v[192:195], 0
    ds_read_b128 v[24:27], v53 offset:9216
    s_add_u32 s28, s37, 14336
    buffer_load_dwordx4 a[36:39], v1, s[8:11], s28 offen sc1
    v_mfma_f32_16x16x32_bf16 v[84:87], v[28:31], v[208:211], 0
    s_waitcnt lgkmcnt(6)
    v_mfma_f32_16x16x32_bf16 v[88:91], v[32:35], v[192:195], 0
    ds_read_b128 v[28:31], v53 offset:10240
    v_mfma_f32_16x16x32_bf16 v[92:95], v[32:35], v[208:211], 0
    s_waitcnt lgkmcnt(6)
    v_mfma_f32_16x16x32_bf16 v[96:99], v[36:39], v[192:195], 0
    ds_read_b128 v[32:35], v53 offset:11264
    s_add_u32 s28, s37, 15360
    buffer_load_dwordx4 a[40:43], v1, s[8:11], s28 offen sc1
    v_mfma_f32_16x16x32_bf16 v[100:103], v[36:39], v[208:211], 0
    s_waitcnt lgkmcnt(6)
    v_mfma_f32_16x16x32_bf16 v[104:107], v[40:43], v[192:195], 0
    ds_read_b128 v[36:39], v53 offset:12288
    v_mfma_f32_16x16x32_bf16 v[108:111], v[40:43], v[208:211], 0
    s_waitcnt lgkmcnt(6)
    v_mfma_f32_16x16x32_bf16 v[112:115], v[44:47], v[192:195], 0
    ds_read_b128 v[40:43], v53 offset:13312
    s_add_u32 s28, s37, 16384
    buffer_load_dwordx4 a[44:47], v1, s[8:11], s28 offen sc1
    v_mfma_f32_16x16x32_bf16 v[116:119], v[44:47], v[208:211], 0
    s_waitcnt lgkmcnt(6)
    v_mfma_f32_16x16x32_bf16 v[64:67], v[48:51], v[196:199], v[64:67]
    ds_read_b128 v[44:47], v53 offset:14336
    v_mfma_f32_16x16x32_bf16 v[68:71], v[48:51], v[212:215], v[68:71]
    s_waitcnt lgkmcnt(6)
    v_mfma_f32_16x16x32_bf16 v[72:75], v[20:23], v[196:199], v[72:75]
    ds_read_b128 v[48:51], v53 offset:15360
    s_add_u32 s28, s37, 158720
    buffer_load_dwordx4 a[176:179], v1, s[8:11], s28 offen sc1
    v_mfma_f32_16x16x32_bf16 v[76:79], v[20:23], v[212:215], v[76:79]
    s_waitcnt lgkmcnt(6)
    v_mfma_f32_16x16x32_bf16 v[80:83], v[24:27], v[196:199], v[80:83]
    ds_read_b128 v[20:23], v53 offset:16384
    v_mfma_f32_16x16x32_bf16 v[84:87], v[24:27], v[212:215], v[84:87]
    s_waitcnt lgkmcnt(6)
    v_mfma_f32_16x16x32_bf16 v[88:91], v[28:31], v[196:199], v[88:91]
    ds_read_b128 v[24:27], v53 offset:17408
    s_add_u32 s28, s37, 161792
    buffer_load_dwordx4 a[180:183], v1, s[8:11], s28 offen sc1
    v_mfma_f32_16x16x32_bf16 v[92:95], v[28:31], v[212:215], v[92:95]
    s_waitcnt lgkmcnt(6)
    v_mfma_f32_16x16x32_bf16 v[96:99], v[32:35], v[196:199], v[96:99]
    ds_read_b128 v[28:31], v53 offset:18432
    v_mfma_f32_16x16x32_bf16 v[100:103], v[32:35], v[212:215], v[100:103]
    s_waitcnt lgkmcnt(6)
    v_mfma_f32_16x16x32_bf16 v[104:107], v[36:39], v[196:199], v[104:107]
    ds_read_b128 v[32:35], v53 offset:19456
    s_add_u32 s28, s37, 162816
    buffer_load_dwordx4 a[184:187], v1, s[8:11], s28 offen sc1
    v_mfma_f32_16x16x32_bf16 v[108:111], v[36:39], v[212:215], v[108:111]
    s_waitcnt lgkmcnt(6)
    v_mfma_f32_16x16x32_bf16 v[112:115], v[40:43], v[196:199], v[112:115]
    ds_read_b128 v[36:39], v53 offset:20480
    v_mfma_f32_16x16x32_bf16 v[116:119], v[40:43], v[212:215], v[116:119]
    s_waitcnt lgkmcnt(6)
    v_mfma_f32_16x16x32_bf16 v[64:67], v[44:47], v[200:203], v[64:67]
    ds_read_b128 v[40:43], v53 offset:21504
    s_add_u32 s28, s37, 163840
    buffer_load_dwordx4 a[188:191], v1, s[8:11], s28 offen sc1
    v_mfma_f32_16x16x32_bf16 v[68:71], v[44:47], v[216:219], v[68:71]
    s_waitcnt lgkmcnt(6)
    v_mfma_f32_16x16x32_bf16 v[72:75], v[48:51], v[200:203], v[72:75]
    ds_read_b128 v[44:47], v53 offset:22528
    v_mfma_f32_16x16x32_bf16 v[76:79], v[48:51], v[216:219], v[76:79]
    s_waitcnt lgkmcnt(6)
    v_mfma_f32_16x16x32_bf16 v[80:83], v[20:23], v[200:203], v[80:83]
    ds_read_b128 v[48:51], v53 offset:23552
    s_add_u32 s28, s37, 18432
    buffer_load_dwordx4 a[48:51], v1, s[8:11], s28 offen sc1
    v_mfma_f32_16x16x32_bf16 v[84:87], v[20:23], v[216:219], v[84:87]
    s_waitcnt lgkmcnt(6)
    v_mfma_f32_16x16x32_bf16 v[88:91], v[24:27], v[200:203], v[88:91]
    ds_read_b128 v[20:23], v53 offset:24576
    v_mfma_f32_16x16x32_bf16 v[92:95], v[24:27], v[216:219], v[92:95]
    s_waitcnt lgkmcnt(6)
    v_mfma_f32_16x16x32_bf16 v[96:99], v[28:31], v[200:203], v[96:99]
    ds_read_b128 v[24:27], v53 offset:25600
    s_add_u32 s28, s37, 19456
    buffer_load_dwordx4 a[52:55], v1, s[8:11], s28 offen sc1
    v_mfma_f32_16x16x32_bf16 v[100:103], v[28:31], v[216:219], v[100:103]
    s_waitcnt lgkmcnt(6)
    v_mfma_f32_16x16x32_bf16 v[104:107], v[32:35], v[200:203], v[104:107]
    ds_read_b128 v[28:31], v53 offset:26624
    v_mfma_f32_16x16x32_bf16 v[108:111], v[32:35], v[216:219], v[108:111]
    s_waitcnt lgkmcnt(6)
    v_mfma_f32_16x16x32_bf16 v[112:115], v[36:39], v[200:203], v[112:115]
    ds_read_b128 v[32:35], v53 offset:27648
    s_add_u32 s28, s37, 20480
    buffer_load_dwordx4 a[56:59], v1, s[8:11], s28 offen sc1
    v_mfma_f32_16x16x32_bf16 v[116:119], v[36:39], v[216:219], v[116:119]
    s_waitcnt lgkmcnt(6)
    v_mfma_f32_16x16x32_bf16 v[64:67], v[40:43], v[204:207], v[64:67]
    ds_read_b128 v[36:39], v53 offset:28672
    v_mfma_f32_16x16x32_bf16 v[68:71], v[40:43], v[220:223], v[68:71]
    s_waitcnt lgkmcnt(6)
    v_mfma_f32_16x16x32_bf16 v[72:75], v[44:47], v[204:207], v[72:75]
    ds_read_b128 v[40:43], v53 offset:29696
    s_add_u32 s28, s37, 23552
    buffer_load_dwordx4 a[60:63], v1, s[8:11], s28 offen sc1
    v_mfma_f32_16x16x32_bf16 v[76:79], v[44:47], v[220:223], v[76:79]
    s_waitcnt lgkmcnt(6)
    v_mfma_f32_16x16x32_bf16 v[80:83], v[48:51], v[204:207], v[80:83]
    ds_read_b128 v[44:47], v53 offset:30720
    v_mfma_f32_16x16x32_bf16 v[84:87], v[48:51], v[220:223], v[84:87]
    s_waitcnt lgkmcnt(6)
    v_mfma_f32_16x16x32_bf16 v[88:91], v[20:23], v[204:207], v[88:91]
    ds_read_b128 v[48:51], v53 offset:31744
    s_add_u32 s28, s37, 165888
    buffer_load_dwordx4 a[192:195], v1, s[8:11], s28 offen sc1
    v_mfma_f32_16x16x32_bf16 v[92:95], v[20:23], v[220:223], v[92:95]
    s_waitcnt lgkmcnt(6)
    v_mfma_f32_16x16x32_bf16 v[96:99], v[24:27], v[204:207], v[96:99]
    ds_read_b128 v[20:23], v53 offset:32768
    v_mfma_f32_16x16x32_bf16 v[100:103], v[24:27], v[220:223], v[100:103]
    s_waitcnt lgkmcnt(6)
    v_mfma_f32_16x16x32_bf16 v[104:107], v[28:31], v[204:207], v[104:107]
    ds_read_b128 v[24:27], v53 offset:33792
    s_add_u32 s28, s37, 166912
    buffer_load_dwordx4 a[196:199], v1, s[8:11], s28 offen sc1
    v_mfma_f32_16x16x32_bf16 v[108:111], v[28:31], v[220:223], v[108:111]
    s_waitcnt lgkmcnt(6)
    v_mfma_f32_16x16x32_bf16 v[112:115], v[32:35], v[204:207], v[112:115]
    ds_read_b128 v[28:31], v53 offset:34816
    v_mfma_f32_16x16x32_bf16 v[116:119], v[32:35], v[220:223], v[116:119]
    s_waitcnt lgkmcnt(6)
    s_waitcnt vmcnt(16)
    v_mfma_f32_16x16x32_bf16 v[64:67], v[36:39], v[160:163], v[64:67]
    ds_read_b128 v[32:35], v53 offset:35840
    s_add_u32 s28, s37, 167936
    buffer_load_dwordx4 a[200:203], v1, s[8:11], s28 offen sc1
    v_mfma_f32_16x16x32_bf16 v[68:71], v[36:39], v[176:179], v[68:71]
    s_waitcnt lgkmcnt(6)
    v_mfma_f32_16x16x32_bf16 v[72:75], v[40:43], v[160:163], v[72:75]
    v_mfma_f32_16x16x32_bf16 v[76:79], v[40:43], v[176:179], v[76:79]
    s_waitcnt lgkmcnt(5)
    v_mfma_f32_16x16x32_bf16 v[80:83], v[44:47], v[160:163], v[80:83]
    s_add_u32 s28, s37, 171008
    buffer_load_dwordx4 a[204:207], v1, s[8:11], s28 offen sc1
    v_mfma_f32_16x16x32_bf16 v[84:87], v[44:47], v[176:179], v[84:87]
    s_waitcnt lgkmcnt(0)
    s_waitcnt vmcnt(16)
    s_barrier
    s_cmp_lg_u32 s12, 0
    s_cbranch_scc1 L_l15
    v_mov_b32 v16, 0
    v_mov_b32 v17, 1
    s_mov_b64 exec, 1
    buffer_store_dword v17, v16, s[8:11], s31 offen sc1
    s_mov_b64 exec, -1
L_l15:
    ds_read_b128 v[36:39], v54 offset:0
    v_mfma_f32_16x16x32_bf16 v[88:91], v[48:51], v[160:163], v[88:91]
    ds_read_b128 v[40:43], v54 offset:1024
    v_mfma_f32_16x16x32_bf16 v[92:95], v[48:51], v[176:179], v[92:95]
    ds_read_b128 v[44:47], v54 offset:2048
    v_mfma_f32_16x16x32_bf16 v[96:99], v[20:23], v[160:163], v[96:99]
    ds_read_b128 v[48:51], v54 offset:3072
    s_add_u32 m0, s24, 0
    s_add_u32 s27, s36, 110592
    buffer_load_dwordx4 v1, s[8:11], s27 offen offset:0  lds
    v_mfma_f32_16x16x32_bf16 v[100:103], v[20:23], v[176:179], v[100:103]
    v_mfma_f32_16x16x32_bf16 v[104:107], v[24:27], v[160:163], v[104:107]
    ds_read_b128 v[20:23], v54 offset:4096
    v_mfma_f32_16x16x32_bf16 v[108:111], v[24:27], v[176:179], v[108:111]
    v_mfma_f32_16x16x32_bf16 v[112:115], v[28:31], v[160:163], v[112:115]
    ds_read_b128 v[24:27], v54 offset:5120
    buffer_load_dwordx4 v1, s[8:11], s27 offen offset:1024  lds
    v_mfma_f32_16x16x32_bf16 v[116:119], v[28:31], v[176:179], v[116:119]
    v_mfma_f32_16x16x32_bf16 v[64:67], v[32:35], v[164:167], v[64:67]
    ds_read_b128 v[28:31], v54 offset:6144
    v_mfma_f32_16x16x32_bf16 v[68:71], v[32:35], v[180:183], v[68:71]
    s_waitcnt lgkmcnt(6)
    v_mfma_f32_16x16x32_bf16 v[72:75], v[36:39], v[164:167], v[72:75]
    ds_read_b128 v[32:35], v54 offset:7168
    buffer_load_dwordx4 v1, s[8:11], s27 offen offset:2048  lds
    v_mfma_f32_16x16x32_bf16 v[76:79], v[36:39], v[180:183], v[76:79]
    s_waitcnt lgkmcnt(6)
    v_mfma_f32_16x16x32_bf16 v[80:83], v[40:43], v[164:167], v[80:83]
    ds_read_b128 v[36:39], v54 offset:8192
    v_mfma_f32_16x16x32_bf16 v[84:87], v[40:43], v[180:183], v[84:87]
    s_waitcnt lgkmcnt(6)
    v_mfma_f32_16x16x32_bf16 v[88:91], v[44:47], v[164:167], v[88:91]
    ds_read_b128 v[40:43], v54 offset:9216
    buffer_load_dwordx4 v1, s[8:11], s27 offen offset:3072  lds
    v_mfma_f32_16x16x32_bf16 v[92:95], v[44:47], v[180:183], v[92:95]
    s_waitcnt lgkmcnt(6)
    v_mfma_f32_16x16x32_bf16 v[96:99], v[48:51], v[164:167], v[96:99]
    ds_read_b128 v[44:47], v54 offset:10240
    v_mfma_f32_16x16x32_bf16 v[100:103], v[48:51], v[180:183], v[100:103]
    s_waitcnt lgkmcnt(6)
    v_mfma_f32_16x16x32_bf16 v[104:107], v[20:23], v[164:167], v[104:107]
    ds_read_b128 v[48:51], v54 offset:11264
    s_add_u32 m0, s24, 4096
    s_add_u32 s27, s36, 114688
    buffer_load_dwordx4 v1, s[8:11], s27 offen offset:0  lds
    v_mfma_f32_16x16x32_bf16 v[108:111], v[20:23], v[180:183], v[108:111]
    s_waitcnt lgkmcnt(6)
    v_mfma_f32_16x16x32_bf16 v[112:115], v[24:27], v[164:167], v[112:115]
    ds_read_b128 v[20:23], v54 offset:12288
    v_mfma_f32_16x16x32_bf16 v[116:119], v[24:27], v[180:183], v[116:119]
    s_waitcnt lgkmcnt(6)
    v_mfma_f32_16x16x32_bf16 v[64:67], v[28:31], v[168:171], v[64:67]
    ds_read_b128 v[24:27], v54 offset:13312
    buffer_load_dwordx4 v1, s[8:11], s27 offen offset:1024  lds
    v_mfma_f32_16x16x32_bf16 v[68:71], v[28:31], v[184:187], v[68:71]
    s_waitcnt lgkmcnt(6)
    v_mfma_f32_16x16x32_bf16 v[72:75], v[32:35], v[168:171], v[72:75]
    ds_read_b128 v[28:31], v54 offset:14336
    v_mfma_f32_16x16x32_bf16 v[76:79], v[32:35], v[184:187], v[76:79]
    s_waitcnt lgkmcnt(6)
    v_mfma_f32_16x16x32_bf16 v[80:83], v[36:39], v[168:171], v[80:83]
    ds_read_b128 v[32:35], v54 offset:15360
    buffer_load_dwordx4 v1, s[8:11], s27 offen offset:2048  lds
    v_mfma_f32_16x16x32_bf16 v[84:87], v[36:39], v[184:187], v[84:87]
    s_waitcnt lgkmcnt(6)
    v_mfma_f32_16x16x32_bf16 v[88:91], v[40:43], v[168:171], v[88:91]
    ds_read_b128 v[36:39], v54 offset:16384
    v_mfma_f32_16x16x32_bf16 v[92:95], v[40:43], v[184:187], v[92:95]
    s_waitcnt lgkmcnt(6)
    v_mfma_f32_16x16x32_bf16 v[96:99], v[44:47], v[168:171], v[96:99]
    ds_read_b128 v[40:43], v54 offset:17408
    buffer_load_dwordx4 v1, s[8:11], s27 offen offset:3072  lds
    v_mfma_f32_16x16x32_bf16 v[100:103], v[44:47], v[184:187], v[100:103]
    s_waitcnt lgkmcnt(6)
    v_mfma_f32_16x16x32_bf16 v[104:107], v[48:51], v[168:171], v[104:107]
    ds_read_b128 v[44:47], v54 offset:18432
    v_mfma_f32_16x16x32_bf16 v[108:111], v[48:51], v[184:187], v[108:111]
    s_waitcnt lgkmcnt(6)
    v_mfma_f32_16x16x32_bf16 v[112:115], v[20:23], v[168:171], v[112:115]
    ds_read_b128 v[48:51], v54 offset:19456
    s_add_u32 m0, s24, 8192
    s_add_u32 s27, s36, 118784
    buffer_load_dwordx4 v1, s[8:11], s27 offen offset:0  lds
    v_mfma_f32_16x16x32_bf16 v[116:119], v[20:23], v[184:187], v[116:119]
    s_waitcnt lgkmcnt(6)
    v_mfma_f32_16x16x32_bf16 v[64:67], v[24:27], v[172:175], v[64:67]
    ds_read_b128 v[20:23], v54 offset:20480
    v_mfma_f32_16x16x32_bf16 v[68:71], v[24:27], v[188:191], v[68:71]
    s_waitcnt lgkmcnt(6)
    v_mfma_f32_16x16x32_bf16 v[72:75], v[28:31], v[172:175], v[72:75]
    ds_read_b128 v[24:27], v54 offset:21504
    s_add_u32 s28, s37, 24576
    buffer_load_dwordx4 a[64:67], v1, s[8:11], s28 offen sc1
    v_mfma_f32_16x16x32_bf16 v[76:79], v[28:31], v[188:191], v[76:79]
    s_waitcnt lgkmcnt(6)
    v_mfma_f32_16x16x32_bf16 v[80:83], v[32:35], v[172:175], v[80:83]
    ds_read_b128 v[28:31], v54 offset:22528
    v_mfma_f32_16x16x32_bf16 v[84:87], v[32:35], v[188:191], v[84:87]
    s_waitcnt lgkmcnt(6)
    v_mfma_f32_16x16x32_bf16 v[88:91], v[36:39], v[172:175], v[88:91]
    ds_read_b128 v[32:35], v54 offset:23552
    s_add_u32 s28, s37, 25600
    buffer_load_dwordx4 a[68:71], v1, s[8:11], s28 offen sc1
    v_mfma_f32_16x16x32_bf16 v[92:95], v[36:39], v[188:191], v[92:95]
    s_waitcnt lgkmcnt(6)
    v_mfma_f32_16x16x32_bf16 v[96:99], v[40:43], v[172:175], v[96:99]
    ds_read_b128 v[36:39], v54 offset:24576
    v_mfma_f32_16x16x32_bf16 v[100:103], v[40:43], v[188:191], v[100:103]
    s_waitcnt lgkmcnt(6)
    v_mfma_f32_16x16x32_bf16 v[104:107], v[44:47], v[172:175], v[104:107]
    ds_read_b128 v[40:43], v54 offset:25600
    s_add_u32 s28, s37, 27648
    buffer_load_dwordx4 a[72:75], v1, s[8:11], s28 offen sc1
    v_mfma_f32_16x16x32_bf16 v[108:111], v[44:47], v[188:191], v[108:111]
    s_waitcnt lgkmcnt(6)
    v_mfma_f32_16x16x32_bf16 v[112:115], v[48:51], v[172:175], v[112:115]
    ds_read_b128 v[44:47], v54 offset:26624
    v_mfma_f32_16x16x32_bf16 v[116:119], v[48:51], v[188:191], v[116:119]
    s_waitcnt lgkmcnt(6)
    s_waitcnt vmcnt(20)
    v_mfma_f32_16x16x32_bf16 v[64:67], v[20:23], a[32:35], v[64:67]
    ds_read_b128 v[48:51], v54 offset:27648
    s_add_u32 s28, s37, 28672
    buffer_load_dwordx4 a[76:79], v1, s[8:11], s28 offen sc1
    v_mfma_f32_16x16x32_bf16 v[68:71], v[20:23], a[176:179], v[68:71]
    s_waitcnt lgkmcnt(6)
    v_mfma_f32_16x16x32_bf16 v[72:75], v[24:27], a[32:35], v[72:75]
    ds_read_b128 v[20:23], v54 offset:28672
    v_mfma_f32_16x16x32_bf16 v[76:79], v[24:27], a[176:179], v[76:79]
    s_waitcnt lgkmcnt(6)
    v_mfma_f32_16x16x32_bf16 v[80:83], v[28:31], a[32:35], v[80:83]
    ds_read_b128 v[24:27], v54 offset:29696
    s_add_u32 s28, s37, 172032
    buffer_load_dwordx4 a[208:211], v1, s[8:11], s28 offen sc1
    v_mfma_f32_16x16x32_bf16 v[84:87], v[28:31], a[176:179], v[84:87]
    s_waitcnt lgkmcnt(6)
    v_mfma_f32_16x16x32_bf16 v[88:91], v[32:35], a[32:35], v[88:91]
    ds_read_b128 v[28:31], v54 offset:30720
    v_mfma_f32_16x16x32_bf16 v[92:95], v[32:35], a[176:179], v[92:95]
    s_waitcnt lgkmcnt(6)
    v_mfma_f32_16x16x32_bf16 v[96:99], v[36:39], a[32:35], v[96:99]
    ds_read_b128 v[32:35], v54 offset:31744
    s_add_u32 s28, s37, 173056
    buffer_load_dwordx4 a[212:215], v1, s[8:11], s28 offen sc1
    v_mfma_f32_16x16x32_bf16 v[100:103], v[36:39], a[176:179], v[100:103]
    s_waitcnt lgkmcnt(6)
    v_mfma_f32_16x16x32_bf16 v[104:107], v[40:43], a[32:35], v[104:107]
    ds_read_b128 v[36:39], v54 offset:32768
    v_mfma_f32_16x16x32_bf16 v[108:111], v[40:43], a[176:179], v[108:111]
    s_waitcnt lgkmcnt(6)
    v_mfma_f32_16x16x32_bf16 v[112:115], v[44:47], a[32:35], v[112:115]
    ds_read_b128 v[40:43], v54 offset:33792
    s_add_u32 s28, s37, 175104
    buffer_load_dwordx4 a[216:219], v1, s[8:11], s28 offen sc1
    v_mfma_f32_16x16x32_bf16 v[116:119], v[44:47], a[176:179], v[116:119]
    s_waitcnt lgkmcnt(6)
    v_mfma_f32_16x16x32_bf16 v[64:67], v[48:51], a[36:39], v[64:67]
    ds_read_b128 v[44:47], v54 offset:34816
    v_mfma_f32_16x16x32_bf16 v[68:71], v[48:51], a[180:183], v[68:71]
    s_waitcnt lgkmcnt(6)
    v_mfma_f32_16x16x32_bf16 v[72:75], v[20:23], a[36:39], v[72:75]
    ds_read_b128 v[48:51], v54 offset:35840
    s_add_u32 s28, s37, 176128
    buffer_load_dwordx4 a[220:223], v1, s[8:11], s28 offen sc1
    v_mfma_f32_16x16x32_bf16 v[76:79], v[20:23], a[180:183], v[76:79]
    s_waitcnt lgkmcnt(6)
    v_mfma_f32_16x16x32_bf16 v[80:83], v[24:27], a[36:39], v[80:83]
    v_mfma_f32_16x16x32_bf16 v[84:87], v[24:27], a[180:183], v[84:87]
    s_waitcnt lgkmcnt(5)
    v_mfma_f32_16x16x32_bf16 v[88:91], v[28:31], a[36:39], v[88:91]
    s_add_u32 s28, s37, 29696
    buffer_load_dwordx4 a[80:83], v1, s[8:11], s28 offen sc1
    v_mfma_f32_16x16x32_bf16 v[92:95], v[28:31], a[180:183], v[92:95]
    s_waitcnt lgkmcnt(0)
    s_barrier
    ds_read_b128 v[20:23], v55 offset:0
    v_mfma_f32_16x16x32_bf16 v[96:99], v[32:35], a[36:39], v[96:99]
    ds_read_b128 v[24:27], v55 offset:1024
    v_mfma_f32_16x16x32_bf16 v[100:103], v[32:35], a[180:183], v[100:103]
    ds_read_b128 v[28:31], v55 offset:2048
    v_mfma_f32_16x16x32_bf16 v[104:107], v[36:39], a[36:39], v[104:107]
    ds_read_b128 v[32:35], v55 offset:3072
    s_add_u32 s28, s37, 32768
    buffer_load_dwordx4 a[84:87], v1, s[8:11], s28 offen sc1
    v_mfma_f32_16x16x32_bf16 v[108:111], v[36:39], a[180:183], v[108:111]
    v_mfma_f32_16x16x32_bf16 v[112:115], v[40:43], a[36:39], v[112:115]
    ds_read_b128 v[36:39], v55 offset:4096
    v_mfma_f32_16x16x32_bf16 v[116:119], v[40:43], a[180:183], v[116:119]
    v_mfma_f32_16x16x32_bf16 v[64:67], v[44:47], a[40:43], v[64:67]
    ds_read_b128 v[40:43], v55 offset:5120
    s_add_u32 s28, s37, 33792
    buffer_load_dwordx4 a[88:91], v1, s[8:11], s28 offen sc1
    v_mfma_f32_16x16x32_bf16 v[68:71], v[44:47], a[184:187], v[68:71]
    v_mfma_f32_16x16x32_bf16 v[72:75], v[48:51], a[40:43], v[72:75]
    ds_read_b128 v[44:47], v55 offset:6144
    v_mfma_f32_16x16x32_bf16 v[76:79], v[48:51], a[184:187], v[76:79]
    s_waitcnt lgkmcnt(6)
    v_mfma_f32_16x16x32_bf16 v[80:83], v[20:23], a[40:43], v[80:83]
    ds_read_b128 v[48:51], v55 offset:7168
    s_add_u32 s28, s37, 34816
    buffer_load_dwordx4 a[92:95], v1, s[8:11], s28 offen sc1
    v_mfma_f32_16x16x32_bf16 v[84:87], v[20:23], a[184:187], v[84:87]
    s_waitcnt lgkmcnt(6)
    v_mfma_f32_16x16x32_bf16 v[88:91], v[24:27], a[40:43], v[88:91]
    ds_read_b128 v[20:23], v55 offset:8192
    v_mfma_f32_16x16x32_bf16 v[92:95], v[24:27], a[184:187], v[92:95]
    s_waitcnt lgkmcnt(6)
    v_mfma_f32_16x16x32_bf16 v[96:99], v[28:31], a[40:43], v[96:99]
    ds_read_b128 v[24:27], v55 offset:9216
    s_add_u32 s28, s37, 177152
    buffer_load_dwordx4 a[224:227], v1, s[8:11], s28 offen sc1
    v_mfma_f32_16x16x32_bf16 v[100:103], v[28:31], a[184:187], v[100:103]
    s_waitcnt lgkmcnt(6)
    v_mfma_f32_16x16x32_bf16 v[104:107], v[32:35], a[40:43], v[104:107]
    ds_read_b128 v[28:31], v55 offset:10240
    v_mfma_f32_16x16x32_bf16 v[108:111], v[32:35], a[184:187], v[108:111]
    s_waitcnt lgkmcnt(6)
    v_mfma_f32_16x16x32_bf16 v[112:115], v[36:39], a[40:43], v[112:115]
    ds_read_b128 v[32:35], v55 offset:11264
    s_add_u32 s28, s37, 180224
    buffer_load_dwordx4 a[228:231], v1, s[8:11], s28 offen sc1
    v_mfma_f32_16x16x32_bf16 v[116:119], v[36:39], a[184:187], v[116:119]
    s_waitcnt lgkmcnt(6)
    v_mfma_f32_16x16x32_bf16 v[64:67], v[40:43], a[44:47], v[64:67]
    ds_read_b128 v[36:39], v55 offset:12288
    v_mfma_f32_16x16x32_bf16 v[68:71], v[40:43], a[188:191], v[68:71]
    s_waitcnt lgkmcnt(6)
    v_mfma_f32_16x16x32_bf16 v[72:75], v[44:47], a[44:47], v[72:75]
    ds_read_b128 v[40:43], v55 offset:13312
    s_add_u32 s28, s37, 181248
    buffer_load_dwordx4 a[232:235], v1, s[8:11], s28 offen sc1
    v_mfma_f32_16x16x32_bf16 v[76:79], v[44:47], a[188:191], v[76:79]
    s_waitcnt lgkmcnt(6)
    v_mfma_f32_16x16x32_bf16 v[80:83], v[48:51], a[44:47], v[80:83]
    ds_read_b128 v[44:47], v55 offset:14336
    v_mfma_f32_16x16x32_bf16 v[84:87], v[48:51], a[188:191], v[84:87]
    s_waitcnt lgkmcnt(6)
    v_mfma_f32_16x16x32_bf16 v[88:91], v[20:23], a[44:47], v[88:91]
    ds_read_b128 v[48:51], v55 offset:15360
    s_add_u32 s28, s37, 182272
    buffer_load_dwordx4 a[236:239], v1, s[8:11], s28 offen sc1
    v_mfma_f32_16x16x32_bf16 v[92:95], v[20:23], a[188:191], v[92:95]
    s_waitcnt lgkmcnt(6)
    v_mfma_f32_16x16x32_bf16 v[96:99], v[24:27], a[44:47], v[96:99]
    ds_read_b128 v[20:23], v55 offset:16384
    v_mfma_f32_16x16x32_bf16 v[100:103], v[24:27], a[188:191], v[100:103]
    s_waitcnt lgkmcnt(6)
    v_mfma_f32_16x16x32_bf16 v[104:107], v[28:31], a[44:47], v[104:107]
    ds_read_b128 v[24:27], v55 offset:17408
    s_add_u32 m0, s24, 36864
    s_add_u32 s27, s36, 147456
    buffer_load_dwordx4 v1, s[8:11], s27 offen offset:0  lds
    v_mfma_f32_16x16x32_bf16 v[108:111], v[28:31], a[188:191], v[108:111]
    s_waitcnt lgkmcnt(6)
    v_mfma_f32_16x16x32_bf16 v[112:115], v[32:35], a[44:47], v[112:115]
    ds_read_b128 v[28:31], v55 offset:18432
    v_mfma_f32_16x16x32_bf16 v[116:119], v[32:35], a[188:191], v[116:119]
    s_waitcnt lgkmcnt(6)
    s_waitcnt vmcnt(26)
    v_mfma_f32_16x16x32_bf16 v[64:67], v[36:39], a[48:51], v[64:67]
    ds_read_b128 v[32:35], v55 offset:19456
    buffer_load_dwordx4 v1, s[8:11], s27 offen offset:1024  lds
    v_mfma_f32_16x16x32_bf16 v[68:71], v[36:39], a[192:195], v[68:71]
    s_waitcnt lgkmcnt(6)
    v_mfma_f32_16x16x32_bf16 v[72:75], v[40:43], a[48:51], v[72:75]
    ds_read_b128 v[36:39], v55 offset:20480
    v_mfma_f32_16x16x32_bf16 v[76:79], v[40:43], a[192:195], v[76:79]
    s_waitcnt lgkmcnt(6)
    v_mfma_f32_16x16x32_bf16 v[80:83], v[44:47], a[48:51], v[80:83]
    ds_read_b128 v[40:43], v55 offset:21504
    buffer_load_dwordx4 v1, s[8:11], s27 offen offset:2048  lds
    v_mfma_f32_16x16x32_bf16 v[84:87], v[44:47], a[192:195], v[84:87]
    s_waitcnt lgkmcnt(6)
    v_mfma_f32_16x16x32_bf16 v[88:91], v[48:51], a[48:51], v[88:91]
    ds_read_b128 v[44:47], v55 offset:22528
    v_mfma_f32_16x16x32_bf16 v[92:95], v[48:51], a[192:195], v[92:95]
    s_waitcnt lgkmcnt(6)
    v_mfma_f32_16x16x32_bf16 v[96:99], v[20:23], a[48:51], v[96:99]
    ds_read_b128 v[48:51], v55 offset:23552
    buffer_load_dwordx4 v1, s[8:11], s27 offen offset:3072  lds
    v_mfma_f32_16x16x32_bf16 v[100:103], v[20:23], a[192:195], v[100:103]
    s_waitcnt lgkmcnt(6)
    v_mfma_f32_16x16x32_bf16 v[104:107], v[24:27], a[48:51], v[104:107]
    ds_read_b128 v[20:23], v55 offset:24576
    v_mfma_f32_16x16x32_bf16 v[108:111], v[24:27], a[192:195], v[108:111]
    s_waitcnt lgkmcnt(6)
    v_mfma_f32_16x16x32_bf16 v[112:115], v[28:31], a[48:51], v[112:115]
    ds_read_b128 v[24:27], v55 offset:25600
    s_add_u32 m0, s24, 40960
    s_add_u32 s27, s36, 151552
    buffer_load_dwordx4 v1, s[8:11], s27 offen offset:0  lds
    v_mfma_f32_16x16x32_bf16 v[116:119], v[28:31], a[192:195], v[116:119]
    s_waitcnt lgkmcnt(6)
    v_mfma_f32_16x16x32_bf16 v[64:67], v[32:35], a[52:55], v[64:67]
    ds_read_b128 v[28:31], v55 offset:26624
    v_mfma_f32_16x16x32_bf16 v[68:71], v[32:35], a[196:199], v[68:71]
    s_waitcnt lgkmcnt(6)
    v_mfma_f32_16x16x32_bf16 v[72:75], v[36:39], a[52:55], v[72:75]
    ds_read_b128 v[32:35], v55 offset:27648
    buffer_load_dwordx4 v1, s[8:11], s27 offen offset:1024  lds
    v_mfma_f32_16x16x32_bf16 v[76:79], v[36:39], a[196:199], v[76:79]
    s_waitcnt lgkmcnt(6)
    v_mfma_f32_16x16x32_bf16 v[80:83], v[40:43], a[52:55], v[80:83]
    ds_read_b128 v[36:39], v55 offset:28672
    v_mfma_f32_16x16x32_bf16 v[84:87], v[40:43], a[196:199], v[84:87]
    s_waitcnt lgkmcnt(6)
    v_mfma_f32_16x16x32_bf16 v[88:91], v[44:47], a[52:55], v[88:91]
    ds_read_b128 v[40:43], v55 offset:29696
    buffer_load_dwordx4 v1, s[8:11], s27 offen offset:2048  lds
    v_mfma_f32_16x16x32_bf16 v[92:95], v[44:47], a[196:199], v[92:95]
    s_waitcnt lgkmcnt(6)
    v_mfma_f32_16x16x32_bf16 v[96:99], v[48:51], a[52:55], v[96:99]
    ds_read_b128 v[44:47], v55 offset:30720
    v_mfma_f32_16x16x32_bf16 v[100:103], v[48:51], a[196:199], v[100:103]
    s_waitcnt lgkmcnt(6)
    v_mfma_f32_16x16x32_bf16 v[104:107], v[20:23], a[52:55], v[104:107]
    ds_read_b128 v[48:51], v55 offset:31744
    buffer_load_dwordx4 v1, s[8:11], s27 offen offset:3072  lds
    v_mfma_f32_16x16x32_bf16 v[108:111], v[20:23], a[196:199], v[108:111]
    s_waitcnt lgkmcnt(6)
    v_mfma_f32_16x16x32_bf16 v[112:115], v[24:27], a[52:55], v[112:115]
    ds_read_b128 v[20:23], v55 offset:32768
    v_mfma_f32_16x16x32_bf16 v[116:119], v[24:27], a[196:199], v[116:119]
    s_waitcnt lgkmcnt(6)
    v_mfma_f32_16x16x32_bf16 v[64:67], v[28:31], a[56:59], v[64:67]
    ds_read_b128 v[24:27], v55 offset:33792
    s_add_u32 m0, s24, 45056
    s_add_u32 s27, s36, 155648
    buffer_load_dwordx4 v1, s[8:11], s27 offen offset:0  lds
    v_mfma_f32_16x16x32_bf16 v[68:71], v[28:31], a[200:203], v[68:71]
    s_waitcnt lgkmcnt(6)
    v_mfma_f32_16x16x32_bf16 v[72:75], v[32:35], a[56:59], v[72:75]
    ds_read_b128 v[28:31], v55 offset:34816
    v_mfma_f32_16x16x32_bf16 v[76:79], v[32:35], a[200:203], v[76:79]
    s_waitcnt lgkmcnt(6)
    v_mfma_f32_16x16x32_bf16 v[80:83], v[36:39], a[56:59], v[80:83]
    ds_read_b128 v[32:35], v55 offset:35840
    s_add_u32 m0, s24, 73728
    s_add_u32 s27, s36, 184320
    buffer_load_dwordx4 v1, s[8:11], s27 offen offset:0  lds
    v_mfma_f32_16x16x32_bf16 v[84:87], v[36:39], a[200:203], v[84:87]
    s_waitcnt lgkmcnt(6)
    v_mfma_f32_16x16x32_bf16 v[88:91], v[40:43], a[56:59], v[88:91]
    v_mfma_f32_16x16x32_bf16 v[92:95], v[40:43], a[200:203], v[92:95]
    s_waitcnt lgkmcnt(5)
    v_mfma_f32_16x16x32_bf16 v[96:99], v[44:47], a[56:59], v[96:99]
    buffer_load_dwordx4 v1, s[8:11], s27 offen offset:1024  lds
    v_mfma_f32_16x16x32_bf16 v[100:103], v[44:47], a[200:203], v[100:103]
    s_waitcnt lgkmcnt(0)
    s_waitcnt vmcnt(27)
    s_cmp_lg_u32 s12, 0
    s_cbranch_scc1 L_pd16
    s_mov_b32 s88, 0
L_pl16:
    buffer_load_dword v18, v3, s[8:11], 0 offen sc1
    s_add_u32 s88, s88, 1
    s_waitcnt vmcnt(0)
    v_cmp_ne_u32 vcc, 1, v18
    s_nop 1
    s_cbranch_vccz L_pd16
    s_sleep 1
    s_cmp_lt_u32 s88, 1048576
    s_cbranch_scc1 L_pl16
L_pd16:
    s_barrier
    ds_read_b128 v[36:39], v52 offset:0
    v_mfma_f32_16x16x32_bf16 v[104:107], v[48:51], a[56:59], v[104:107]
    ds_read_b128 v[40:43], v52 offset:1024
    v_mfma_f32_16x16x32_bf16 v[108:111], v[48:51], a[200:203], v[108:111]
    ds_read_b128 v[44:47], v52 offset:2048
    v_mfma_f32_16x16x32_bf16 v[112:115], v[20:23], a[56:59], v[112:115]
    ds_read_b128 v[48:51], v52 offset:3072
    s_add_u32 s28, s37, 3072
    buffer_load_dwordx4 a[96:99], v1, s[8:11], s28 offen sc1
    v_mfma_f32_16x16x32_bf16 v[116:119], v[20:23], a[200:203], v[116:119]
    v_mfma_f32_16x16x32_bf16 v[64:67], v[24:27], a[60:63], v[64:67]
    ds_read_b128 v[20:23], v52 offset:4096
    v_mfma_f32_16x16x32_bf16 v[68:71], v[24:27], a[204:207], v[68:71]
    v_mfma_f32_16x16x32_bf16 v[72:75], v[28:31], a[60:63], v[72:75]
    ds_read_b128 v[24:27], v52 offset:5120
    s_add_u32 s28, s37, 4096
    buffer_load_dwordx4 a[100:103], v1, s[8:11], s28 offen sc1
    v_mfma_f32_16x16x32_bf16 v[76:79], v[28:31], a[204:207], v[76:79]
    v_mfma_f32_16x16x32_bf16 v[80:83], v[32:35], a[60:63], v[80:83]
    ds_read_b128 v[28:31], v52 offset:6144
    v_mfma_f32_16x16x32_bf16 v[84:87], v[32:35], a[204:207], v[84:87]
    s_waitcnt lgkmcnt(6)
    v_mfma_f32_16x16x32_bf16 v[88:91], v[36:39], a[60:63], v[88:91]
    ds_read_b128 v[32:35], v52 offset:7168
    s_add_u32 s28, s37, 8192
    buffer_load_dwordx4 a[104:107], v1, s[8:11], s28 offen sc1
    v_mfma_f32_16x16x32_bf16 v[92:95], v[36:39], a[204:207], v[92:95]
    s_waitcnt lgkmcnt(6)
    v_mfma_f32_16x16x32_bf16 v[96:99], v[40:43], a[60:63], v[96:99]
    ds_read_b128 v[36:39], v52 offset:8192
    v_mfma_f32_16x16x32_bf16 v[100:103], v[40:43], a[204:207], v[100:103]
    s_waitcnt lgkmcnt(6)
    v_mfma_f32_16x16x32_bf16 v[104:107], v[44:47], a[60:63], v[104:107]
    ds_read_b128 v[40:43], v52 offset:9216
    s_add_u32 s28, s37, 12288
    buffer_load_dwordx4 a[108:111], v1, s[8:11], s28 offen sc1
    v_mfma_f32_16x16x32_bf16 v[108:111], v[44:47], a[204:207], v[108:111]
    s_waitcnt lgkmcnt(6)
    v_mfma_f32_16x16x32_bf16 v[112:115], v[48:51], a[60:63], v[112:115]
    ds_read_b128 v[44:47], v52 offset:10240
    v_mfma_f32_16x16x32_bf16 v[116:119], v[48:51], a[204:207], v[116:119]
    s_waitcnt lgkmcnt(6)
    s_waitcnt vmcnt(23)
    v_mfma_f32_16x16x32_bf16 v[64:67], v[20:23], a[64:67], v[64:67]
    ds_read_b128 v[48:51], v52 offset:11264
    s_add_u32 s28, s37, 150528
    buffer_load_dwordx4 a[240:243], v1, s[8:11], s28 offen sc1
    v_mfma_f32_16x16x32_bf16 v[68:71], v[20:23], a[208:211], v[68:71]
    s_waitcnt lgkmcnt(6)
    v_mfma_f32_16x16x32_bf16 v[72:75], v[24:27], a[64:67], v[72:75]
    ds_read_b128 v[20:23], v52 offset:12288
    v_mfma_f32_16x16x32_bf16 v[76:79], v[24:27], a[208:211], v[76:79]
    s_waitcnt lgkmcnt(6)
    v_mfma_f32_16x16x32_bf16 v[80:83], v[28:31], a[64:67], v[80:83]
    ds_read_b128 v[24:27], v52 offset:13312
    s_add_u32 s28, s37, 151552
    buffer_load_dwordx4 a[244:247], v1, s[8:11], s28 offen sc1
    v_mfma_f32_16x16x32_bf16 v[84:87], v[28:31], a[208:211], v[84:87]
    s_waitcnt lgkmcnt(6)
    v_mfma_f32_16x16x32_bf16 v[88:91], v[32:35], a[64:67], v[88:91]
    ds_read_b128 v[28:31], v52 offset:14336
    v_mfma_f32_16x16x32_bf16 v[92:95], v[32:35], a[208:211], v[92:95]
    s_waitcnt lgkmcnt(6)
    v_mfma_f32_16x16x32_bf16 v[96:99], v[36:39], a[64:67], v[96:99]
    ds_read_b128 v[32:35], v52 offset:15360
    s_add_u32 s28, s37, 155648
    buffer_load_dwordx4 a[248:251], v1, s[8:11], s28 offen sc1
    v_mfma_f32_16x16x32_bf16 v[100:103], v[36:39], a[208:211], v[100:103]
    s_waitcnt lgkmcnt(6)
    v_mfma_f32_16x16x32_bf16 v[104:107], v[40:43], a[64:67], v[104:107]
    ds_read_b128 v[36:39], v52 offset:16384
    v_mfma_f32_16x16x32_bf16 v[108:111], v[40:43], a[208:211], v[108:111]
    s_waitcnt lgkmcnt(6)
    v_mfma_f32_16x16x32_bf16 v[112:115], v[44:47], a[64:67], v[112:115]
    ds_read_b128 v[40:43], v52 offset:17408
    s_add_u32 s28, s37, 159744
    buffer_load_dwordx4 a[252:255], v1, s[8:11], s28 offen sc1
    v_mfma_f32_16x16x32_bf16 v[116:119], v[44:47], a[208:211], v[116:119]
    s_waitcnt lgkmcnt(6)
    v_mfma_f32_16x16x32_bf16 v[64:67], v[48:51], a[68:71], v[64:67]
    ds_read_b128 v[44:47], v52 offset:18432
    v_mfma_f32_16x16x32_bf16 v[68:71], v[48:51], a[212:215], v[68:71]
    s_waitcnt lgkmcnt(6)
    v_mfma_f32_16x16x32_bf16 v[72:75], v[20:23], a[68:71], v[72:75]
    ds_read_b128 v[48:51], v52 offset:19456
    buffer_load_dwordx4 v1, s[8:11], s27 offen offset:2048  lds
    v_mfma_f32_16x16x32_bf16 v[76:79], v[20:23], a[212:215], v[76:79]
    s_waitcnt lgkmcnt(6)
    v_mfma_f32_16x16x32_bf16 v[80:83], v[24:27], a[68:71], v[80:83]
    ds_read_b128 v[20:23], v52 offset:20480
    v_mfma_f32_16x16x32_bf16 v[84:87], v[24:27], a[212:215], v[84:87]
    s_waitcnt lgkmcnt(6)
    v_mfma_f32_16x16x32_bf16 v[88:91], v[28:31], a[68:71], v[88:91]
    ds_read_b128 v[24:27], v52 offset:21504
    buffer_load_dwordx4 v1, s[8:11], s27 offen offset:3072  lds
    v_mfma_f32_16x16x32_bf16 v[92:95], v[28:31], a[212:215], v[92:95]
    s_waitcnt lgkmcnt(6)
    v_mfma_f32_16x16x32_bf16 v[96:99], v[32:35], a[68:71], v[96:99]
    ds_read_b128 v[28:31], v52 offset:22528
    v_mfma_f32_16x16x32_bf16 v[100:103], v[32:35], a[212:215], v[100:103]
    s_waitcnt lgkmcnt(6)
    v_mfma_f32_16x16x32_bf16 v[104:107], v[36:39], a[68:71], v[104:107]
    ds_read_b128 v[32:35], v52 offset:23552
    s_add_u32 m0, s24, 77824
    s_add_u32 s27, s36, 188416
    buffer_load_dwordx4 v1, s[8:11], s27 offen offset:0  lds
    v_mfma_f32_16x16x32_bf16 v[108:111], v[36:39], a[212:215], v[108:111]
    s_waitcnt lgkmcnt(6)
    v_mfma_f32_16x16x32_bf16 v[112:115], v[40:43], a[68:71], v[112:115]
    ds_read_b128 v[36:39], v52 offset:24576
    v_mfma_f32_16x16x32_bf16 v[116:119], v[40:43], a[212:215], v[116:119]
    s_waitcnt lgkmcnt(6)
    v_mfma_f32_16x16x32_bf16 v[64:67], v[44:47], a[72:75], v[64:67]
    ds_read_b128 v[40:43], v52 offset:25600
    buffer_load_dwordx4 v1, s[8:11], s27 offen offset:1024  lds
    v_mfma_f32_16x16x32_bf16 v[68:71], v[44:47], a[216:219], v[68:71]
    s_waitcnt lgkmcnt(6)
    v_mfma_f32_16x16x32_bf16 v[72:75], v[48:51], a[72:75], v[72:75]
    ds_read_b128 v[44:47], v52 offset:26624
    v_mfma_f32_16x16x32_bf16 v[76:79], v[48:51], a[216:219], v[76:79]
    s_waitcnt lgkmcnt(6)
    v_mfma_f32_16x16x32_bf16 v[80:83], v[20:23], a[72:75], v[80:83]
    ds_read_b128 v[48:51], v52 offset:27648
    buffer_load_dwordx4 v1, s[8:11], s27 offen offset:2048  lds
    v_mfma_f32_16x16x32_bf16 v[84:87], v[20:23], a[216:219], v[84:87]
    s_waitcnt lgkmcnt(6)
    v_mfma_f32_16x16x32_bf16 v[88:91], v[24:27], a[72:75], v[88:91]
    ds_read_b128 v[20:23], v52 offset:28672
    v_mfma_f32_16x16x32_bf16 v[92:95], v[24:27], a[216:219], v[92:95]
    s_waitcnt lgkmcnt(6)
    v_mfma_f32_16x16x32_bf16 v[96:99], v[28:31], a[72:75], v[96:99]
    ds_read_b128 v[24:27], v52 offset:29696
    buffer_load_dwordx4 v1, s[8:11], s27 offen offset:3072  lds
    v_mfma_f32_16x16x32_bf16 v[100:103], v[28:31], a[216:219], v[100:103]
    s_waitcnt lgkmcnt(6)
    v_mfma_f32_16x16x32_bf16 v[104:107], v[32:35], a[72:75], v[104:107]
    ds_read_b128 v[28:31], v52 offset:30720
    v_mfma_f32_16x16x32_bf16 v[108:111], v[32:35], a[216:219], v[108:111]
    s_waitcnt lgkmcnt(6)
    v_mfma_f32_16x16x32_bf16 v[112:115], v[36:39], a[72:75], v[112:115]
    ds_read_b128 v[32:35], v52 offset:31744
    s_add_u32 m0, s24, 81920
    s_add_u32 s27, s36, 192512
    buffer_load_dwordx4 v1, s[8:11], s27 offen offset:0  lds
    v_mfma_f32_16x16x32_bf16 v[116:119], v[36:39], a[216:219], v[116:119]
    s_waitcnt lgkmcnt(6)
    v_mfma_f32_16x16x32_bf16 v[64:67], v[40:43], a[76:79], v[64:67]
    ds_read_b128 v[36:39], v52 offset:32768
    v_mfma_f32_16x16x32_bf16 v[68:71], v[40:43], a[220:223], v[68:71]
    s_waitcnt lgkmcnt(6)
    v_mfma_f32_16x16x32_bf16 v[72:75], v[44:47], a[76:79], v[72:75]
    ds_read_b128 v[40:43], v52 offset:33792
    s_add_u32 s28, s37, 13312
    buffer_load_dwordx4 a[112:115], v1, s[8:11], s28 offen sc1
    v_mfma_f32_16x16x32_bf16 v[76:79], v[44:47], a[220:223], v[76:79]
    s_waitcnt lgkmcnt(6)
    v_mfma_f32_16x16x32_bf16 v[80:83], v[48:51], a[76:79], v[80:83]
    ds_read_b128 v[44:47], v52 offset:34816
    v_mfma_f32_16x16x32_bf16 v[84:87], v[48:51], a[220:223], v[84:87]
    s_waitcnt lgkmcnt(6)
    v_mfma_f32_16x16x32_bf16 v[88:91], v[20:23], a[76:79], v[88:91]
    ds_read_b128 v[48:51], v52 offset:35840
    s_add_u32 s28, s37, 17408
    buffer_load_dwordx4 a[116:119], v1, s[8:11], s28 offen sc1
    v_mfma_f32_16x16x32_bf16 v[92:95], v[20:23], a[220:223], v[92:95]
    s_waitcnt lgkmcnt(6)
    v_mfma_f32_16x16x32_bf16 v[96:99], v[24:27], a[76:79], v[96:99]
    v_mfma_f32_16x16x32_bf16 v[100:103], v[24:27], a[220:223], v[100:103]
    s_waitcnt lgkmcnt(5)
    v_mfma_f32_16x16x32_bf16 v[104:107], v[28:31], a[76:79], v[104:107]
    s_add_u32 s28, s37, 21504
    buffer_load_dwordx4 a[120:123], v1, s[8:11], s28 offen sc1
    v_mfma_f32_16x16x32_bf16 v[108:111], v[28:31], a[220:223], v[108:111]
    s_waitcnt lgkmcnt(0)
    s_waitcnt vmcnt(20)
    s_barrier
    ds_read_b128 v[20:23], v53 offset:0
    v_mfma_f32_16x16x32_bf16 v[112:115], v[32:35], a[76:79], v[112:115]
    ds_read_b128 v[24:27], v53 offset:1024
    v_mfma_f32_16x16x32_bf16 v[116:119], v[32:35], a[220:223], v[116:119]
    ds_read_b128 v[28:31], v53 offset:2048
    v_mfma_f32_16x16x32_bf16 v[64:67], v[36:39], a[80:83], v[64:67]
    ds_read_b128 v[32:35], v53 offset:3072
    s_add_u32 s28, s37, 22528
    buffer_load_dwordx4 a[124:127], v1, s[8:11], s28 offen sc1
    v_mfma_f32_16x16x32_bf16 v[68:71], v[36:39], a[224:227], v[68:71]
    v_mfma_f32_16x16x32_bf16 v[72:75], v[40:43], a[80:83], v[72:75]
    ds_read_b128 v[36:39], v53 offset:4096
    v_mfma_f32_16x16x32_bf16 v[76:79], v[40:43], a[224:227], v[76:79]
    v_mfma_f32_16x16x32_bf16 v[80:83], v[44:47], a[80:83], v[80:83]
    ds_read_b128 v[40:43], v53 offset:5120
    s_add_u32 s28, s37, 160768
    buffer_load_dwordx4 v[224:227], v1, s[8:11], s28 offen sc1
    v_mfma_f32_16x16x32_bf16 v[84:87], v[44:47], a[224:227], v[84:87]
    v_mfma_f32_16x16x32_bf16 v[88:91], v[48:51], a[80:83], v[88:91]
    ds_read_b128 v[44:47], v53 offset:6144
    v_mfma_f32_16x16x32_bf16 v[92:95], v[48:51], a[224:227], v[92:95]
    s_waitcnt lgkmcnt(6)
    v_mfma_f32_16x16x32_bf16 v[96:99], v[20:23], a[80:83], v[96:99]
    ds_read_b128 v[48:51], v53 offset:7168
    s_add_u32 s28, s37, 164864
    buffer_load_dwordx4 v[228:231], v1, s[8:11], s28 offen sc1
    v_mfma_f32_16x16x32_bf16 v[100:103], v[20:23], a[224:227], v[100:103]
    s_waitcnt lgkmcnt(6)
    v_mfma_f32_16x16x32_bf16 v[104:107], v[24:27], a[80:83], v[104:107]
    ds_read_b128 v[20:23], v53 offset:8192
    v_mfma_f32_16x16x32_bf16 v[108:111], v[24:27], a[224:227], v[108:111]
    s_waitcnt lgkmcnt(6)
    v_mfma_f32_16x16x32_bf16 v[112:115], v[28:31], a[80:83], v[112:115]
    ds_read_b128 v[24:27], v53 offset:9216
    s_add_u32 s28, s37, 168960
    buffer_load_dwordx4 v[232:235], v1, s[8:11], s28 offen sc1
    v_mfma_f32_16x16x32_bf16 v[116:119], v[28:31], a[224:227], v[116:119]
    s_waitcnt lgkmcnt(6)
    v_mfma_f32_16x16x32_bf16 v[64:67], v[32:35], a[84:87], v[64:67]
    ds_read_b128 v[28:31], v53 offset:10240
    v_mfma_f32_16x16x32_bf16 v[68:71], v[32:35], a[228:231], v[68:71]
    s_waitcnt lgkmcnt(6)
    v_mfma_f32_16x16x32_bf16 v[72:75], v[36:39], a[84:87], v[72:75]
    ds_read_b128 v[32:35], v53 offset:11264
    s_add_u32 s28, s37, 169984
    buffer_load_dwordx4 v[236:239], v1, s[8:11], s28 offen sc1
    v_mfma_f32_16x16x32_bf16 v[76:79], v[36:39], a[228:231], v[76:79]
    s_waitcnt lgkmcnt(6)
    v_mfma_f32_16x16x32_bf16 v[80:83], v[40:43], a[84:87], v[80:83]
    ds_read_b128 v[36:39], v53 offset:12288
    v_mfma_f32_16x16x32_bf16 v[84:87], v[40:43], a[228:231], v[84:87]
    s_waitcnt lgkmcnt(6)
    v_mfma_f32_16x16x32_bf16 v[88:91], v[44:47], a[84:87], v[88:91]
    ds_read_b128 v[40:43], v53 offset:13312
    s_add_u32 m0, s24, 110592
    s_add_u32 s27, s36, 221184
    buffer_load_dwordx4 v1, s[8:11], s27 offen offset:0  lds
    v_mfma_f32_16x16x32_bf16 v[92:95], v[44:47], a[228:231], v[92:95]
    s_waitcnt lgkmcnt(6)
    v_mfma_f32_16x16x32_bf16 v[96:99], v[48:51], a[84:87], v[96:99]
    ds_read_b128 v[44:47], v53 offset:14336
    v_mfma_f32_16x16x32_bf16 v[100:103], v[48:51], a[228:231], v[100:103]
    s_waitcnt lgkmcnt(6)
    v_mfma_f32_16x16x32_bf16 v[104:107], v[20:23], a[84:87], v[104:107]
    ds_read_b128 v[48:51], v53 offset:15360
    buffer_load_dwordx4 v1, s[8:11], s27 offen offset:1024  lds
    v_mfma_f32_16x16x32_bf16 v[108:111], v[20:23], a[228:231], v[108:111]
    s_waitcnt lgkmcnt(6)
    v_mfma_f32_16x16x32_bf16 v[112:115], v[24:27], a[84:87], v[112:115]
    ds_read_b128 v[20:23], v53 offset:16384
    v_mfma_f32_16x16x32_bf16 v[116:119], v[24:27], a[228:231], v[116:119]
    s_waitcnt lgkmcnt(6)
    v_mfma_f32_16x16x32_bf16 v[64:67], v[28:31], a[88:91], v[64:67]
    ds_read_b128 v[24:27], v53 offset:17408
    buffer_load_dwordx4 v1, s[8:11], s27 offen offset:2048  lds
    v_mfma_f32_16x16x32_bf16 v[68:71], v[28:31], a[232:235], v[68:71]
    s_waitcnt lgkmcnt(6)
    v_mfma_f32_16x16x32_bf16 v[72:75], v[32:35], a[88:91], v[72:75]
    ds_read_b128 v[28:31], v53 offset:18432
    v_mfma_f32_16x16x32_bf16 v[76:79], v[32:35], a[232:235], v[76:79]
    s_waitcnt lgkmcnt(6)
    v_mfma_f32_16x16x32_bf16 v[80:83], v[36:39], a[88:91], v[80:83]
    ds_read_b128 v[32:35], v53 offset:19456
    buffer_load_dwordx4 v1, s[8:11], s27 offen offset:3072  lds
    v_mfma_f32_16x16x32_bf16 v[84:87], v[36:39], a[232:235], v[84:87]
    s_waitcnt lgkmcnt(6)
    v_mfma_f32_16x16x32_bf16 v[88:91], v[40:43], a[88:91], v[88:91]
    ds_read_b128 v[36:39], v53 offset:20480
    v_mfma_f32_16x16x32_bf16 v[92:95], v[40:43], a[232:235], v[92:95]
    s_waitcnt lgkmcnt(6)
    v_mfma_f32_16x16x32_bf16 v[96:99], v[44:47], a[88:91], v[96:99]
    ds_read_b128 v[40:43], v53 offset:21504
    s_add_u32 m0, s24, 114688
    s_add_u32 s27, s36, 225280
    buffer_load_dwordx4 v1, s[8:11], s27 offen offset:0  lds
    v_mfma_f32_16x16x32_bf16 v[100:103], v[44:47], a[232:235], v[100:103]
    s_waitcnt lgkmcnt(6)
    v_mfma_f32_16x16x32_bf16 v[104:107], v[48:51], a[88:91], v[104:107]
    ds_read_b128 v[44:47], v53 offset:22528
    v_mfma_f32_16x16x32_bf16 v[108:111], v[48:51], a[232:235], v[108:111]
    s_waitcnt lgkmcnt(6)
    v_mfma_f32_16x16x32_bf16 v[112:115], v[20:23], a[88:91], v[112:115]
    ds_read_b128 v[48:51], v53 offset:23552
    buffer_load_dwordx4 v1, s[8:11], s27 offen offset:1024  lds
    v_mfma_f32_16x16x32_bf16 v[116:119], v[20:23], a[232:235], v[116:119]
    s_waitcnt lgkmcnt(6)
    v_mfma_f32_16x16x32_bf16 v[64:67], v[24:27], a[92:95], v[64:67]
    ds_read_b128 v[20:23], v53 offset:24576
    v_mfma_f32_16x16x32_bf16 v[68:71], v[24:27], a[236:239], v[68:71]
    s_waitcnt lgkmcnt(6)
    v_mfma_f32_16x16x32_bf16 v[72:75], v[28:31], a[92:95], v[72:75]
    ds_read_b128 v[24:27], v53 offset:25600
    buffer_load_dwordx4 v1, s[8:11], s27 offen offset:2048  lds
    v_mfma_f32_16x16x32_bf16 v[76:79], v[28:31], a[236:239], v[76:79]
    s_waitcnt lgkmcnt(6)
    v_mfma_f32_16x16x32_bf16 v[80:83], v[32:35], a[92:95], v[80:83]
    ds_read_b128 v[28:31], v53 offset:26624
    v_mfma_f32_16x16x32_bf16 v[84:87], v[32:35], a[236:239], v[84:87]
    s_waitcnt lgkmcnt(6)
    v_mfma_f32_16x16x32_bf16 v[88:91], v[36:39], a[92:95], v[88:91]
    ds_read_b128 v[32:35], v53 offset:27648
    buffer_load_dwordx4 v1, s[8:11], s27 offen offset:3072  lds
    v_mfma_f32_16x16x32_bf16 v[92:95], v[36:39], a[236:239], v[92:95]
    s_waitcnt lgkmcnt(6)
    v_mfma_f32_16x16x32_bf16 v[96:99], v[40:43], a[92:95], v[96:99]
    ds_read_b128 v[36:39], v53 offset:28672
    v_mfma_f32_16x16x32_bf16 v[100:103], v[40:43], a[236:239], v[100:103]
    s_waitcnt lgkmcnt(6)
    v_mfma_f32_16x16x32_bf16 v[104:107], v[44:47], a[92:95], v[104:107]
    ds_read_b128 v[40:43], v53 offset:29696
    s_add_u32 m0, s24, 118784
    s_add_u32 s27, s36, 229376
    buffer_load_dwordx4 v1, s[8:11], s27 offen offset:0  lds
    v_mfma_f32_16x16x32_bf16 v[108:111], v[44:47], a[236:239], v[108:111]
    s_waitcnt lgkmcnt(6)
    v_mfma_f32_16x16x32_bf16 v[112:115], v[48:51], a[92:95], v[112:115]
    ds_read_b128 v[44:47], v53 offset:30720
    v_mfma_f32_16x16x32_bf16 v[116:119], v[48:51], a[236:239], v[116:119]
    s_waitcnt lgkmcnt(6)
    s_waitcnt vmcnt(24)
    v_mfma_f32_16x16x32_bf16 v[64:67], v[20:23], a[96:99], v[64:67]
    ds_read_b128 v[48:51], v53 offset:31744
    s_add_u32 s28, s37, 26624
    buffer_load_dwordx4 a[128:131], v1, s[8:11], s28 offen sc1
    v_mfma_f32_16x16x32_bf16 v[68:71], v[20:23], a[240:243], v[68:71]
    s_waitcnt lgkmcnt(6)
    v_mfma_f32_16x16x32_bf16 v[72:75], v[24:27], a[96:99], v[72:75]
    ds_read_b128 v[20:23], v53 offset:32768
    v_mfma_f32_16x16x32_bf16 v[76:79], v[24:27], a[240:243], v[76:79]
    s_waitcnt lgkmcnt(6)
    v_mfma_f32_16x16x32_bf16 v[80:83], v[28:31], a[96:99], v[80:83]
    ds_read_b128 v[24:27], v53 offset:33792
    s_add_u32 s28, s37, 30720
    buffer_load_dwordx4 a[132:135], v1, s[8:11], s28 offen sc1
    v_mfma_f32_16x16x32_bf16 v[84:87], v[28:31], a[240:243], v[84:87]
    s_waitcnt lgkmcnt(6)
    v_mfma_f32_16x16x32_bf16 v[88:91], v[32:35], a[96:99], v[88:91]
    ds_read_b128 v[28:31], v53 offset:34816
    v_mfma_f32_16x16x32_bf16 v[92:95], v[32:35], a[240:243], v[92:95]
    s_waitcnt lgkmcnt(6)
    v_mfma_f32_16x16x32_bf16 v[96:99], v[36:39], a[96:99], v[96:99]
    ds_read_b128 v[32:35], v53 offset:35840
    s_add_u32 s28, s37, 31744
    buffer_load_dwordx4 a[136:139], v1, s[8:11], s28 offen sc1
    v_mfma_f32_16x16x32_bf16 v[100:103], v[36:39], a[240:243], v[100:103]
    s_waitcnt lgkmcnt(6)
    v_mfma_f32_16x16x32_bf16 v[104:107], v[40:43], a[96:99], v[104:107]
    v_mfma_f32_16x16x32_bf16 v[108:111], v[40:43], a[240:243], v[108:111]
    s_waitcnt lgkmcnt(5)
    v_mfma_f32_16x16x32_bf16 v[112:115], v[44:47], a[96:99], v[112:115]
    s_add_u32 s28, s37, 35840
    buffer_load_dwordx4 a[140:143], v1, s[8:11], s28 offen sc1
    v_mfma_f32_16x16x32_bf16 v[116:119], v[44:47], a[240:243], v[116:119]
    s_waitcnt lgkmcnt(0)
    s_waitcnt vmcnt(21)
    s_barrier
    ds_read_b128 v[36:39], v54 offset:0
    v_mfma_f32_16x16x32_bf16 v[64:67], v[48:51], a[100:103], v[64:67]
    ds_read_b128 v[40:43], v54 offset:1024
    v_mfma_f32_16x16x32_bf16 v[68:71], v[48:51], a[244:247], v[68:71]
    ds_read_b128 v[44:47], v54 offset:2048
    v_mfma_f32_16x16x32_bf16 v[72:75], v[20:23], a[100:103], v[72:75]
    ds_read_b128 v[48:51], v54 offset:3072
    s_add_u32 s28, s37, 174080
    buffer_load_dwordx4 v[240:243], v1, s[8:11], s28 offen sc1
    v_mfma_f32_16x16x32_bf16 v[76:79], v[20:23], a[244:247], v[76:79]
    v_mfma_f32_16x16x32_bf16 v[80:83], v[24:27], a[100:103], v[80:83]
    ds_read_b128 v[20:23], v54 offset:4096
    v_mfma_f32_16x16x32_bf16 v[84:87], v[24:27], a[244:247], v[84:87]
    v_mfma_f32_16x16x32_bf16 v[88:91], v[28:31], a[100:103], v[88:91]
    ds_read_b128 v[24:27], v54 offset:5120
    s_add_u32 s28, s37, 178176
    buffer_load_dwordx4 v[244:247], v1, s[8:11], s28 offen sc1
    v_mfma_f32_16x16x32_bf16 v[92:95], v[28:31], a[244:247], v[92:95]
    v_mfma_f32_16x16x32_bf16 v[96:99], v[32:35], a[100:103], v[96:99]
    ds_read_b128 v[28:31], v54 offset:6144
    v_mfma_f32_16x16x32_bf16 v[100:103], v[32:35], a[244:247], v[100:103]
    s_waitcnt lgkmcnt(6)
    v_mfma_f32_16x16x32_bf16 v[104:107], v[36:39], a[100:103], v[104:107]
    ds_read_b128 v[32:35], v54 offset:7168
    s_add_u32 s28, s37, 179200
    buffer_load_dwordx4 v[248:251], v1, s[8:11], s28 offen sc1
    v_mfma_f32_16x16x32_bf16 v[108:111], v[36:39], a[244:247], v[108:111]
    s_waitcnt lgkmcnt(6)
    v_mfma_f32_16x16x32_bf16 v[112:115], v[40:43], a[100:103], v[112:115]
    ds_read_b128 v[36:39], v54 offset:8192
    v_mfma_f32_16x16x32_bf16 v[116:119], v[40:43], a[244:247], v[116:119]
    s_waitcnt lgkmcnt(6)
    v_mfma_f32_16x16x32_bf16 v[64:67], v[44:47], a[104:107], v[64:67]
    ds_read_b128 v[40:43], v54 offset:9216
    s_add_u32 s28, s37, 183296
    buffer_load_dwordx4 v[252:255], v1, s[8:11], s28 offen sc1
    v_mfma_f32_16x16x32_bf16 v[68:71], v[44:47], a[248:251], v[68:71]
    s_waitcnt lgkmcnt(6)
    v_mfma_f32_16x16x32_bf16 v[72:75], v[48:51], a[104:107], v[72:75]
    ds_read_b128 v[44:47], v54 offset:10240
    v_mfma_f32_16x16x32_bf16 v[76:79], v[48:51], a[248:251], v[76:79]
    s_waitcnt lgkmcnt(6)
    v_mfma_f32_16x16x32_bf16 v[80:83], v[20:23], a[104:107], v[80:83]
    ds_read_b128 v[48:51], v54 offset:11264
    s_add_u32 m0, s24, 0
    s_add_u32 s27, s36, 258048
    buffer_load_dwordx4 v1, s[8:11], s27 offen offset:0  lds
    v_mfma_f32_16x16x32_bf16 v[84:87], v[20:23], a[248:251], v[84:87]
    s_waitcnt lgkmcnt(6)
    v_mfma_f32_16x16x32_bf16 v[88:91], v[24:27], a[104:107], v[88:91]
    ds_read_b128 v[20:23], v54 offset:12288
    v_mfma_f32_16x16x32_bf16 v[92:95], v[24:27], a[248:251], v[92:95]
    s_waitcnt lgkmcnt(6)
    v_mfma_f32_16x16x32_bf16 v[96:99], v[28:31], a[104:107], v[96:99]
    ds_read_b128 v[24:27], v54 offset:13312
    buffer_load_dwordx4 v1, s[8:11], s27 offen offset:1024  lds
    v_mfma_f32_16x16x32_bf16 v[100:103], v[28:31], a[248:251], v[100:103]
    s_waitcnt lgkmcnt(6)
    v_mfma_f32_16x16x32_bf16 v[104:107], v[32:35], a[104:107], v[104:107]
    ds_read_b128 v[28:31], v54 offset:14336
    v_mfma_f32_16x16x32_bf16 v[108:111], v[32:35], a[248:251], v[108:111]
    s_waitcnt lgkmcnt(6)
    v_mfma_f32_16x16x32_bf16 v[112:115], v[36:39], a[104:107], v[112:115]
    ds_read_b128 v[32:35], v54 offset:15360
    buffer_load_dwordx4 v1, s[8:11], s27 offen offset:2048  lds
    v_mfma_f32_16x16x32_bf16 v[116:119], v[36:39], a[248:251], v[116:119]
    s_waitcnt lgkmcnt(6)
    v_mfma_f32_16x16x32_bf16 v[64:67], v[40:43], a[108:111], v[64:67]
    ds_read_b128 v[36:39], v54 offset:16384
    v_mfma_f32_16x16x32_bf16 v[68:71], v[40:43], a[252:255], v[68:71]
    s_waitcnt lgkmcnt(6)
    v_mfma_f32_16x16x32_bf16 v[72:75], v[44:47], a[108:111], v[72:75]
    ds_read_b128 v[40:43], v54 offset:17408
    buffer_load_dwordx4 v1, s[8:11], s27 offen offset:3072  lds
    v_mfma_f32_16x16x32_bf16 v[76:79], v[44:47], a[252:255], v[76:79]
    s_waitcnt lgkmcnt(6)
    v_mfma_f32_16x16x32_bf16 v[80:83], v[48:51], a[108:111], v[80:83]
    ds_read_b128 v[44:47], v54 offset:18432
    v_mfma_f32_16x16x32_bf16 v[84:87], v[48:51], a[252:255], v[84:87]
    s_waitcnt lgkmcnt(6)
    v_mfma_f32_16x16x32_bf16 v[88:91], v[20:23], a[108:111], v[88:91]
    ds_read_b128 v[48:51], v54 offset:19456
    s_add_u32 m0, s24, 4096
    s_add_u32 s27, s36, 262144
    buffer_load_dwordx4 v1, s[8:11], s27 offen offset:0  lds
    v_mfma_f32_16x16x32_bf16 v[92:95], v[20:23], a[252:255], v[92:95]
    s_waitcnt lgkmcnt(6)
    v_mfma_f32_16x16x32_bf16 v[96:99], v[24:27], a[108:111], v[96:99]
    ds_read_b128 v[20:23], v54 offset:20480
    v_mfma_f32_16x16x32_bf16 v[100:103], v[24:27], a[252:255], v[100:103]
    s_waitcnt lgkmcnt(6)
    v_mfma_f32_16x16x32_bf16 v[104:107], v[28:31], a[108:111], v[104:107]
    ds_read_b128 v[24:27], v54 offset:21504
    buffer_load_dwordx4 v1, s[8:11], s27 offen offset:1024  lds
    v_mfma_f32_16x16x32_bf16 v[108:111], v[28:31], a[252:255], v[108:111]
    s_waitcnt lgkmcnt(6)
    v_mfma_f32_16x16x32_bf16 v[112:115], v[32:35], a[108:111], v[112:115]
    ds_read_b128 v[28:31], v54 offset:22528
    v_mfma_f32_16x16x32_bf16 v[116:119], v[32:35], a[252:255], v[116:119]
    s_waitcnt lgkmcnt(6)
    s_waitcnt vmcnt(23)
    v_mfma_f32_16x16x32_bf16 v[64:67], v[36:39], a[112:115], v[64:67]
    ds_read_b128 v[32:35], v54 offset:23552
    buffer_load_dwordx4 v1, s[8:11], s27 offen offset:2048  lds
    v_mfma_f32_16x16x32_bf16 v[68:71], v[36:39], v[224:227], v[68:71]
    s_waitcnt lgkmcnt(6)
    v_mfma_f32_16x16x32_bf16 v[72:75], v[40:43], a[112:115], v[72:75]
    ds_read_b128 v[36:39], v54 offset:24576
    v_mfma_f32_16x16x32_bf16 v[76:79], v[40:43], v[224:227], v[76:79]
    s_waitcnt lgkmcnt(6)
    v_mfma_f32_16x16x32_bf16 v[80:83], v[44:47], a[112:115], v[80:83]
    ds_read_b128 v[40:43], v54 offset:25600
    buffer_load_dwordx4 v1, s[8:11], s27 offen offset:3072  lds
    v_mfma_f32_16x16x32_bf16 v[84:87], v[44:47], v[224:227], v[84:87]
    s_waitcnt lgkmcnt(6)
    v_mfma_f32_16x16x32_bf16 v[88:91], v[48:51], a[112:115], v[88:91]
    ds_read_b128 v[44:47], v54 offset:26624
    v_mfma_f32_16x16x32_bf16 v[92:95], v[48:51], v[224:227], v[92:95]
    s_waitcnt lgkmcnt(6)
    v_mfma_f32_16x16x32_bf16 v[96:99], v[20:23], a[112:115], v[96:99]
    ds_read_b128 v[48:51], v54 offset:27648
    s_add_u32 m0, s24, 8192
    s_add_u32 s27, s36, 266240
    buffer_load_dwordx4 v1, s[8:11], s27 offen offset:0  lds
    v_mfma_f32_16x16x32_bf16 v[100:103], v[20:23], v[224:227], v[100:103]
    s_waitcnt lgkmcnt(6)
    v_mfma_f32_16x16x32_bf16 v[104:107], v[24:27], a[112:115], v[104:107]
    ds_read_b128 v[20:23], v54 offset:28672
    v_mfma_f32_16x16x32_bf16 v[108:111], v[24:27], v[224:227], v[108:111]
    s_waitcnt lgkmcnt(6)
    v_mfma_f32_16x16x32_bf16 v[112:115], v[28:31], a[112:115], v[112:115]
    ds_read_b128 v[24:27], v54 offset:29696
    s_add_u32 m0, s24, 36864
    s_add_u32 s27, s36, 294912
    buffer_load_dwordx4 v1, s[8:11], s27 offen offset:0  lds
    v_mfma_f32_16x16x32_bf16 v[116:119], v[28:31], v[224:227], v[116:119]
    s_waitcnt lgkmcnt(6)
    v_mfma_f32_16x16x32_bf16 v[64:67], v[32:35], a[116:119], v[64:67]
    ds_read_b128 v[28:31], v54 offset:30720
    v_mfma_f32_16x16x32_bf16 v[68:71], v[32:35], v[228:231], v[68:71]
    s_waitcnt lgkmcnt(6)
    v_mfma_f32_16x16x32_bf16 v[72:75], v[36:39], a[116:119], v[72:75]
    ds_read_b128 v[32:35], v54 offset:31744
    buffer_load_dwordx4 v1, s[8:11], s27 offen offset:1024  lds
    v_mfma_f32_16x16x32_bf16 v[76:79], v[36:39], v[228:231], v[76:79]
    s_waitcnt lgkmcnt(6)
    v_mfma_f32_16x16x32_bf16 v[80:83], v[40:43], a[116:119], v[80:83]
    ds_read_b128 v[36:39], v54 offset:32768
    v_mfma_f32_16x16x32_bf16 v[84:87], v[40:43], v[228:231], v[84:87]
    s_waitcnt lgkmcnt(6)
    v_mfma_f32_16x16x32_bf16 v[88:91], v[44:47], a[116:119], v[88:91]
    ds_read_b128 v[40:43], v54 offset:33792
    buffer_load_dwordx4 v1, s[8:11], s27 offen offset:2048  lds
    v_mfma_f32_16x16x32_bf16 v[92:95], v[44:47], v[228:231], v[92:95]
    s_waitcnt lgkmcnt(6)
    v_mfma_f32_16x16x32_bf16 v[96:99], v[48:51], a[116:119], v[96:99]
    ds_read_b128 v[44:47], v54 offset:34816
    v_mfma_f32_16x16x32_bf16 v[100:103], v[48:51], v[228:231], v[100:103]
    s_waitcnt lgkmcnt(6)
    v_mfma_f32_16x16x32_bf16 v[104:107], v[20:23], a[116:119], v[104:107]
    ds_read_b128 v[48:51], v54 offset:35840
    buffer_load_dwordx4 v1, s[8:11], s27 offen offset:3072  lds
    v_mfma_f32_16x16x32_bf16 v[108:111], v[20:23], v[228:231], v[108:111]
    s_waitcnt lgkmcnt(6)
    v_mfma_f32_16x16x32_bf16 v[112:115], v[24:27], a[116:119], v[112:115]
    v_mfma_f32_16x16x32_bf16 v[116:119], v[24:27], v[228:231], v[116:119]
    s_waitcnt lgkmcnt(5)
    v_mfma_f32_16x16x32_bf16 v[64:67], v[28:31], a[120:123], v[64:67]
    s_add_u32 m0, s24, 40960
    s_add_u32 s27, s36, 299008
    buffer_load_dwordx4 v1, s[8:11], s27 offen offset:0  lds
    v_mfma_f32_16x16x32_bf16 v[68:71], v[28:31], v[232:235], v[68:71]
    s_waitcnt lgkmcnt(0)
    s_waitcnt vmcnt(22)
    s_barrier
    ds_read_b128 v[20:23], v55 offset:0
    v_mfma_f32_16x16x32_bf16 v[72:75], v[32:35], a[120:123], v[72:75]
    ds_read_b128 v[24:27], v55 offset:1024
    v_mfma_f32_16x16x32_bf16 v[76:79], v[32:35], v[232:235], v[76:79]
    ds_read_b128 v[28:31], v55 offset:2048
    v_mfma_f32_16x16x32_bf16 v[80:83], v[36:39], a[120:123], v[80:83]
    ds_read_b128 v[32:35], v55 offset:3072
    buffer_load_dwordx4 v1, s[8:11], s27 offen offset:1024  lds
    v_mfma_f32_16x16x32_bf16 v[84:87], v[36:39], v[232:235], v[84:87]
    v_mfma_f32_16x16x32_bf16 v[88:91], v[40:43], a[120:123], v[88:91]
    ds_read_b128 v[36:39], v55 offset:4096
    v_mfma_f32_16x16x32_bf16 v[92:95], v[40:43], v[232:235], v[92:95]
    v_mfma_f32_16x16x32_bf16 v[96:99], v[44:47], a[120:123], v[96:99]
    ds_read_b128 v[40:43], v55 offset:5120
    buffer_load_dwordx4 v1, s[8:11], s27 offen offset:2048  lds
    v_mfma_f32_16x16x32_bf16 v[100:103], v[44:47], v[232:235], v[100:103]
    v_mfma_f32_16x16x32_bf16 v[104:107], v[48:51], a[120:123], v[104:107]
    ds_read_b128 v[44:47], v55 offset:6144
    v_mfma_f32_16x16x32_bf16 v[108:111], v[48:51], v[232:235], v[108:111]
    s_waitcnt lgkmcnt(6)
    v_mfma_f32_16x16x32_bf16 v[112:115], v[20:23], a[120:123], v[112:115]
    ds_read_b128 v[48:51], v55 offset:7168
    buffer_load_dwordx4 v1, s[8:11], s27 offen offset:3072  lds
    v_mfma_f32_16x16x32_bf16 v[116:119], v[20:23], v[232:235], v[116:119]
    s_waitcnt lgkmcnt(6)
    v_mfma_f32_16x16x32_bf16 v[64:67], v[24:27], a[124:127], v[64:67]
    ds_read_b128 v[20:23], v55 offset:8192
    v_mfma_f32_16x16x32_bf16 v[68:71], v[24:27], v[236:239], v[68:71]
    s_waitcnt lgkmcnt(6)
    v_mfma_f32_16x16x32_bf16 v[72:75], v[28:31], a[124:127], v[72:75]
    ds_read_b128 v[24:27], v55 offset:9216
    s_add_u32 m0, s24, 45056
    s_add_u32 s27, s36, 303104
    buffer_load_dwordx4 v1, s[8:11], s27 offen offset:0  lds
    v_mfma_f32_16x16x32_bf16 v[76:79], v[28:31], v[236:239], v[76:79]
    s_waitcnt lgkmcnt(6)
    v_mfma_f32_16x16x32_bf16 v[80:83], v[32:35], a[124:127], v[80:83]
    ds_read_b128 v[28:31], v55 offset:10240
    v_mfma_f32_16x16x32_bf16 v[84:87], v[32:35], v[236:239], v[84:87]
    s_waitcnt lgkmcnt(6)
    v_mfma_f32_16x16x32_bf16 v[88:91], v[36:39], a[124:127], v[88:91]
    ds_read_b128 v[32:35], v55 offset:11264
    v_mfma_f32_16x16x32_bf16 v[92:95], v[36:39], v[236:239], v[92:95]
    s_waitcnt lgkmcnt(6)
    v_mfma_f32_16x16x32_bf16 v[96:99], v[40:43], a[124:127], v[96:99]
    ds_read_b128 v[36:39], v55 offset:12288
    v_mfma_f32_16x16x32_bf16 v[100:103], v[40:43], v[236:239], v[100:103]
    s_waitcnt lgkmcnt(6)
    v_mfma_f32_16x16x32_bf16 v[104:107], v[44:47], a[124:127], v[104:107]
    ds_read_b128 v[40:43], v55 offset:13312
    v_mfma_f32_16x16x32_bf16 v[108:111], v[44:47], v[236:239], v[108:111]
    s_waitcnt lgkmcnt(6)
    v_mfma_f32_16x16x32_bf16 v[112:115], v[48:51], a[124:127], v[112:115]
    ds_read_b128 v[44:47], v55 offset:14336
    v_mfma_f32_16x16x32_bf16 v[116:119], v[48:51], v[236:239], v[116:119]
    s_waitcnt lgkmcnt(6)
    s_waitcnt vmcnt(18)
    v_mfma_f32_16x16x32_bf16 v[64:67], v[20:23], a[128:131], v[64:67]
    ds_read_b128 v[48:51], v55 offset:15360
    v_mfma_f32_16x16x32_bf16 v[68:71], v[20:23], v[240:243], v[68:71]
    s_waitcnt lgkmcnt(6)
    v_mfma_f32_16x16x32_bf16 v[72:75], v[24:27], a[128:131], v[72:75]
    ds_read_b128 v[20:23], v55 offset:16384
    v_mfma_f32_16x16x32_bf16 v[76:79], v[24:27], v[240:243], v[76:79]
    s_waitcnt lgkmcnt(6)
    v_mfma_f32_16x16x32_bf16 v[80:83], v[28:31], a[128:131], v[80:83]
    ds_read_b128 v[24:27], v55 offset:17408
    v_mfma_f32_16x16x32_bf16 v[84:87], v[28:31], v[240:243], v[84:87]
    s_waitcnt lgkmcnt(6)
    v_mfma_f32_16x16x32_bf16 v[88:91], v[32:35], a[128:131], v[88:91]
    ds_read_b128 v[28:31], v55 offset:18432
    v_mfma_f32_16x16x32_bf16 v[92:95], v[32:35], v[240:243], v[92:95]
    s_waitcnt lgkmcnt(6)
    v_mfma_f32_16x16x32_bf16 v[96:99], v[36:39], a[128:131], v[96:99]
    ds_read_b128 v[32:35], v55 offset:19456
    v_mfma_f32_16x16x32_bf16 v[100:103], v[36:39], v[240:243], v[100:103]
    s_waitcnt lgkmcnt(6)
    v_mfma_f32_16x16x32_bf16 v[104:107], v[40:43], a[128:131], v[104:107]
    ds_read_b128 v[36:39], v55 offset:20480
    v_mfma_f32_16x16x32_bf16 v[108:111], v[40:43], v[240:243], v[108:111]
    s_waitcnt lgkmcnt(6)
    v_mfma_f32_16x16x32_bf16 v[112:115], v[44:47], a[128:131], v[112:115]
    ds_read_b128 v[40:43], v55 offset:21504
    v_mfma_f32_16x16x32_bf16 v[116:119], v[44:47], v[240:243], v[116:119]
    s_waitcnt lgkmcnt(6)
    v_mfma_f32_16x16x32_bf16 v[64:67], v[48:51], a[132:135], v[64:67]
    ds_read_b128 v[44:47], v55 offset:22528
    v_mfma_f32_16x16x32_bf16 v[68:71], v[48:51], v[244:247], v[68:71]
    s_waitcnt lgkmcnt(6)
    v_mfma_f32_16x16x32_bf16 v[72:75], v[20:23], a[132:135], v[72:75]
    ds_read_b128 v[48:51], v55 offset:23552
    v_mfma_f32_16x16x32_bf16 v[76:79], v[20:23], v[244:247], v[76:79]
    s_waitcnt lgkmcnt(6)
    v_mfma_f32_16x16x32_bf16 v[80:83], v[24:27], a[132:135], v[80:83]
    ds_read_b128 v[20:23], v55 offset:24576
    v_mfma_f32_16x16x32_bf16 v[84:87], v[24:27], v[244:247], v[84:87]
    s_waitcnt lgkmcnt(6)
    v_mfma_f32_16x16x32_bf16 v[88:91], v[28:31], a[132:135], v[88:91]
    ds_read_b128 v[24:27], v55 offset:25600
    v_mfma_f32_16x16x32_bf16 v[92:95], v[28:31], v[244:247], v[92:95]
    s_waitcnt lgkmcnt(6)
    v_mfma_f32_16x16x32_bf16 v[96:99], v[32:35], a[132:135], v[96:99]
    ds_read_b128 v[28:31], v55 offset:26624
    v_mfma_f32_16x16x32_bf16 v[100:103], v[32:35], v[244:247], v[100:103]
    s_waitcnt lgkmcnt(6)
    v_mfma_f32_16x16x32_bf16 v[104:107], v[36:39], a[132:135], v[104:107]
    ds_read_b128 v[32:35], v55 offset:27648
    v_mfma_f32_16x16x32_bf16 v[108:111], v[36:39], v[244:247], v[108:111]
    s_waitcnt lgkmcnt(6)
    v_mfma_f32_16x16x32_bf16 v[112:115], v[40:43], a[132:135], v[112:115]
    ds_read_b128 v[36:39], v55 offset:28672
    v_mfma_f32_16x16x32_bf16 v[116:119], v[40:43], v[244:247], v[116:119]
    s_waitcnt lgkmcnt(6)
    v_mfma_f32_16x16x32_bf16 v[64:67], v[44:47], a[136:139], v[64:67]
    ds_read_b128 v[40:43], v55 offset:29696
    v_mfma_f32_16x16x32_bf16 v[68:71], v[44:47], v[248:251], v[68:71]
    s_waitcnt lgkmcnt(6)
    v_mfma_f32_16x16x32_bf16 v[72:75], v[48:51], a[136:139], v[72:75]
    ds_read_b128 v[44:47], v55 offset:30720
    v_mfma_f32_16x16x32_bf16 v[76:79], v[48:51], v[248:251], v[76:79]
    s_waitcnt lgkmcnt(6)
    v_mfma_f32_16x16x32_bf16 v[80:83], v[20:23], a[136:139], v[80:83]
    ds_read_b128 v[48:51], v55 offset:31744
    v_mfma_f32_16x16x32_bf16 v[84:87], v[20:23], v[248:251], v[84:87]
    s_waitcnt lgkmcnt(6)
    v_mfma_f32_16x16x32_bf16 v[88:91], v[24:27], a[136:139], v[88:91]
    ds_read_b128 v[20:23], v55 offset:32768
    v_mfma_f32_16x16x32_bf16 v[92:95], v[24:27], v[248:251], v[92:95]
    s_waitcnt lgkmcnt(6)
    v_mfma_f32_16x16x32_bf16 v[96:99], v[28:31], a[136:139], v[96:99]
    ds_read_b128 v[24:27], v55 offset:33792
    v_mfma_f32_16x16x32_bf16 v[100:103], v[28:31], v[248:251], v[100:103]
    s_waitcnt lgkmcnt(6)
    v_mfma_f32_16x16x32_bf16 v[104:107], v[32:35], a[136:139], v[104:107]
    ds_read_b128 v[28:31], v55 offset:34816
    v_mfma_f32_16x16x32_bf16 v[108:111], v[32:35], v[248:251], v[108:111]
    s_waitcnt lgkmcnt(6)
    v_mfma_f32_16x16x32_bf16 v[112:115], v[36:39], a[136:139], v[112:115]
    ds_read_b128 v[32:35], v55 offset:35840
    v_mfma_f32_16x16x32_bf16 v[116:119], v[36:39], v[248:251], v[116:119]
    s_waitcnt lgkmcnt(6)
    v_mfma_f32_16x16x32_bf16 v[64:67], v[40:43], a[140:143], v[64:67]
    v_mfma_f32_16x16x32_bf16 v[68:71], v[40:43], v[252:255], v[68:71]
    s_waitcnt lgkmcnt(5)
    v_mfma_f32_16x16x32_bf16 v[72:75], v[44:47], a[140:143], v[72:75]
    v_mfma_f32_16x16x32_bf16 v[76:79], v[44:47], v[252:255], v[76:79]
    s_waitcnt lgkmcnt(0)
    s_waitcnt vmcnt(9)
    s_barrier
    ds_read_b128 v[36:39], v52 offset:0
    v_mfma_f32_16x16x32_bf16 v[80:83], v[48:51], a[140:143], v[80:83]
    ds_read_b128 v[40:43], v52 offset:1024
    v_mfma_f32_16x16x32_bf16 v[84:87], v[48:51], v[252:255], v[84:87]
    ds_read_b128 v[44:47], v52 offset:2048
    v_mfma_f32_16x16x32_bf16 v[88:91], v[20:23], a[140:143], v[88:91]
    ds_read_b128 v[48:51], v52 offset:3072
    v_mfma_f32_16x16x32_bf16 v[92:95], v[20:23], v[252:255], v[92:95]
    v_mfma_f32_16x16x32_bf16 v[96:99], v[24:27], a[140:143], v[96:99]
    ds_read_b128 v[20:23], v52 offset:4096
    v_mfma_f32_16x16x32_bf16 v[100:103], v[24:27], v[252:255], v[100:103]
    v_mfma_f32_16x16x32_bf16 v[104:107], v[28:31], a[140:143], v[104:107]
    ds_read_b128 v[24:27], v52 offset:5120
    v_mfma_f32_16x16x32_bf16 v[108:111], v[28:31], v[252:255], v[108:111]
    v_mfma_f32_16x16x32_bf16 v[112:115], v[32:35], a[140:143], v[112:115]
    ds_read_b128 v[28:31], v52 offset:6144
    v_mfma_f32_16x16x32_bf16 v[116:119], v[32:35], v[252:255], v[116:119]
    s_waitcnt lgkmcnt(6)
    v_mfma_f32_16x16x32_bf16 v[120:123], v[36:39], v[192:195], 0
    ds_read_b128 v[32:35], v52 offset:7168
    v_mfma_f32_16x16x32_bf16 v[124:127], v[36:39], v[208:211], 0
    s_waitcnt lgkmcnt(6)
    v_mfma_f32_16x16x32_bf16 v[128:131], v[40:43], v[192:195], 0
    ds_read_b128 v[36:39], v52 offset:8192
    v_mfma_f32_16x16x32_bf16 v[132:135], v[40:43], v[208:211], 0
    s_waitcnt lgkmcnt(6)
    v_mfma_f32_16x16x32_bf16 v[120:123], v[44:47], v[196:199], v[120:123]
    ds_read_b128 v[40:43], v52 offset:9216
    v_mfma_f32_16x16x32_bf16 v[124:127], v[44:47], v[212:215], v[124:127]
    s_waitcnt lgkmcnt(6)
    v_mfma_f32_16x16x32_bf16 v[128:131], v[48:51], v[196:199], v[128:131]
    ds_read_b128 v[44:47], v52 offset:10240
    v_mfma_f32_16x16x32_bf16 v[132:135], v[48:51], v[212:215], v[132:135]
    s_waitcnt lgkmcnt(6)
    v_mfma_f32_16x16x32_bf16 v[120:123], v[20:23], v[200:203], v[120:123]
    ds_read_b128 v[48:51], v52 offset:11264
    v_mfma_f32_16x16x32_bf16 v[124:127], v[20:23], v[216:219], v[124:127]
    s_waitcnt lgkmcnt(6)
    v_mfma_f32_16x16x32_bf16 v[128:131], v[24:27], v[200:203], v[128:131]
    ds_read_b128 v[20:23], v52 offset:12288
    v_cvt_pk_bf16_f32 v4, v64, v65
    v_cvt_pk_bf16_f32 v5, v66, v67
    v_mfma_f32_16x16x32_bf16 v[132:135], v[24:27], v[216:219], v[132:135]
    v_cvt_pk_bf16_f32 v6, v68, v69
    v_cvt_pk_bf16_f32 v7, v70, v71
    s_waitcnt lgkmcnt(6)
    v_mfma_f32_16x16x32_bf16 v[120:123], v[28:31], v[204:207], v[120:123]
    ds_read_b128 v[24:27], v52 offset:13312
    s_cmp_gt_u32 s22, 0
    s_cselect_b32 s23, 0, 2
    v_mfma_f32_16x16x32_bf16 v[124:127], v[28:31], v[220:223], v[124:127]
    s_lshr_b32 s25, s23, 1
    s_mul_i32 s25, s25, 49152
    s_waitcnt lgkmcnt(6)
    v_mfma_f32_16x16x32_bf16 v[128:131], v[32:35], v[204:207], v[128:131]
    ds_read_b128 v[28:31], v52 offset:14336
    s_and_b32 s23, s23, 1
    s_lshl_b32 s23, s23, 10
    v_mfma_f32_16x16x32_bf16 v[132:135], v[32:35], v[220:223], v[132:135]
    s_add_u32 s25, s25, s23
    s_add_u32 s25, s25, s21
    s_waitcnt lgkmcnt(6)
    v_mfma_f32_16x16x32_bf16 v[120:123], v[36:39], v[160:163], v[120:123]
    ds_read_b128 v[32:35], v52 offset:15360
    buffer_store_dwordx4 v[4:7], v1, s[8:11], s25 offen sc1
    v_mfma_f32_16x16x32_bf16 v[124:127], v[36:39], v[176:179], v[124:127]
    v_cvt_pk_bf16_f32 v8, v72, v73
    v_cvt_pk_bf16_f32 v9, v74, v75
    s_waitcnt lgkmcnt(6)
    v_mfma_f32_16x16x32_bf16 v[128:131], v[40:43], v[160:163], v[128:131]
    ds_read_b128 v[36:39], v52 offset:16384
    v_cvt_pk_bf16_f32 v10, v76, v77
    v_cvt_pk_bf16_f32 v11, v78, v79
    v_mfma_f32_16x16x32_bf16 v[132:135], v[40:43], v[176:179], v[132:135]
    s_cmp_gt_u32 s22, 1
    s_cselect_b32 s23, 1, 3
    s_waitcnt lgkmcnt(6)
    v_mfma_f32_16x16x32_bf16 v[120:123], v[44:47], v[164:167], v[120:123]
    ds_read_b128 v[40:43], v52 offset:17408
    s_lshr_b32 s25, s23, 1
    s_mul_i32 s25, s25, 49152
    v_mfma_f32_16x16x32_bf16 v[124:127], v[44:47], v[180:183], v[124:127]
    s_and_b32 s23, s23, 1
    s_lshl_b32 s23, s23, 10
    s_waitcnt lgkmcnt(6)
    v_mfma_f32_16x16x32_bf16 v[128:131], v[48:51], v[164:167], v[128:131]
    ds_read_b128 v[44:47], v52 offset:18432
    s_add_u32 s25, s25, s23
    s_add_u32 s25, s25, s21
    v_mfma_f32_16x16x32_bf16 v[132:135], v[48:51], v[180:183], v[132:135]
    buffer_store_dwordx4 v[8:11], v1, s[8:11], s25 offen sc1
    s_waitcnt lgkmcnt(6)
    v_mfma_f32_16x16x32_bf16 v[120:123], v[20:23], v[168:171], v[120:123]
    ds_read_b128 v[48:51], v52 offset:19456
    v_cvt_pk_bf16_f32 v12, v80, v81
    v_cvt_pk_bf16_f32 v13, v82, v83
    v_mfma_f32_16x16x32_bf16 v[124:127], v[20:23], v[184:187], v[124:127]
    v_cvt_pk_bf16_f32 v14, v84, v85
    v_cvt_pk_bf16_f32 v15, v86, v87
    s_waitcnt lgkmcnt(6)
    v_mfma_f32_16x16x32_bf16 v[128:131], v[24:27], v[168:171], v[128:131]
    ds_read_b128 v[20:23], v52 offset:20480
    s_cmp_gt_u32 s22, 2
    s_cselect_b32 s23, 2, 4
    v_mfma_f32_16x16x32_bf16 v[132:135], v[24:27], v[184:187], v[132:135]
    s_lshr_b32 s25, s23, 1
    s_mul_i32 s25, s25, 49152
    s_waitcnt lgkmcnt(6)
    v_mfma_f32_16x16x32_bf16 v[120:123], v[28:31], v[172:175], v[120:123]
    ds_read_b128 v[24:27], v52 offset:21504
    s_and_b32 s23, s23, 1
    s_lshl_b32 s23, s23, 10
    v_mfma_f32_16x16x32_bf16 v[124:127], v[28:31], v[188:191], v[124:127]
    s_add_u32 s25, s25, s23
    s_add_u32 s25, s25, s21
    s_waitcnt lgkmcnt(6)
    v_mfma_f32_16x16x32_bf16 v[128:131], v[32:35], v[172:175], v[128:131]
    ds_read_b128 v[28:31], v52 offset:22528
    buffer_store_dwordx4 v[12:15], v1, s[8:11], s25 offen sc1
    v_mfma_f32_16x16x32_bf16 v[132:135], v[32:35], v[188:191], v[132:135]
    v_cvt_pk_bf16_f32 v60, v88, v89
    v_cvt_pk_bf16_f32 v61, v90, v91
    s_waitcnt lgkmcnt(6)
    v_mfma_f32_16x16x32_bf16 v[120:123], v[36:39], a[32:35], v[120:123]
    ds_read_b128 v[32:35], v52 offset:23552
    v_cvt_pk_bf16_f32 v62, v92, v93
    v_cvt_pk_bf16_f32 v63, v94, v95
    v_mfma_f32_16x16x32_bf16 v[124:127], v[36:39], a[176:179], v[124:127]
    s_cmp_gt_u32 s22, 3
    s_cselect_b32 s23, 3, 5
    s_waitcnt lgkmcnt(6)
    v_mfma_f32_16x16x32_bf16 v[128:131], v[40:43], a[32:35], v[128:131]
    ds_read_b128 v[36:39], v52 offset:24576
    s_lshr_b32 s25, s23, 1
    s_mul_i32 s25, s25, 49152
    v_mfma_f32_16x16x32_bf16 v[132:135], v[40:43], a[176:179], v[132:135]
    s_and_b32 s23, s23, 1
    s_lshl_b32 s23, s23, 10
    s_waitcnt lgkmcnt(6)
    v_mfma_f32_16x16x32_bf16 v[120:123], v[44:47], a[36:39], v[120:123]
    ds_read_b128 v[40:43], v52 offset:25600
    s_add_u32 s25, s25, s23
    s_add_u32 s25, s25, s21
    v_mfma_f32_16x16x32_bf16 v[124:127], v[44:47], a[180:183], v[124:127]
    buffer_store_dwordx4 v[60:63], v1, s[8:11], s25 offen sc1
    s_waitcnt lgkmcnt(6)
    v_mfma_f32_16x16x32_bf16 v[128:131], v[48:51], a[36:39], v[128:131]
    ds_read_b128 v[44:47], v52 offset:26624
    v_cvt_pk_bf16_f32 v4, v96, v97
    v_cvt_pk_bf16_f32 v5, v98, v99
    v_mfma_f32_16x16x32_bf16 v[132:135], v[48:51], a[180:183], v[132:135]
    v_cvt_pk_bf16_f32 v6, v100, v101
    v_cvt_pk_bf16_f32 v7, v102, v103
    s_waitcnt lgkmcnt(6)
    v_mfma_f32_16x16x32_bf16 v[120:123], v[20:23], a[40:43], v[120:123]
    ds_read_b128 v[48:51], v52 offset:27648
    s_cmp_gt_u32 s22, 4
    s_cselect_b32 s23, 4, 6
    v_mfma_f32_16x16x32_bf16 v[124:127], v[20:23], a[184:187], v[124:127]
    s_lshr_b32 s25, s23, 1
    s_mul_i32 s25, s25, 49152
    s_waitcnt lgkmcnt(6)
    v_mfma_f32_16x16x32_bf16 v[128:131], v[24:27], a[40:43], v[128:131]
    ds_read_b128 v[20:23], v52 offset:28672
    s_and_b32 s23, s23, 1
    s_lshl_b32 s23, s23, 10
    v_mfma_f32_16x16x32_bf16 v[132:135], v[24:27], a[184:187], v[132:135]
    s_add_u32 s25, s25, s23
    s_add_u32 s25, s25, s21
    s_waitcnt lgkmcnt(6)
    v_mfma_f32_16x16x32_bf16 v[120:123], v[28:31], a[44:47], v[120:123]
    ds_read_b128 v[24:27], v52 offset:29696
    buffer_store_dwordx4 v[4:7], v1, s[8:11], s25 offen sc1
    v_mfma_f32_16x16x32_bf16 v[124:127], v[28:31], a[188:191], v[124:127]
    v_cvt_pk_bf16_f32 v8, v104, v105
    v_cvt_pk_bf16_f32 v9, v106, v107
    s_waitcnt lgkmcnt(6)
    v_mfma_f32_16x16x32_bf16 v[128:131], v[32:35], a[44:47], v[128:131]
    ds_read_b128 v[28:31], v52 offset:30720
    v_cvt_pk_bf16_f32 v10, v108, v109
    v_cvt_pk_bf16_f32 v11, v110, v111
    v_mfma_f32_16x16x32_bf16 v[132:135], v[32:35], a[188:191], v[132:135]
    s_cmp_gt_u32 s22, 5
    s_cselect_b32 s23, 5, 7
    s_waitcnt lgkmcnt(6)
    v_mfma_f32_16x16x32_bf16 v[120:123], v[36:39], a[48:51], v[120:123]
    ds_read_b128 v[32:35], v52 offset:31744
    s_lshr_b32 s25, s23, 1
    s_mul_i32 s25, s25, 49152
    v_mfma_f32_16x16x32_bf16 v[124:127], v[36:39], a[192:195], v[124:127]
    s_and_b32 s23, s23, 1
    s_lshl_b32 s23, s23, 10
    s_waitcnt lgkmcnt(6)
    v_mfma_f32_16x16x32_bf16 v[128:131], v[40:43], a[48:51], v[128:131]
    ds_read_b128 v[36:39], v52 offset:32768
    s_add_u32 s25, s25, s23
    s_add_u32 s25, s25, s21
    v_mfma_f32_16x16x32_bf16 v[132:135], v[40:43], a[192:195], v[132:135]
    buffer_store_dwordx4 v[8:11], v1, s[8:11], s25 offen sc1
    s_waitcnt lgkmcnt(6)
    v_mfma_f32_16x16x32_bf16 v[120:123], v[44:47], a[52:55], v[120:123]
    ds_read_b128 v[40:43], v52 offset:33792
    v_cvt_pk_bf16_f32 v58, v112, v113
    v_cvt_pk_bf16_f32 v59, v114, v115
    v_mfma_f32_16x16x32_bf16 v[124:127], v[44:47], a[196:199], v[124:127]
    s_lshl_b32 s23, s12, 1
    s_add_u32 s23, s23, 0
    s_waitcnt lgkmcnt(6)
    v_mfma_f32_16x16x32_bf16 v[128:131], v[48:51], a[52:55], v[128:131]
    ds_read_b128 v[44:47], v52 offset:34816
    s_and_b32 s23, s23, 3
    s_mul_i32 s25, s23, 49152
    v_mfma_f32_16x16x32_bf16 v[132:135], v[48:51], a[196:199], v[132:135]
    s_add_u32 s25, s25, s21
    s_add_u32 s25, s25, 2048
    s_waitcnt lgkmcnt(6)
    v_mfma_f32_16x16x32_bf16 v[120:123], v[20:23], a[56:59], v[120:123]
    ds_read_b128 v[48:51], v52 offset:35840
    buffer_store_dwordx2 v[58:59], v56, s[8:11], s25 offen sc1
    v_mfma_f32_16x16x32_bf16 v[124:127], v[20:23], a[200:203], v[124:127]
    s_nop 1
    v_cvt_pk_bf16_f32 v58, v116, v117
    s_waitcnt lgkmcnt(6)
    v_mfma_f32_16x16x32_bf16 v[128:131], v[24:27], a[56:59], v[128:131]
    v_cvt_pk_bf16_f32 v59, v118, v119
    s_lshl_b32 s23, s12, 1
    v_mfma_f32_16x16x32_bf16 v[132:135], v[24:27], a[200:203], v[132:135]
    s_add_u32 s23, s23, 1
    s_and_b32 s23, s23, 3
    s_waitcnt lgkmcnt(5)
    v_mfma_f32_16x16x32_bf16 v[120:123], v[28:31], a[60:63], v[120:123]
    s_mul_i32 s25, s23, 49152
    s_add_u32 s25, s25, s21
    v_mfma_f32_16x16x32_bf16 v[124:127], v[28:31], a[204:207], v[124:127]
    s_waitcnt lgkmcnt(0)
    s_waitcnt vmcnt(7)
    s_barrier
    ds_read_b128 v[20:23], v53 offset:0
    s_add_u32 s25, s25, 2048
    buffer_store_dwordx2 v[58:59], v56, s[8:11], s25 offen sc1
    v_mfma_f32_16x16x32_bf16 v[128:131], v[32:35], a[60:63], v[128:131]
    ds_read_b128 v[24:27], v53 offset:1024
    s_nop 1
    v_mfma_f32_16x16x32_bf16 v[132:135], v[32:35], a[204:207], v[132:135]
    ds_read_b128 v[28:31], v53 offset:2048
    v_mfma_f32_16x16x32_bf16 v[120:123], v[36:39], a[64:67], v[120:123]
    ds_read_b128 v[32:35], v53 offset:3072
    v_mfma_f32_16x16x32_bf16 v[124:127], v[36:39], a[208:211], v[124:127]
    v_mfma_f32_16x16x32_bf16 v[128:131], v[40:43], a[64:67], v[128:131]
    ds_read_b128 v[36:39], v53 offset:4096
    v_mfma_f32_16x16x32_bf16 v[132:135], v[40:43], a[208:211], v[132:135]
    v_mfma_f32_16x16x32_bf16 v[120:123], v[44:47], a[68:71], v[120:123]
    ds_read_b128 v[40:43], v53 offset:5120
    v_mfma_f32_16x16x32_bf16 v[124:127], v[44:47], a[212:215], v[124:127]
    v_mfma_f32_16x16x32_bf16 v[128:131], v[48:51], a[68:71], v[128:131]
    ds_read_b128 v[44:47], v53 offset:6144
    v_mfma_f32_16x16x32_bf16 v[132:135], v[48:51], a[212:215], v[132:135]
    s_waitcnt lgkmcnt(6)
    v_mfma_f32_16x16x32_bf16 v[120:123], v[20:23], a[72:75], v[120:123]
    ds_read_b128 v[48:51], v53 offset:7168
    v_mfma_f32_16x16x32_bf16 v[124:127], v[20:23], a[216:219], v[124:127]
    s_waitcnt lgkmcnt(6)
    v_mfma_f32_16x16x32_bf16 v[128:131], v[24:27], a[72:75], v[128:131]
    ds_read_b128 v[20:23], v53 offset:8192
    v_mfma_f32_16x16x32_bf16 v[132:135], v[24:27], a[216:219], v[132:135]
    s_waitcnt lgkmcnt(6)
    v_mfma_f32_16x16x32_bf16 v[120:123], v[28:31], a[76:79], v[120:123]
    ds_read_b128 v[24:27], v53 offset:9216
    v_mfma_f32_16x16x32_bf16 v[124:127], v[28:31], a[220:223], v[124:127]
    s_waitcnt lgkmcnt(6)
    v_mfma_f32_16x16x32_bf16 v[128:131], v[32:35], a[76:79], v[128:131]
    ds_read_b128 v[28:31], v53 offset:10240
    v_mfma_f32_16x16x32_bf16 v[132:135], v[32:35], a[220:223], v[132:135]
    s_waitcnt lgkmcnt(6)
    v_mfma_f32_16x16x32_bf16 v[120:123], v[36:39], a[80:83], v[120:123]
    ds_read_b128 v[32:35], v53 offset:11264
    v_mfma_f32_16x16x32_bf16 v[124:127], v[36:39], a[224:227], v[124:127]
    s_waitcnt lgkmcnt(6)
    v_mfma_f32_16x16x32_bf16 v[128:131], v[40:43], a[80:83], v[128:131]
    ds_read_b128 v[36:39], v53 offset:12288
    v_mfma_f32_16x16x32_bf16 v[132:135], v[40:43], a[224:227], v[132:135]
    s_waitcnt lgkmcnt(6)
    v_mfma_f32_16x16x32_bf16 v[120:123], v[44:47], a[84:87], v[120:123]
    ds_read_b128 v[40:43], v53 offset:13312
    v_mfma_f32_16x16x32_bf16 v[124:127], v[44:47], a[228:231], v[124:127]
    s_waitcnt lgkmcnt(6)
    v_mfma_f32_16x16x32_bf16 v[128:131], v[48:51], a[84:87], v[128:131]
    ds_read_b128 v[44:47], v53 offset:14336
    v_mfma_f32_16x16x32_bf16 v[132:135], v[48:51], a[228:231], v[132:135]
    s_waitcnt lgkmcnt(6)
    v_mfma_f32_16x16x32_bf16 v[120:123], v[20:23], a[88:91], v[120:123]
    ds_read_b128 v[48:51], v53 offset:15360
    v_mfma_f32_16x16x32_bf16 v[124:127], v[20:23], a[232:235], v[124:127]
    s_waitcnt lgkmcnt(6)
    v_mfma_f32_16x16x32_bf16 v[128:131], v[24:27], a[88:91], v[128:131]
    ds_read_b128 v[20:23], v53 offset:16384
    v_mfma_f32_16x16x32_bf16 v[132:135], v[24:27], a[232:235], v[132:135]
    s_waitcnt lgkmcnt(6)
    v_mfma_f32_16x16x32_bf16 v[120:123], v[28:31], a[92:95], v[120:123]
    ds_read_b128 v[24:27], v53 offset:17408
    v_mfma_f32_16x16x32_bf16 v[124:127], v[28:31], a[236:239], v[124:127]
    s_waitcnt lgkmcnt(6)
    v_mfma_f32_16x16x32_bf16 v[128:131], v[32:35], a[92:95], v[128:131]
    ds_read_b128 v[28:31], v53 offset:18432
    v_mfma_f32_16x16x32_bf16 v[132:135], v[32:35], a[236:239], v[132:135]
    s_waitcnt lgkmcnt(6)
    v_mfma_f32_16x16x32_bf16 v[120:123], v[36:39], a[96:99], v[120:123]
    ds_read_b128 v[32:35], v53 offset:19456
    v_mfma_f32_16x16x32_bf16 v[124:127], v[36:39], a[240:243], v[124:127]
    s_waitcnt vmcnt(0)
    s_barrier
    s_lshl_b32 s23, s20, 2
    s_add_u32 s23, s23, s35
    s_lshl_b32 s23, s23, 7
    s_add_u32 s23, s23, 0x4820000
    s_cmp_lg_u32 s12, 0
    s_cbranch_scc1 L_l17
    v_mov_b32 v16, 0
    v_mov_b32 v17, 1
    s_mov_b64 exec, 1
    buffer_store_dword v17, v16, s[8:11], s23 offen sc1
    s_mov_b64 exec, -1
L_l17:
    s_waitcnt lgkmcnt(6)
    v_mfma_f32_16x16x32_bf16 v[128:131], v[40:43], a[96:99], v[128:131]
    ds_read_b128 v[36:39], v53 offset:20480
    v_mfma_f32_16x16x32_bf16 v[132:135], v[40:43], a[240:243], v[132:135]
    s_waitcnt lgkmcnt(6)
    v_mfma_f32_16x16x32_bf16 v[120:123], v[44:47], a[100:103], v[120:123]
    ds_read_b128 v[40:43], v53 offset:21504
    v_mfma_f32_16x16x32_bf16 v[124:127], v[44:47], a[244:247], v[124:127]
    s_waitcnt lgkmcnt(6)
    v_mfma_f32_16x16x32_bf16 v[128:131], v[48:51], a[100:103], v[128:131]
    ds_read_b128 v[44:47], v53 offset:22528
    v_mfma_f32_16x16x32_bf16 v[132:135], v[48:51], a[244:247], v[132:135]
    s_waitcnt lgkmcnt(6)
    v_mfma_f32_16x16x32_bf16 v[120:123], v[20:23], a[104:107], v[120:123]
    ds_read_b128 v[48:51], v53 offset:23552
    v_mfma_f32_16x16x32_bf16 v[124:127], v[20:23], a[248:251], v[124:127]
    s_waitcnt lgkmcnt(6)
    v_mfma_f32_16x16x32_bf16 v[128:131], v[24:27], a[104:107], v[128:131]
    ds_read_b128 v[20:23], v53 offset:24576
    v_mfma_f32_16x16x32_bf16 v[132:135], v[24:27], a[248:251], v[132:135]
    s_waitcnt lgkmcnt(6)
    v_mfma_f32_16x16x32_bf16 v[120:123], v[28:31], a[108:111], v[120:123]
    ds_read_b128 v[24:27], v53 offset:25600
    v_mfma_f32_16x16x32_bf16 v[124:127], v[28:31], a[252:255], v[124:127]
    s_waitcnt lgkmcnt(6)
    v_mfma_f32_16x16x32_bf16 v[128:131], v[32:35], a[108:111], v[128:131]
    ds_read_b128 v[28:31], v53 offset:26624
    v_mfma_f32_16x16x32_bf16 v[132:135], v[32:35], a[252:255], v[132:135]
    s_waitcnt lgkmcnt(6)
    v_mfma_f32_16x16x32_bf16 v[120:123], v[36:39], a[112:115], v[120:123]
    ds_read_b128 v[32:35], v53 offset:27648
    v_mfma_f32_16x16x32_bf16 v[124:127], v[36:39], v[224:227], v[124:127]
    s_waitcnt lgkmcnt(6)
    v_mfma_f32_16x16x32_bf16 v[128:131], v[40:43], a[112:115], v[128:131]
    ds_read_b128 v[36:39], v53 offset:28672
    v_mfma_f32_16x16x32_bf16 v[132:135], v[40:43], v[224:227], v[132:135]
    s_waitcnt lgkmcnt(6)
    v_mfma_f32_16x16x32_bf16 v[120:123], v[44:47], a[116:119], v[120:123]
    ds_read_b128 v[40:43], v53 offset:29696
    v_mfma_f32_16x16x32_bf16 v[124:127], v[44:47], v[228:231], v[124:127]
    s_waitcnt lgkmcnt(6)
    v_mfma_f32_16x16x32_bf16 v[128:131], v[48:51], a[116:119], v[128:131]
    ds_read_b128 v[44:47], v53 offset:30720
    v_mfma_f32_16x16x32_bf16 v[132:135], v[48:51], v[228:231], v[132:135]
    s_waitcnt lgkmcnt(6)
    v_mfma_f32_16x16x32_bf16 v[120:123], v[20:23], a[120:123], v[120:123]
    ds_read_b128 v[48:51], v53 offset:31744
    v_mfma_f32_16x16x32_bf16 v[124:127], v[20:23], v[232:235], v[124:127]
    s_waitcnt lgkmcnt(6)
    v_mfma_f32_16x16x32_bf16 v[128:131], v[24:27], a[120:123], v[128:131]
    ds_read_b128 v[20:23], v53 offset:32768
    v_mfma_f32_16x16x32_bf16 v[132:135], v[24:27], v[232:235], v[132:135]
    s_waitcnt lgkmcnt(6)
    v_mfma_f32_16x16x32_bf16 v[120:123], v[28:31], a[124:127], v[120:123]
    ds_read_b128 v[24:27], v53 offset:33792
    v_mfma_f32_16x16x32_bf16 v[124:127], v[28:31], v[236:239], v[124:127]
    s_waitcnt lgkmcnt(6)
    v_mfma_f32_16x16x32_bf16 v[128:131], v[32:35], a[124:127], v[128:131]
    ds_read_b128 v[28:31], v53 offset:34816
    v_mfma_f32_16x16x32_bf16 v[132:135], v[32:35], v[236:239], v[132:135]
    s_waitcnt lgkmcnt(6)
    v_mfma_f32_16x16x32_bf16 v[120:123], v[36:39], a[128:131], v[120:123]
    ds_read_b128 v[32:35], v53 offset:35840
    v_mfma_f32_16x16x32_bf16 v[124:127], v[36:39], v[240:243], v[124:127]
    s_waitcnt lgkmcnt(6)
    v_mfma_f32_16x16x32_bf16 v[128:131], v[40:43], a[128:131], v[128:131]
    v_mfma_f32_16x16x32_bf16 v[132:135], v[40:43], v[240:243], v[132:135]
    s_waitcnt lgkmcnt(5)
    v_mfma_f32_16x16x32_bf16 v[120:123], v[44:47], a[132:135], v[120:123]
    v_mfma_f32_16x16x32_bf16 v[124:127], v[44:47], v[244:247], v[124:127]
    s_waitcnt lgkmcnt(4)
    v_mfma_f32_16x16x32_bf16 v[128:131], v[48:51], a[132:135], v[128:131]
    v_mfma_f32_16x16x32_bf16 v[132:135], v[48:51], v[244:247], v[132:135]
    s_waitcnt lgkmcnt(3)
    v_mfma_f32_16x16x32_bf16 v[120:123], v[20:23], a[136:139], v[120:123]
    v_mfma_f32_16x16x32_bf16 v[124:127], v[20:23], v[248:251], v[124:127]
    s_waitcnt lgkmcnt(2)
    v_mfma_f32_16x16x32_bf16 v[128:131], v[24:27], a[136:139], v[128:131]
    v_mfma_f32_16x16x32_bf16 v[132:135], v[24:27], v[248:251], v[132:135]
    s_waitcnt lgkmcnt(1)
    v_mfma_f32_16x16x32_bf16 v[120:123], v[28:31], a[140:143], v[120:123]
    v_mfma_f32_16x16x32_bf16 v[124:127], v[28:31], v[252:255], v[124:127]
    s_waitcnt lgkmcnt(0)
    v_mfma_f32_16x16x32_bf16 v[128:131], v[32:35], a[140:143], v[128:131]
    v_mfma_f32_16x16x32_bf16 v[132:135], v[32:35], v[252:255], v[132:135]
    s_lshl_b32 s16, s33, 2
    s_add_u32 s16, s16, s12
    v_and_b32 v4, 15, v0
    v_lshlrev_b32 v5, 4, v4
    v_bfe_u32 v6, v0, 5, 1
    v_lshlrev_b32 v6, 9, v6
    v_add_u32 v5, v5, v6
    v_bfe_u32 v6, v0, 4, 1
    v_lshlrev_b32 v6, 3, v6
    v_add_u32 v5, v5, v6
    v_mul_u32_u24 v7, 1152, v4
    v_lshrrev_b32 v6, 4, v0
    v_lshlrev_b32 v6, 3, v6
    v_add_u32 v7, v7, v6
    v_lshlrev_b32 v8, 2, v4
    s_mul_i32 s17, s16, 36
    s_mul_i32 s18, s34, 9
    s_add_u32 s17, s17, s18
    s_add_u32 s19, s17, 8
    s_add_u32 s17, s17, s22
    s_lshl_b32 s17, s17, 10
    s_add_u32 s17, s17, 0x500000
    s_and_b32 s29, s35, 1
    s_lshl_b32 s19, s19, 10
    s_lshl_b32 s23, s29, 8
    s_add_u32 s19, s19, s23
    s_add_u32 s19, s19, 0x500000
    s_lshl_b32 s18, s16, 7
    s_add_u32 s18, s18, 0x490000
    s_load_dwordx2 s[24:25], s[0:1], 64
    buffer_load_dword v10, v8, s[8:11], s18 offen sc1
    buffer_load_dword v11, v8, s[8:11], s18 offen offset:64 sc1
    s_add_u32 s23, s17, 0
    buffer_load_dwordx2 v[20:21], v5, s[8:11], s23 offen sc1
    s_add_u32 s23, s17, 256
    buffer_load_dwordx2 v[22:23], v5, s[8:11], s23 offen sc1
    s_add_u32 s23, s17, 1024
    buffer_load_dwordx2 v[24:25], v5, s[8:11], s23 offen sc1
    s_add_u32 s23, s17, 1280
    buffer_load_dwordx2 v[26:27], v5, s[8:11], s23 offen sc1
    buffer_load_dwordx2 v[28:29], v5, s[8:11], s19 offen sc1
    v_and_b32 v3, 3, v0
    v_lshlrev_b32 v3, 7, v3
    s_lshl_b32 s23, s20, 9
    s_add_u32 s23, s23, 0x4820000
    v_add_u32 v3, s23, v3
    s_cmp_lg_u32 s12, 0
    s_cbranch_scc1 L_pd18
    s_mov_b32 s88, 0
L_pl18:
    buffer_load_dword v12, v3, s[8:11], 0 offen sc1
    s_add_u32 s88, s88, 1
    s_waitcnt vmcnt(0)
    v_cmp_ne_u32 vcc, 1, v12
    s_nop 1
    s_cbranch_vccz L_pd18
    s_sleep 1
    s_cmp_lt_u32 s88, 1048576
    s_cbranch_scc1 L_pl18
L_pd18:
    s_barrier
    s_waitcnt lgkmcnt(0)
    s_mov_b32 s26, 2359296
    s_mov_b32 s27, 0x00020000
    s_lshl_b32 s21, s20, 2
    s_add_u32 s21, s21, s35
    s_lshl_b32 s21, s21, 4
    s_add_u32 s21, s21, s12
    s_mul_i32 s21, s21, 3072
    s_add_u32 s21, s21, 0x3000000
    s_add_u32 s23, s35, 1
    s_and_b32 s23, s23, 3
    s_mul_i32 s23, s23, 12288
    s_add_u32 s23, s23, s21
    buffer_load_dwordx4 v[32:35], v1, s[8:11], s23 offen sc1
    buffer_load_dwordx4 v[36:39], v1, s[8:11], s23 offen offset:1024 sc1
    buffer_load_dwordx2 v[12:13], v56, s[8:11], s23 offen offset:2048 sc1
    s_add_u32 s23, s35, 2
    s_and_b32 s23, s23, 3
    s_mul_i32 s23, s23, 12288
    s_add_u32 s23, s23, s21
    buffer_load_dwordx4 v[40:43], v1, s[8:11], s23 offen sc1
    buffer_load_dwordx4 v[44:47], v1, s[8:11], s23 offen offset:1024 sc1
    buffer_load_dwordx2 v[14:15], v56, s[8:11], s23 offen offset:2048 sc1
    s_add_u32 s23, s35, 3
    s_and_b32 s23, s23, 3
    s_mul_i32 s23, s23, 12288
    s_add_u32 s23, s23, s21
    buffer_load_dwordx4 v[48:51], v1, s[8:11], s23 offen sc1
    buffer_load_dwordx4 v[52:55], v1, s[8:11], s23 offen offset:1024 sc1
    buffer_load_dwordx2 v[16:17], v56, s[8:11], s23 offen offset:2048 sc1
    s_mul_i32 s19, s16, 36864
    s_mul_i32 s23, s34, 288
    s_add_u32 s19, s19, s23
    s_add_u32 s28, s19, 256
    s_lshl_b32 s23, s22, 5
    s_add_u32 s19, s19, s23
    s_waitcnt vmcnt(0)
    v_lshlrev_b32 v30, 16, v32
    v_and_b32 v31, 0xffff0000, v32
    v_add_f32 v120, v120, v30
    v_add_f32 v121, v121, v31
    v_lshlrev_b32 v30, 16, v33
    v_and_b32 v31, 0xffff0000, v33
    v_add_f32 v122, v122, v30
    v_add_f32 v123, v123, v31
    v_lshlrev_b32 v30, 16, v40
    v_and_b32 v31, 0xffff0000, v40
    v_add_f32 v120, v120, v30
    v_add_f32 v121, v121, v31
    v_lshlrev_b32 v30, 16, v41
    v_and_b32 v31, 0xffff0000, v41
    v_add_f32 v122, v122, v30
    v_add_f32 v123, v123, v31
    v_lshlrev_b32 v30, 16, v48
    v_and_b32 v31, 0xffff0000, v48
    v_add_f32 v120, v120, v30
    v_add_f32 v121, v121, v31
    v_lshlrev_b32 v30, 16, v49
    v_and_b32 v31, 0xffff0000, v49
    v_add_f32 v122, v122, v30
    v_add_f32 v123, v123, v31
    v_lshlrev_b32 v30, 16, v20
    v_and_b32 v31, 0xffff0000, v20
    v_add_f32 v120, v120, v30
    v_add_f32 v121, v121, v31
    v_lshlrev_b32 v30, 16, v21
    v_and_b32 v31, 0xffff0000, v21
    v_add_f32 v122, v122, v30
    v_add_f32 v123, v123, v31
    v_add_f32 v120, v120, v10
    v_add_f32 v121, v121, v10
    v_add_f32 v122, v122, v10
    v_add_f32 v123, v123, v10
    v_cvt_pk_bf16_f32 v120, v120, v121
    v_cvt_pk_bf16_f32 v121, v122, v123
    s_add_u32 s23, s19, 0
    buffer_store_dwordx2 v[120:121], v7, s[24:27], s23 offen
    v_lshlrev_b32 v30, 16, v34
    v_and_b32 v31, 0xffff0000, v34
    v_add_f32 v124, v124, v30
    v_add_f32 v125, v125, v31
    v_lshlrev_b32 v30, 16, v35
    v_and_b32 v31, 0xffff0000, v35
    v_add_f32 v126, v126, v30
    v_add_f32 v127, v127, v31
    v_lshlrev_b32 v30, 16, v42
    v_and_b32 v31, 0xffff0000, v42
    v_add_f32 v124, v124, v30
    v_add_f32 v125, v125, v31
    v_lshlrev_b32 v30, 16, v43
    v_and_b32 v31, 0xffff0000, v43
    v_add_f32 v126, v126, v30
    v_add_f32 v127, v127, v31
    v_lshlrev_b32 v30, 16, v50
    v_and_b32 v31, 0xffff0000, v50
    v_add_f32 v124, v124, v30
    v_add_f32 v125, v125, v31
    v_lshlrev_b32 v30, 16, v51
    v_and_b32 v31, 0xffff0000, v51
    v_add_f32 v126, v126, v30
    v_add_f32 v127, v127, v31
    v_lshlrev_b32 v30, 16, v22
    v_and_b32 v31, 0xffff0000, v22
    v_add_f32 v124, v124, v30
    v_add_f32 v125, v125, v31
    v_lshlrev_b32 v30, 16, v23
    v_and_b32 v31, 0xffff0000, v23
    v_add_f32 v126, v126, v30
    v_add_f32 v127, v127, v31
    v_add_f32 v124, v124, v11
    v_add_f32 v125, v125, v11
    v_add_f32 v126, v126, v11
    v_add_f32 v127, v127, v11
    v_cvt_pk_bf16_f32 v124, v124, v125
    v_cvt_pk_bf16_f32 v125, v126, v127
    s_add_u32 s23, s19, 18432
    buffer_store_dwordx2 v[124:125], v7, s[24:27], s23 offen
    v_lshlrev_b32 v30, 16, v36
    v_and_b32 v31, 0xffff0000, v36
    v_add_f32 v128, v128, v30
    v_add_f32 v129, v129, v31
    v_lshlrev_b32 v30, 16, v37
    v_and_b32 v31, 0xffff0000, v37
    v_add_f32 v130, v130, v30
    v_add_f32 v131, v131, v31
    v_lshlrev_b32 v30, 16, v44
    v_and_b32 v31, 0xffff0000, v44
    v_add_f32 v128, v128, v30
    v_add_f32 v129, v129, v31
    v_lshlrev_b32 v30, 16, v45
    v_and_b32 v31, 0xffff0000, v45
    v_add_f32 v130, v130, v30
    v_add_f32 v131, v131, v31
    v_lshlrev_b32 v30, 16, v52
    v_and_b32 v31, 0xffff0000, v52
    v_add_f32 v128, v128, v30
    v_add_f32 v129, v129, v31
    v_lshlrev_b32 v30, 16, v53
    v_and_b32 v31, 0xffff0000, v53
    v_add_f32 v130, v130, v30
    v_add_f32 v131, v131, v31
    v_lshlrev_b32 v30, 16, v24
    v_and_b32 v31, 0xffff0000, v24
    v_add_f32 v128, v128, v30
    v_add_f32 v129, v129, v31
    v_lshlrev_b32 v30, 16, v25
    v_and_b32 v31, 0xffff0000, v25
    v_add_f32 v130, v130, v30
    v_add_f32 v131, v131, v31
    v_add_f32 v128, v128, v10
    v_add_f32 v129, v129, v10
    v_add_f32 v130, v130, v10
    v_add_f32 v131, v131, v10
    v_cvt_pk_bf16_f32 v128, v128, v129
    v_cvt_pk_bf16_f32 v129, v130, v131
    s_add_u32 s23, s19, 32
    buffer_store_dwordx2 v[128:129], v7, s[24:27], s23 offen
    v_lshlrev_b32 v30, 16, v38
    v_and_b32 v31, 0xffff0000, v38
    v_add_f32 v132, v132, v30
    v_add_f32 v133, v133, v31
    v_lshlrev_b32 v30, 16, v39
    v_and_b32 v31, 0xffff0000, v39
    v_add_f32 v134, v134, v30
    v_add_f32 v135, v135, v31
    v_lshlrev_b32 v30, 16, v46
    v_and_b32 v31, 0xffff0000, v46
    v_add_f32 v132, v132, v30
    v_add_f32 v133, v133, v31
    v_lshlrev_b32 v30, 16, v47
    v_and_b32 v31, 0xffff0000, v47
    v_add_f32 v134, v134, v30
    v_add_f32 v135, v135, v31
    v_lshlrev_b32 v30, 16, v54
    v_and_b32 v31, 0xffff0000, v54
    v_add_f32 v132, v132, v30
    v_add_f32 v133, v133, v31
    v_lshlrev_b32 v30, 16, v55
    v_and_b32 v31, 0xffff0000, v55
    v_add_f32 v134, v134, v30
    v_add_f32 v135, v135, v31
    v_lshlrev_b32 v30, 16, v26
    v_and_b32 v31, 0xffff0000, v26
    v_add_f32 v132, v132, v30
    v_add_f32 v133, v133, v31
    v_lshlrev_b32 v30, 16, v27
    v_and_b32 v31, 0xffff0000, v27
    v_add_f32 v134, v134, v30
    v_add_f32 v135, v135, v31
    v_add_f32 v132, v132, v11
    v_add_f32 v133, v133, v11
    v_add_f32 v134, v134, v11
    v_add_f32 v135, v135, v11
    v_cvt_pk_bf16_f32 v132, v132, v133
    v_cvt_pk_bf16_f32 v133, v134, v135
    s_add_u32 s23, s19, 18464
    buffer_store_dwordx2 v[132:133], v7, s[24:27], s23 offen
    s_and_b32 s23, s12, 1
    s_lshr_b32 s30, s35, 1
    s_cmp_lg_u32 s23, s30
    s_cbranch_scc1 L_n8_19
    s_cmp_eq_u32 s29, 0
    s_cselect_b64 vcc, -1, 0
    v_cndmask_b32 v112, v116, v112, vcc
    v_cndmask_b32 v113, v117, v113, vcc
    v_cndmask_b32 v114, v118, v114, vcc
    v_cndmask_b32 v115, v119, v115, vcc
    v_cndmask_b32 v10, v11, v10, vcc
    v_lshlrev_b32 v30, 16, v12
    v_and_b32 v31, 0xffff0000, v12
    v_add_f32 v112, v112, v30
    v_add_f32 v113, v113, v31
    v_lshlrev_b32 v30, 16, v13
    v_and_b32 v31, 0xffff0000, v13
    v_add_f32 v114, v114, v30
    v_add_f32 v115, v115, v31
    v_lshlrev_b32 v30, 16, v14
    v_and_b32 v31, 0xffff0000, v14
    v_add_f32 v112, v112, v30
    v_add_f32 v113, v113, v31
    v_lshlrev_b32 v30, 16, v15
    v_and_b32 v31, 0xffff0000, v15
    v_add_f32 v114, v114, v30
    v_add_f32 v115, v115, v31
    v_lshlrev_b32 v30, 16, v16
    v_and_b32 v31, 0xffff0000, v16
    v_add_f32 v112, v112, v30
    v_add_f32 v113, v113, v31
    v_lshlrev_b32 v30, 16, v17
    v_and_b32 v31, 0xffff0000, v17
    v_add_f32 v114, v114, v30
    v_add_f32 v115, v115, v31
    v_lshlrev_b32 v30, 16, v28
    v_and_b32 v31, 0xffff0000, v28
    v_add_f32 v112, v112, v30
    v_add_f32 v113, v113, v31
    v_lshlrev_b32 v30, 16, v29
    v_and_b32 v31, 0xffff0000, v29
    v_add_f32 v114, v114, v30
    v_add_f32 v115, v115, v31
    v_add_f32 v112, v112, v10
    v_add_f32 v113, v113, v10
    v_add_f32 v114, v114, v10
    v_add_f32 v115, v115, v10
    v_cvt_pk_bf16_f32 v112, v112, v113
    v_cvt_pk_bf16_f32 v113, v114, v115
    s_mul_i32 s23, s29, 18432
    s_add_u32 s23, s23, s28
    buffer_store_dwordx2 v[112:113], v7, s[24:27], s23 offen
L_n8_19:
L_k2_kernel_end:
    s_endpgm
L_k2_kernel_codeend:
.section .rodata,"a"
.p2align 6
.amdhsa_kernel k2_kernel
  .amdhsa_next_free_vgpr 512
  .amdhsa_next_free_sgpr 96
  .amdhsa_accum_offset 256
  .amdhsa_group_segment_fixed_size 0
  .amdhsa_kernarg_size 88
  .amdhsa_user_sgpr_count 2
  .amdhsa_user_sgpr_kernarg_segment_ptr 1
  .amdhsa_system_sgpr_workgroup_id_x 1
  .amdhsa_float_denorm_mode_32 3
  .amdhsa_float_denorm_mode_16_64 3
.end_amdhsa_kernel
.text
```
